```python
import torch

def _softmax(x, axis=-1):
    return torch.softmax(x, dim=axis)

def _gelu(x):
    return torch.nn.functional.gelu(x, approximate='tanh')

def _silu(x):
    return torch.nn.functional.silu(x)

def _sigmoid(x):
    return torch.sigmoid(x)

def _layernorm(x, axis=-1, eps=1e-05):
    m = x.mean(dim=axis, keepdim=True)
    v = x.var(dim=axis, keepdim=True, unbiased=False)
    return (x - m) / torch.sqrt(v + eps)

def _scatter_add(tgt, idx, src, axis=0):
    return tgt.clone().index_add_(axis, idx, src)

def _segment_sum(src, seg, n):
    out = torch.zeros((n,) + src.shape[1:], dtype=src.dtype)
    return out.index_add_(0, seg, src)

def _pad(x, pw):
    flat = tuple((v for pair in reversed(pw) for v in pair))
    return torch.nn.functional.pad(x, flat)
kernel_name = 'adaLN_cond__memory_aug_recurrent_mem_tr__glu_gated_reglu__prompt'

def setup_inputs():

    _w = lambda a: (lambda t: t.to(torch.bfloat16) if t.is_floating_point() else t)(torch.as_tensor(a))

    def _A_setup():
        B, S, Dm = (1, 2048, 576)
        H, Dh = (32, 128)
        M, seg = (8, 32)
        seg = min(seg, S)
        S = S // seg * seg
        return {'x': _w((lambda *s: torch.randn(*s, dtype=torch.bfloat16) * 0.05)(B, S, Dm)), 'mem0': _w((lambda *s: torch.randn(*s, dtype=torch.bfloat16) * 0.8)(B, M, Dm)), 'Wq': _w((lambda *s: torch.randn(*s, dtype=torch.bfloat16) * 0.8)(Dm, H, Dh) * Dm ** (-0.5)), 'Wk': _w((lambda *s: torch.randn(*s, dtype=torch.bfloat16) * 0.8)(Dm, H, Dh) * Dm ** (-0.5)), 'Wv': _w((lambda *s: torch.randn(*s, dtype=torch.bfloat16) * 0.8)(Dm, H, Dh) * Dm ** (-0.5)), 'Wo': _w((lambda *s: torch.randn(*s, dtype=torch.bfloat16) * 0.8)(H, Dh, Dm) * (H * Dh) ** (-0.5)), 'seg_len': seg}
    _A_in = _A_setup()

    def _B_setup():
        B, S, D, F = (1, 2048, 576, 4608)
        return {'x': _w((lambda *s: torch.randn(*s, dtype=torch.bfloat16) * 0.05)(B, S, D)), 'W_gate': _w((lambda *s: torch.randn(*s, dtype=torch.bfloat16) * 0.4)(D, F) * (2.0 / D) ** 0.5), 'W_up': _w((lambda *s: torch.randn(*s, dtype=torch.bfloat16) * 0.4)(D, F) * (2.0 / D) ** 0.5), 'W_down': _w((lambda *s: torch.randn(*s, dtype=torch.bfloat16) * 0.4)(F, D) * (1.0 / F) ** 0.5)}
    _B_in = _B_setup()
    return {'A_x': _A_in['x'], 'A_mem0': _A_in['mem0'], 'A_Wq': _A_in['Wq'], 'A_Wk': _A_in['Wk'], 'A_Wv': _A_in['Wv'], 'A_Wo': _A_in['Wo'], 'A_seg_len': _A_in['seg_len'], 'B_x': _B_in['x'], 'B_W_gate': _B_in['W_gate'], 'B_W_up': _B_in['W_up'], 'B_W_down': _B_in['W_down'], 'c': _w((lambda *s: torch.randn(*s, dtype=torch.bfloat16) * 0.1)(1, 576) * 8.0), 'w_mod': _w((lambda *s: torch.randn(*s, dtype=torch.bfloat16) * 0.1)(576, 6 * 576) * 576 ** (-0.5) * 8.0)}

def reference(A_x, A_mem0, A_Wq, A_Wk, A_Wv, A_Wo, A_seg_len, B_x, B_W_gate, B_W_up, B_W_down, c, w_mod):

    def _A_ref(x, mem0, Wq, Wk, Wv, Wo, seg_len):
        B, S, Dm = x.shape
        H, Dh = (Wq.shape[1], Wq.shape[2])
        M = mem0.shape[1]
        scale = Dh ** (-0.5)
        n_seg = S // seg_len
        L = M + seg_len
        idx = torch.arange(L)
        mask = (idx[:, None] < M) | (idx[:, None] >= idx[None, :])
        mem = mem0
        outs = []
        for s in range(n_seg):
            xs = x[:, s * seg_len:(s + 1) * seg_len, :].clone()
            h = torch.concatenate([mem, xs], axis=1)
            q = torch.einsum('btd,dhe->bhte', h, Wq)
            k = torch.einsum('btd,dhe->bhte', h, Wk)
            v = torch.einsum('btd,dhe->bhte', h, Wv)
            scores = torch.einsum('bhqe,bhke->bhqk', q, k) * scale
            scores = torch.where(mask[None, None], scores, -1000000000.0)
            p = _softmax(scores, axis=-1)
            o = torch.einsum('bhqk,bhke->bhqe', p, v)
            o = torch.einsum('bhte,hed->btd', o, Wo)
            mem = o[:, :M, :].clone()
            outs.append(o[:, M:, :])
        return torch.concatenate(outs, axis=1)

    def _B_ref(x, W_gate, W_up, W_down):
        gate = torch.einsum('bsd,df->bsf', x, W_gate)
        up = torch.einsum('bsd,df->bsf', x, W_up)
        gate = gate * (lambda x, dt: x.to(dt))(gate > 0, gate.dtype)
        h = gate * up
        return torch.einsum('bsf,fd->bsd', h, W_down)
    x = A_x
    mod = (_silu(c) @ w_mod).reshape(c.shape[0], 6, 1, -1)
    sa, ca, ga, sb, cb, gb = (mod[:, 0].clone(), mod[:, 1].clone(), mod[:, 2].clone(), mod[:, 3].clone(), mod[:, 4].clone(), mod[:, 5].clone())
    h = _layernorm(x, axis=-1) * (1 + ca) + sa
    x = x + ga * _A_ref(h, A_mem0, A_Wq, A_Wk, A_Wv, A_Wo, A_seg_len)
    h = _layernorm(x, axis=-1) * (1 + cb) + sb
    x = x + gb * _B_ref(h, B_W_gate, B_W_up, B_W_down)
    return x
```

```asm
; @launch kernel=k0_kernel grid=(90,1,1) block=(256,1,1) lds=8192
; @launch kernel=ln1_kernel grid=(512,1,1) block=(256,1,1) lds=0
; @launch kernel=qkv_kernel grid=(1536,1,1) block=(256,1,1) lds=65536
; @launch kernel=rec_kernel grid=(32,1,1) block=(256,1,1) lds=163840
; @launch kernel=attn_kernel grid=(512,1,1) block=(256,1,1) lds=65536
; @launch kernel=oproj_kernel grid=(80,1,1) block=(256,1,1) lds=65536
; @launch kernel=ln2_kernel grid=(512,1,1) block=(256,1,1) lds=0
; @launch kernel=ffn1_kernel grid=(1152,1,1) block=(256,1,1) lds=65536
; @launch kernel=ffn2_kernel grid=(80,1,1) block=(256,1,1) lds=65536
.amdgcn_target "amdgcn-amd-amdhsa--gfx950"
.text
.globl k0_kernel
.p2align 8
.type k0_kernel,@function
k0_kernel:
    s_cmp_ge_u32 s2, 90
    s_cbranch_scc1 k0_end
    s_load_dwordx2 s[4:5], s[0:1], 120
    s_load_dwordx2 s[6:7], s[0:1], 88
    s_load_dwordx2 s[8:9], s[0:1], 96
    s_waitcnt lgkmcnt(0)
    s_cmp_ge_u32 s2, 54
    s_cbranch_scc1 k0_zero
    s_mov_b32 s12, s6
    s_and_b32 s13, s7, 0xffff
    s_mov_b32 s14, 1152
    s_mov_b32 s15, 0x00020000
    s_mov_b32 s16, s8
    s_and_b32 s17, s9, 0xffff
    s_mov_b32 s18, 3981312
    s_mov_b32 s19, 0x00020000
    v_lshlrev_b32 v1, 1, v0
    buffer_load_ushort v2, v1, s[12:15], 0 offen offset:0
    buffer_load_ushort v3, v1, s[12:15], 0 offen offset:512
    buffer_load_ushort v4, v1, s[12:15], 0 offen offset:1024
    s_waitcnt vmcnt(0)
    v_lshlrev_b32 v8, 2, v0
    v_lshlrev_b32 v2, 16, v2
    v_mul_f32 v5, 0xbfb8aa3b, v2
    v_exp_f32 v5, v5
    s_nop 0
    v_add_f32 v5, 1.0, v5
    v_rcp_f32 v5, v5
    s_nop 0
    v_mul_f32 v5, v5, v2
    v_cvt_pk_bf16_f32 v5, v5, v5
    v_lshlrev_b32 v5, 16, v5
    ds_write_b32 v8, v5 offset:0
    v_lshlrev_b32 v3, 16, v3
    v_mul_f32 v5, 0xbfb8aa3b, v3
    v_exp_f32 v5, v5
    s_nop 0
    v_add_f32 v5, 1.0, v5
    v_rcp_f32 v5, v5
    s_nop 0
    v_mul_f32 v5, v5, v3
    v_cvt_pk_bf16_f32 v5, v5, v5
    v_lshlrev_b32 v5, 16, v5
    ds_write_b32 v8, v5 offset:1024
    v_lshlrev_b32 v4, 16, v4
    v_mul_f32 v5, 0xbfb8aa3b, v4
    v_exp_f32 v5, v5
    s_nop 0
    v_add_f32 v5, 1.0, v5
    v_rcp_f32 v5, v5
    s_nop 0
    v_mul_f32 v5, v5, v4
    v_cvt_pk_bf16_f32 v5, v5, v5
    v_lshlrev_b32 v5, 16, v5
    ds_write_b32 v8, v5 offset:2048
    s_waitcnt lgkmcnt(0)
    s_barrier
    v_lshrrev_b32 v1, 6, v0
    v_and_b32 v2, 63, v0
    s_lshl_b32 s3, s2, 6
    v_add_u32 v2, s3, v2
    v_lshlrev_b32 v3, 1, v2
    s_mov_b32 s20, 995328
    v_mul_lo_u32 v4, v1, s20
    v_add_u32 v3, v3, v4
    s_mov_b32 s20, 576
    v_mul_lo_u32 v9, v1, s20
    v_mov_b32 v30, 0
    s_mov_b32 s20, 0
    buffer_load_ushort v10, v3, s[16:19], s20 offen
    s_add_u32 s20, s20, 6912
    buffer_load_ushort v11, v3, s[16:19], s20 offen
    s_add_u32 s20, s20, 6912
    buffer_load_ushort v12, v3, s[16:19], s20 offen
    s_add_u32 s20, s20, 6912
    buffer_load_ushort v13, v3, s[16:19], s20 offen
    s_add_u32 s20, s20, 6912
    buffer_load_ushort v14, v3, s[16:19], s20 offen
    s_add_u32 s20, s20, 6912
    buffer_load_ushort v15, v3, s[16:19], s20 offen
    s_add_u32 s20, s20, 6912
    buffer_load_ushort v16, v3, s[16:19], s20 offen
    s_add_u32 s20, s20, 6912
    buffer_load_ushort v17, v3, s[16:19], s20 offen
    s_add_u32 s20, s20, 6912
    ds_read_b128 v[20:23], v9 offset:0
    ds_read_b128 v[24:27], v9 offset:16
    s_waitcnt vmcnt(0) lgkmcnt(0)
    v_lshlrev_b32 v10, 16, v10
    v_fmac_f32 v30, v10, v20
    v_lshlrev_b32 v11, 16, v11
    v_fmac_f32 v30, v11, v21
    v_lshlrev_b32 v12, 16, v12
    v_fmac_f32 v30, v12, v22
    v_lshlrev_b32 v13, 16, v13
    v_fmac_f32 v30, v13, v23
    v_lshlrev_b32 v14, 16, v14
    v_fmac_f32 v30, v14, v24
    v_lshlrev_b32 v15, 16, v15
    v_fmac_f32 v30, v15, v25
    v_lshlrev_b32 v16, 16, v16
    v_fmac_f32 v30, v16, v26
    v_lshlrev_b32 v17, 16, v17
    v_fmac_f32 v30, v17, v27
    buffer_load_ushort v10, v3, s[16:19], s20 offen
    s_add_u32 s20, s20, 6912
    buffer_load_ushort v11, v3, s[16:19], s20 offen
    s_add_u32 s20, s20, 6912
    buffer_load_ushort v12, v3, s[16:19], s20 offen
    s_add_u32 s20, s20, 6912
    buffer_load_ushort v13, v3, s[16:19], s20 offen
    s_add_u32 s20, s20, 6912
    buffer_load_ushort v14, v3, s[16:19], s20 offen
    s_add_u32 s20, s20, 6912
    buffer_load_ushort v15, v3, s[16:19], s20 offen
    s_add_u32 s20, s20, 6912
    buffer_load_ushort v16, v3, s[16:19], s20 offen
    s_add_u32 s20, s20, 6912
    buffer_load_ushort v17, v3, s[16:19], s20 offen
    s_add_u32 s20, s20, 6912
    ds_read_b128 v[20:23], v9 offset:32
    ds_read_b128 v[24:27], v9 offset:48
    s_waitcnt vmcnt(0) lgkmcnt(0)
    v_lshlrev_b32 v10, 16, v10
    v_fmac_f32 v30, v10, v20
    v_lshlrev_b32 v11, 16, v11
    v_fmac_f32 v30, v11, v21
    v_lshlrev_b32 v12, 16, v12
    v_fmac_f32 v30, v12, v22
    v_lshlrev_b32 v13, 16, v13
    v_fmac_f32 v30, v13, v23
    v_lshlrev_b32 v14, 16, v14
    v_fmac_f32 v30, v14, v24
    v_lshlrev_b32 v15, 16, v15
    v_fmac_f32 v30, v15, v25
    v_lshlrev_b32 v16, 16, v16
    v_fmac_f32 v30, v16, v26
    v_lshlrev_b32 v17, 16, v17
    v_fmac_f32 v30, v17, v27
    buffer_load_ushort v10, v3, s[16:19], s20 offen
    s_add_u32 s20, s20, 6912
    buffer_load_ushort v11, v3, s[16:19], s20 offen
    s_add_u32 s20, s20, 6912
    buffer_load_ushort v12, v3, s[16:19], s20 offen
    s_add_u32 s20, s20, 6912
    buffer_load_ushort v13, v3, s[16:19], s20 offen
    s_add_u32 s20, s20, 6912
    buffer_load_ushort v14, v3, s[16:19], s20 offen
    s_add_u32 s20, s20, 6912
    buffer_load_ushort v15, v3, s[16:19], s20 offen
    s_add_u32 s20, s20, 6912
    buffer_load_ushort v16, v3, s[16:19], s20 offen
    s_add_u32 s20, s20, 6912
    buffer_load_ushort v17, v3, s[16:19], s20 offen
    s_add_u32 s20, s20, 6912
    ds_read_b128 v[20:23], v9 offset:64
    ds_read_b128 v[24:27], v9 offset:80
    s_waitcnt vmcnt(0) lgkmcnt(0)
    v_lshlrev_b32 v10, 16, v10
    v_fmac_f32 v30, v10, v20
    v_lshlrev_b32 v11, 16, v11
    v_fmac_f32 v30, v11, v21
    v_lshlrev_b32 v12, 16, v12
    v_fmac_f32 v30, v12, v22
    v_lshlrev_b32 v13, 16, v13
    v_fmac_f32 v30, v13, v23
    v_lshlrev_b32 v14, 16, v14
    v_fmac_f32 v30, v14, v24
    v_lshlrev_b32 v15, 16, v15
    v_fmac_f32 v30, v15, v25
    v_lshlrev_b32 v16, 16, v16
    v_fmac_f32 v30, v16, v26
    v_lshlrev_b32 v17, 16, v17
    v_fmac_f32 v30, v17, v27
    buffer_load_ushort v10, v3, s[16:19], s20 offen
    s_add_u32 s20, s20, 6912
    buffer_load_ushort v11, v3, s[16:19], s20 offen
    s_add_u32 s20, s20, 6912
    buffer_load_ushort v12, v3, s[16:19], s20 offen
    s_add_u32 s20, s20, 6912
    buffer_load_ushort v13, v3, s[16:19], s20 offen
    s_add_u32 s20, s20, 6912
    buffer_load_ushort v14, v3, s[16:19], s20 offen
    s_add_u32 s20, s20, 6912
    buffer_load_ushort v15, v3, s[16:19], s20 offen
    s_add_u32 s20, s20, 6912
    buffer_load_ushort v16, v3, s[16:19], s20 offen
    s_add_u32 s20, s20, 6912
    buffer_load_ushort v17, v3, s[16:19], s20 offen
    s_add_u32 s20, s20, 6912
    ds_read_b128 v[20:23], v9 offset:96
    ds_read_b128 v[24:27], v9 offset:112
    s_waitcnt vmcnt(0) lgkmcnt(0)
    v_lshlrev_b32 v10, 16, v10
    v_fmac_f32 v30, v10, v20
    v_lshlrev_b32 v11, 16, v11
    v_fmac_f32 v30, v11, v21
    v_lshlrev_b32 v12, 16, v12
    v_fmac_f32 v30, v12, v22
    v_lshlrev_b32 v13, 16, v13
    v_fmac_f32 v30, v13, v23
    v_lshlrev_b32 v14, 16, v14
    v_fmac_f32 v30, v14, v24
    v_lshlrev_b32 v15, 16, v15
    v_fmac_f32 v30, v15, v25
    v_lshlrev_b32 v16, 16, v16
    v_fmac_f32 v30, v16, v26
    v_lshlrev_b32 v17, 16, v17
    v_fmac_f32 v30, v17, v27
    buffer_load_ushort v10, v3, s[16:19], s20 offen
    s_add_u32 s20, s20, 6912
    buffer_load_ushort v11, v3, s[16:19], s20 offen
    s_add_u32 s20, s20, 6912
    buffer_load_ushort v12, v3, s[16:19], s20 offen
    s_add_u32 s20, s20, 6912
    buffer_load_ushort v13, v3, s[16:19], s20 offen
    s_add_u32 s20, s20, 6912
    buffer_load_ushort v14, v3, s[16:19], s20 offen
    s_add_u32 s20, s20, 6912
    buffer_load_ushort v15, v3, s[16:19], s20 offen
    s_add_u32 s20, s20, 6912
    buffer_load_ushort v16, v3, s[16:19], s20 offen
    s_add_u32 s20, s20, 6912
    buffer_load_ushort v17, v3, s[16:19], s20 offen
    s_add_u32 s20, s20, 6912
    ds_read_b128 v[20:23], v9 offset:128
    ds_read_b128 v[24:27], v9 offset:144
    s_waitcnt vmcnt(0) lgkmcnt(0)
    v_lshlrev_b32 v10, 16, v10
    v_fmac_f32 v30, v10, v20
    v_lshlrev_b32 v11, 16, v11
    v_fmac_f32 v30, v11, v21
    v_lshlrev_b32 v12, 16, v12
    v_fmac_f32 v30, v12, v22
    v_lshlrev_b32 v13, 16, v13
    v_fmac_f32 v30, v13, v23
    v_lshlrev_b32 v14, 16, v14
    v_fmac_f32 v30, v14, v24
    v_lshlrev_b32 v15, 16, v15
    v_fmac_f32 v30, v15, v25
    v_lshlrev_b32 v16, 16, v16
    v_fmac_f32 v30, v16, v26
    v_lshlrev_b32 v17, 16, v17
    v_fmac_f32 v30, v17, v27
    buffer_load_ushort v10, v3, s[16:19], s20 offen
    s_add_u32 s20, s20, 6912
    buffer_load_ushort v11, v3, s[16:19], s20 offen
    s_add_u32 s20, s20, 6912
    buffer_load_ushort v12, v3, s[16:19], s20 offen
    s_add_u32 s20, s20, 6912
    buffer_load_ushort v13, v3, s[16:19], s20 offen
    s_add_u32 s20, s20, 6912
    buffer_load_ushort v14, v3, s[16:19], s20 offen
    s_add_u32 s20, s20, 6912
    buffer_load_ushort v15, v3, s[16:19], s20 offen
    s_add_u32 s20, s20, 6912
    buffer_load_ushort v16, v3, s[16:19], s20 offen
    s_add_u32 s20, s20, 6912
    buffer_load_ushort v17, v3, s[16:19], s20 offen
    s_add_u32 s20, s20, 6912
    ds_read_b128 v[20:23], v9 offset:160
    ds_read_b128 v[24:27], v9 offset:176
    s_waitcnt vmcnt(0) lgkmcnt(0)
    v_lshlrev_b32 v10, 16, v10
    v_fmac_f32 v30, v10, v20
    v_lshlrev_b32 v11, 16, v11
    v_fmac_f32 v30, v11, v21
    v_lshlrev_b32 v12, 16, v12
    v_fmac_f32 v30, v12, v22
    v_lshlrev_b32 v13, 16, v13
    v_fmac_f32 v30, v13, v23
    v_lshlrev_b32 v14, 16, v14
    v_fmac_f32 v30, v14, v24
    v_lshlrev_b32 v15, 16, v15
    v_fmac_f32 v30, v15, v25
    v_lshlrev_b32 v16, 16, v16
    v_fmac_f32 v30, v16, v26
    v_lshlrev_b32 v17, 16, v17
    v_fmac_f32 v30, v17, v27
    buffer_load_ushort v10, v3, s[16:19], s20 offen
    s_add_u32 s20, s20, 6912
    buffer_load_ushort v11, v3, s[16:19], s20 offen
    s_add_u32 s20, s20, 6912
    buffer_load_ushort v12, v3, s[16:19], s20 offen
    s_add_u32 s20, s20, 6912
    buffer_load_ushort v13, v3, s[16:19], s20 offen
    s_add_u32 s20, s20, 6912
    buffer_load_ushort v14, v3, s[16:19], s20 offen
    s_add_u32 s20, s20, 6912
    buffer_load_ushort v15, v3, s[16:19], s20 offen
    s_add_u32 s20, s20, 6912
    buffer_load_ushort v16, v3, s[16:19], s20 offen
    s_add_u32 s20, s20, 6912
    buffer_load_ushort v17, v3, s[16:19], s20 offen
    s_add_u32 s20, s20, 6912
    ds_read_b128 v[20:23], v9 offset:192
    ds_read_b128 v[24:27], v9 offset:208
    s_waitcnt vmcnt(0) lgkmcnt(0)
    v_lshlrev_b32 v10, 16, v10
    v_fmac_f32 v30, v10, v20
    v_lshlrev_b32 v11, 16, v11
    v_fmac_f32 v30, v11, v21
    v_lshlrev_b32 v12, 16, v12
    v_fmac_f32 v30, v12, v22
    v_lshlrev_b32 v13, 16, v13
    v_fmac_f32 v30, v13, v23
    v_lshlrev_b32 v14, 16, v14
    v_fmac_f32 v30, v14, v24
    v_lshlrev_b32 v15, 16, v15
    v_fmac_f32 v30, v15, v25
    v_lshlrev_b32 v16, 16, v16
    v_fmac_f32 v30, v16, v26
    v_lshlrev_b32 v17, 16, v17
    v_fmac_f32 v30, v17, v27
    buffer_load_ushort v10, v3, s[16:19], s20 offen
    s_add_u32 s20, s20, 6912
    buffer_load_ushort v11, v3, s[16:19], s20 offen
    s_add_u32 s20, s20, 6912
    buffer_load_ushort v12, v3, s[16:19], s20 offen
    s_add_u32 s20, s20, 6912
    buffer_load_ushort v13, v3, s[16:19], s20 offen
    s_add_u32 s20, s20, 6912
    buffer_load_ushort v14, v3, s[16:19], s20 offen
    s_add_u32 s20, s20, 6912
    buffer_load_ushort v15, v3, s[16:19], s20 offen
    s_add_u32 s20, s20, 6912
    buffer_load_ushort v16, v3, s[16:19], s20 offen
    s_add_u32 s20, s20, 6912
    buffer_load_ushort v17, v3, s[16:19], s20 offen
    s_add_u32 s20, s20, 6912
    ds_read_b128 v[20:23], v9 offset:224
    ds_read_b128 v[24:27], v9 offset:240
    s_waitcnt vmcnt(0) lgkmcnt(0)
    v_lshlrev_b32 v10, 16, v10
    v_fmac_f32 v30, v10, v20
    v_lshlrev_b32 v11, 16, v11
    v_fmac_f32 v30, v11, v21
    v_lshlrev_b32 v12, 16, v12
    v_fmac_f32 v30, v12, v22
    v_lshlrev_b32 v13, 16, v13
    v_fmac_f32 v30, v13, v23
    v_lshlrev_b32 v14, 16, v14
    v_fmac_f32 v30, v14, v24
    v_lshlrev_b32 v15, 16, v15
    v_fmac_f32 v30, v15, v25
    v_lshlrev_b32 v16, 16, v16
    v_fmac_f32 v30, v16, v26
    v_lshlrev_b32 v17, 16, v17
    v_fmac_f32 v30, v17, v27
    buffer_load_ushort v10, v3, s[16:19], s20 offen
    s_add_u32 s20, s20, 6912
    buffer_load_ushort v11, v3, s[16:19], s20 offen
    s_add_u32 s20, s20, 6912
    buffer_load_ushort v12, v3, s[16:19], s20 offen
    s_add_u32 s20, s20, 6912
    buffer_load_ushort v13, v3, s[16:19], s20 offen
    s_add_u32 s20, s20, 6912
    buffer_load_ushort v14, v3, s[16:19], s20 offen
    s_add_u32 s20, s20, 6912
    buffer_load_ushort v15, v3, s[16:19], s20 offen
    s_add_u32 s20, s20, 6912
    buffer_load_ushort v16, v3, s[16:19], s20 offen
    s_add_u32 s20, s20, 6912
    buffer_load_ushort v17, v3, s[16:19], s20 offen
    s_add_u32 s20, s20, 6912
    ds_read_b128 v[20:23], v9 offset:256
    ds_read_b128 v[24:27], v9 offset:272
    s_waitcnt vmcnt(0) lgkmcnt(0)
    v_lshlrev_b32 v10, 16, v10
    v_fmac_f32 v30, v10, v20
    v_lshlrev_b32 v11, 16, v11
    v_fmac_f32 v30, v11, v21
    v_lshlrev_b32 v12, 16, v12
    v_fmac_f32 v30, v12, v22
    v_lshlrev_b32 v13, 16, v13
    v_fmac_f32 v30, v13, v23
    v_lshlrev_b32 v14, 16, v14
    v_fmac_f32 v30, v14, v24
    v_lshlrev_b32 v15, 16, v15
    v_fmac_f32 v30, v15, v25
    v_lshlrev_b32 v16, 16, v16
    v_fmac_f32 v30, v16, v26
    v_lshlrev_b32 v17, 16, v17
    v_fmac_f32 v30, v17, v27
    buffer_load_ushort v10, v3, s[16:19], s20 offen
    s_add_u32 s20, s20, 6912
    buffer_load_ushort v11, v3, s[16:19], s20 offen
    s_add_u32 s20, s20, 6912
    buffer_load_ushort v12, v3, s[16:19], s20 offen
    s_add_u32 s20, s20, 6912
    buffer_load_ushort v13, v3, s[16:19], s20 offen
    s_add_u32 s20, s20, 6912
    buffer_load_ushort v14, v3, s[16:19], s20 offen
    s_add_u32 s20, s20, 6912
    buffer_load_ushort v15, v3, s[16:19], s20 offen
    s_add_u32 s20, s20, 6912
    buffer_load_ushort v16, v3, s[16:19], s20 offen
    s_add_u32 s20, s20, 6912
    buffer_load_ushort v17, v3, s[16:19], s20 offen
    s_add_u32 s20, s20, 6912
    ds_read_b128 v[20:23], v9 offset:288
    ds_read_b128 v[24:27], v9 offset:304
    s_waitcnt vmcnt(0) lgkmcnt(0)
    v_lshlrev_b32 v10, 16, v10
    v_fmac_f32 v30, v10, v20
    v_lshlrev_b32 v11, 16, v11
    v_fmac_f32 v30, v11, v21
    v_lshlrev_b32 v12, 16, v12
    v_fmac_f32 v30, v12, v22
    v_lshlrev_b32 v13, 16, v13
    v_fmac_f32 v30, v13, v23
    v_lshlrev_b32 v14, 16, v14
    v_fmac_f32 v30, v14, v24
    v_lshlrev_b32 v15, 16, v15
    v_fmac_f32 v30, v15, v25
    v_lshlrev_b32 v16, 16, v16
    v_fmac_f32 v30, v16, v26
    v_lshlrev_b32 v17, 16, v17
    v_fmac_f32 v30, v17, v27
    buffer_load_ushort v10, v3, s[16:19], s20 offen
    s_add_u32 s20, s20, 6912
    buffer_load_ushort v11, v3, s[16:19], s20 offen
    s_add_u32 s20, s20, 6912
    buffer_load_ushort v12, v3, s[16:19], s20 offen
    s_add_u32 s20, s20, 6912
    buffer_load_ushort v13, v3, s[16:19], s20 offen
    s_add_u32 s20, s20, 6912
    buffer_load_ushort v14, v3, s[16:19], s20 offen
    s_add_u32 s20, s20, 6912
    buffer_load_ushort v15, v3, s[16:19], s20 offen
    s_add_u32 s20, s20, 6912
    buffer_load_ushort v16, v3, s[16:19], s20 offen
    s_add_u32 s20, s20, 6912
    buffer_load_ushort v17, v3, s[16:19], s20 offen
    s_add_u32 s20, s20, 6912
    ds_read_b128 v[20:23], v9 offset:320
    ds_read_b128 v[24:27], v9 offset:336
    s_waitcnt vmcnt(0) lgkmcnt(0)
    v_lshlrev_b32 v10, 16, v10
    v_fmac_f32 v30, v10, v20
    v_lshlrev_b32 v11, 16, v11
    v_fmac_f32 v30, v11, v21
    v_lshlrev_b32 v12, 16, v12
    v_fmac_f32 v30, v12, v22
    v_lshlrev_b32 v13, 16, v13
    v_fmac_f32 v30, v13, v23
    v_lshlrev_b32 v14, 16, v14
    v_fmac_f32 v30, v14, v24
    v_lshlrev_b32 v15, 16, v15
    v_fmac_f32 v30, v15, v25
    v_lshlrev_b32 v16, 16, v16
    v_fmac_f32 v30, v16, v26
    v_lshlrev_b32 v17, 16, v17
    v_fmac_f32 v30, v17, v27
    buffer_load_ushort v10, v3, s[16:19], s20 offen
    s_add_u32 s20, s20, 6912
    buffer_load_ushort v11, v3, s[16:19], s20 offen
    s_add_u32 s20, s20, 6912
    buffer_load_ushort v12, v3, s[16:19], s20 offen
    s_add_u32 s20, s20, 6912
    buffer_load_ushort v13, v3, s[16:19], s20 offen
    s_add_u32 s20, s20, 6912
    buffer_load_ushort v14, v3, s[16:19], s20 offen
    s_add_u32 s20, s20, 6912
    buffer_load_ushort v15, v3, s[16:19], s20 offen
    s_add_u32 s20, s20, 6912
    buffer_load_ushort v16, v3, s[16:19], s20 offen
    s_add_u32 s20, s20, 6912
    buffer_load_ushort v17, v3, s[16:19], s20 offen
    s_add_u32 s20, s20, 6912
    ds_read_b128 v[20:23], v9 offset:352
    ds_read_b128 v[24:27], v9 offset:368
    s_waitcnt vmcnt(0) lgkmcnt(0)
    v_lshlrev_b32 v10, 16, v10
    v_fmac_f32 v30, v10, v20
    v_lshlrev_b32 v11, 16, v11
    v_fmac_f32 v30, v11, v21
    v_lshlrev_b32 v12, 16, v12
    v_fmac_f32 v30, v12, v22
    v_lshlrev_b32 v13, 16, v13
    v_fmac_f32 v30, v13, v23
    v_lshlrev_b32 v14, 16, v14
    v_fmac_f32 v30, v14, v24
    v_lshlrev_b32 v15, 16, v15
    v_fmac_f32 v30, v15, v25
    v_lshlrev_b32 v16, 16, v16
    v_fmac_f32 v30, v16, v26
    v_lshlrev_b32 v17, 16, v17
    v_fmac_f32 v30, v17, v27
    buffer_load_ushort v10, v3, s[16:19], s20 offen
    s_add_u32 s20, s20, 6912
    buffer_load_ushort v11, v3, s[16:19], s20 offen
    s_add_u32 s20, s20, 6912
    buffer_load_ushort v12, v3, s[16:19], s20 offen
    s_add_u32 s20, s20, 6912
    buffer_load_ushort v13, v3, s[16:19], s20 offen
    s_add_u32 s20, s20, 6912
    buffer_load_ushort v14, v3, s[16:19], s20 offen
    s_add_u32 s20, s20, 6912
    buffer_load_ushort v15, v3, s[16:19], s20 offen
    s_add_u32 s20, s20, 6912
    buffer_load_ushort v16, v3, s[16:19], s20 offen
    s_add_u32 s20, s20, 6912
    buffer_load_ushort v17, v3, s[16:19], s20 offen
    s_add_u32 s20, s20, 6912
    ds_read_b128 v[20:23], v9 offset:384
    ds_read_b128 v[24:27], v9 offset:400
    s_waitcnt vmcnt(0) lgkmcnt(0)
    v_lshlrev_b32 v10, 16, v10
    v_fmac_f32 v30, v10, v20
    v_lshlrev_b32 v11, 16, v11
    v_fmac_f32 v30, v11, v21
    v_lshlrev_b32 v12, 16, v12
    v_fmac_f32 v30, v12, v22
    v_lshlrev_b32 v13, 16, v13
    v_fmac_f32 v30, v13, v23
    v_lshlrev_b32 v14, 16, v14
    v_fmac_f32 v30, v14, v24
    v_lshlrev_b32 v15, 16, v15
    v_fmac_f32 v30, v15, v25
    v_lshlrev_b32 v16, 16, v16
    v_fmac_f32 v30, v16, v26
    v_lshlrev_b32 v17, 16, v17
    v_fmac_f32 v30, v17, v27
    buffer_load_ushort v10, v3, s[16:19], s20 offen
    s_add_u32 s20, s20, 6912
    buffer_load_ushort v11, v3, s[16:19], s20 offen
    s_add_u32 s20, s20, 6912
    buffer_load_ushort v12, v3, s[16:19], s20 offen
    s_add_u32 s20, s20, 6912
    buffer_load_ushort v13, v3, s[16:19], s20 offen
    s_add_u32 s20, s20, 6912
    buffer_load_ushort v14, v3, s[16:19], s20 offen
    s_add_u32 s20, s20, 6912
    buffer_load_ushort v15, v3, s[16:19], s20 offen
    s_add_u32 s20, s20, 6912
    buffer_load_ushort v16, v3, s[16:19], s20 offen
    s_add_u32 s20, s20, 6912
    buffer_load_ushort v17, v3, s[16:19], s20 offen
    s_add_u32 s20, s20, 6912
    ds_read_b128 v[20:23], v9 offset:416
    ds_read_b128 v[24:27], v9 offset:432
    s_waitcnt vmcnt(0) lgkmcnt(0)
    v_lshlrev_b32 v10, 16, v10
    v_fmac_f32 v30, v10, v20
    v_lshlrev_b32 v11, 16, v11
    v_fmac_f32 v30, v11, v21
    v_lshlrev_b32 v12, 16, v12
    v_fmac_f32 v30, v12, v22
    v_lshlrev_b32 v13, 16, v13
    v_fmac_f32 v30, v13, v23
    v_lshlrev_b32 v14, 16, v14
    v_fmac_f32 v30, v14, v24
    v_lshlrev_b32 v15, 16, v15
    v_fmac_f32 v30, v15, v25
    v_lshlrev_b32 v16, 16, v16
    v_fmac_f32 v30, v16, v26
    v_lshlrev_b32 v17, 16, v17
    v_fmac_f32 v30, v17, v27
    buffer_load_ushort v10, v3, s[16:19], s20 offen
    s_add_u32 s20, s20, 6912
    buffer_load_ushort v11, v3, s[16:19], s20 offen
    s_add_u32 s20, s20, 6912
    buffer_load_ushort v12, v3, s[16:19], s20 offen
    s_add_u32 s20, s20, 6912
    buffer_load_ushort v13, v3, s[16:19], s20 offen
    s_add_u32 s20, s20, 6912
    buffer_load_ushort v14, v3, s[16:19], s20 offen
    s_add_u32 s20, s20, 6912
    buffer_load_ushort v15, v3, s[16:19], s20 offen
    s_add_u32 s20, s20, 6912
    buffer_load_ushort v16, v3, s[16:19], s20 offen
    s_add_u32 s20, s20, 6912
    buffer_load_ushort v17, v3, s[16:19], s20 offen
    s_add_u32 s20, s20, 6912
    ds_read_b128 v[20:23], v9 offset:448
    ds_read_b128 v[24:27], v9 offset:464
    s_waitcnt vmcnt(0) lgkmcnt(0)
    v_lshlrev_b32 v10, 16, v10
    v_fmac_f32 v30, v10, v20
    v_lshlrev_b32 v11, 16, v11
    v_fmac_f32 v30, v11, v21
    v_lshlrev_b32 v12, 16, v12
    v_fmac_f32 v30, v12, v22
    v_lshlrev_b32 v13, 16, v13
    v_fmac_f32 v30, v13, v23
    v_lshlrev_b32 v14, 16, v14
    v_fmac_f32 v30, v14, v24
    v_lshlrev_b32 v15, 16, v15
    v_fmac_f32 v30, v15, v25
    v_lshlrev_b32 v16, 16, v16
    v_fmac_f32 v30, v16, v26
    v_lshlrev_b32 v17, 16, v17
    v_fmac_f32 v30, v17, v27
    buffer_load_ushort v10, v3, s[16:19], s20 offen
    s_add_u32 s20, s20, 6912
    buffer_load_ushort v11, v3, s[16:19], s20 offen
    s_add_u32 s20, s20, 6912
    buffer_load_ushort v12, v3, s[16:19], s20 offen
    s_add_u32 s20, s20, 6912
    buffer_load_ushort v13, v3, s[16:19], s20 offen
    s_add_u32 s20, s20, 6912
    buffer_load_ushort v14, v3, s[16:19], s20 offen
    s_add_u32 s20, s20, 6912
    buffer_load_ushort v15, v3, s[16:19], s20 offen
    s_add_u32 s20, s20, 6912
    buffer_load_ushort v16, v3, s[16:19], s20 offen
    s_add_u32 s20, s20, 6912
    buffer_load_ushort v17, v3, s[16:19], s20 offen
    s_add_u32 s20, s20, 6912
    ds_read_b128 v[20:23], v9 offset:480
    ds_read_b128 v[24:27], v9 offset:496
    s_waitcnt vmcnt(0) lgkmcnt(0)
    v_lshlrev_b32 v10, 16, v10
    v_fmac_f32 v30, v10, v20
    v_lshlrev_b32 v11, 16, v11
    v_fmac_f32 v30, v11, v21
    v_lshlrev_b32 v12, 16, v12
    v_fmac_f32 v30, v12, v22
    v_lshlrev_b32 v13, 16, v13
    v_fmac_f32 v30, v13, v23
    v_lshlrev_b32 v14, 16, v14
    v_fmac_f32 v30, v14, v24
    v_lshlrev_b32 v15, 16, v15
    v_fmac_f32 v30, v15, v25
    v_lshlrev_b32 v16, 16, v16
    v_fmac_f32 v30, v16, v26
    v_lshlrev_b32 v17, 16, v17
    v_fmac_f32 v30, v17, v27
    buffer_load_ushort v10, v3, s[16:19], s20 offen
    s_add_u32 s20, s20, 6912
    buffer_load_ushort v11, v3, s[16:19], s20 offen
    s_add_u32 s20, s20, 6912
    buffer_load_ushort v12, v3, s[16:19], s20 offen
    s_add_u32 s20, s20, 6912
    buffer_load_ushort v13, v3, s[16:19], s20 offen
    s_add_u32 s20, s20, 6912
    buffer_load_ushort v14, v3, s[16:19], s20 offen
    s_add_u32 s20, s20, 6912
    buffer_load_ushort v15, v3, s[16:19], s20 offen
    s_add_u32 s20, s20, 6912
    buffer_load_ushort v16, v3, s[16:19], s20 offen
    s_add_u32 s20, s20, 6912
    buffer_load_ushort v17, v3, s[16:19], s20 offen
    s_add_u32 s20, s20, 6912
    ds_read_b128 v[20:23], v9 offset:512
    ds_read_b128 v[24:27], v9 offset:528
    s_waitcnt vmcnt(0) lgkmcnt(0)
    v_lshlrev_b32 v10, 16, v10
    v_fmac_f32 v30, v10, v20
    v_lshlrev_b32 v11, 16, v11
    v_fmac_f32 v30, v11, v21
    v_lshlrev_b32 v12, 16, v12
    v_fmac_f32 v30, v12, v22
    v_lshlrev_b32 v13, 16, v13
    v_fmac_f32 v30, v13, v23
    v_lshlrev_b32 v14, 16, v14
    v_fmac_f32 v30, v14, v24
    v_lshlrev_b32 v15, 16, v15
    v_fmac_f32 v30, v15, v25
    v_lshlrev_b32 v16, 16, v16
    v_fmac_f32 v30, v16, v26
    v_lshlrev_b32 v17, 16, v17
    v_fmac_f32 v30, v17, v27
    buffer_load_ushort v10, v3, s[16:19], s20 offen
    s_add_u32 s20, s20, 6912
    buffer_load_ushort v11, v3, s[16:19], s20 offen
    s_add_u32 s20, s20, 6912
    buffer_load_ushort v12, v3, s[16:19], s20 offen
    s_add_u32 s20, s20, 6912
    buffer_load_ushort v13, v3, s[16:19], s20 offen
    s_add_u32 s20, s20, 6912
    buffer_load_ushort v14, v3, s[16:19], s20 offen
    s_add_u32 s20, s20, 6912
    buffer_load_ushort v15, v3, s[16:19], s20 offen
    s_add_u32 s20, s20, 6912
    buffer_load_ushort v16, v3, s[16:19], s20 offen
    s_add_u32 s20, s20, 6912
    buffer_load_ushort v17, v3, s[16:19], s20 offen
    s_add_u32 s20, s20, 6912
    ds_read_b128 v[20:23], v9 offset:544
    ds_read_b128 v[24:27], v9 offset:560
    s_waitcnt vmcnt(0) lgkmcnt(0)
    v_lshlrev_b32 v10, 16, v10
    v_fmac_f32 v30, v10, v20
    v_lshlrev_b32 v11, 16, v11
    v_fmac_f32 v30, v11, v21
    v_lshlrev_b32 v12, 16, v12
    v_fmac_f32 v30, v12, v22
    v_lshlrev_b32 v13, 16, v13
    v_fmac_f32 v30, v13, v23
    v_lshlrev_b32 v14, 16, v14
    v_fmac_f32 v30, v14, v24
    v_lshlrev_b32 v15, 16, v15
    v_fmac_f32 v30, v15, v25
    v_lshlrev_b32 v16, 16, v16
    v_fmac_f32 v30, v16, v26
    v_lshlrev_b32 v17, 16, v17
    v_fmac_f32 v30, v17, v27
    v_lshlrev_b32 v8, 2, v0
    ds_write_b32 v8, v30 offset:4096
    s_waitcnt lgkmcnt(0)
    s_barrier
    v_cmp_gt_u32 vcc, 64, v0
    s_and_saveexec_b64 s[22:23], vcc
    s_cbranch_execz k0_end
    ds_read_b32 v10, v8 offset:4096
    ds_read_b32 v11, v8 offset:4352
    ds_read_b32 v12, v8 offset:4608
    ds_read_b32 v13, v8 offset:4864
    s_waitcnt lgkmcnt(0)
    v_add_f32 v10, v10, v11
    v_add_f32 v12, v12, v13
    v_add_f32 v10, v10, v12
    v_cvt_pk_bf16_f32 v10, v10, v10
    v_lshlrev_b32 v10, 16, v10
    v_lshlrev_b32 v3, 2, v2
    global_store_dword v3, v10, s[4:5] offset:0
    s_branch k0_end
k0_zero:
    s_sub_u32 s3, s2, 54
    s_lshl_b32 s3, s3, 16
    s_add_u32 s3, s3, 16384
    s_add_u32 s4, s4, s3
    s_addc_u32 s5, s5, 0
    v_lshlrev_b32 v1, 4, v0
    v_mov_b32 v4, 0
    v_mov_b32 v5, 0
    v_mov_b32 v6, 0
    v_mov_b32 v7, 0
    global_store_dwordx4 v1, v[4:7], s[4:5]
    s_add_u32 s4, s4, 4096
    s_addc_u32 s5, s5, 0
    global_store_dwordx4 v1, v[4:7], s[4:5]
    s_add_u32 s4, s4, 4096
    s_addc_u32 s5, s5, 0
    global_store_dwordx4 v1, v[4:7], s[4:5]
    s_add_u32 s4, s4, 4096
    s_addc_u32 s5, s5, 0
    global_store_dwordx4 v1, v[4:7], s[4:5]
    s_add_u32 s4, s4, 4096
    s_addc_u32 s5, s5, 0
    global_store_dwordx4 v1, v[4:7], s[4:5]
    s_add_u32 s4, s4, 4096
    s_addc_u32 s5, s5, 0
    global_store_dwordx4 v1, v[4:7], s[4:5]
    s_add_u32 s4, s4, 4096
    s_addc_u32 s5, s5, 0
    global_store_dwordx4 v1, v[4:7], s[4:5]
    s_add_u32 s4, s4, 4096
    s_addc_u32 s5, s5, 0
    global_store_dwordx4 v1, v[4:7], s[4:5]
    s_add_u32 s4, s4, 4096
    s_addc_u32 s5, s5, 0
    global_store_dwordx4 v1, v[4:7], s[4:5]
    s_add_u32 s4, s4, 4096
    s_addc_u32 s5, s5, 0
    global_store_dwordx4 v1, v[4:7], s[4:5]
    s_add_u32 s4, s4, 4096
    s_addc_u32 s5, s5, 0
    global_store_dwordx4 v1, v[4:7], s[4:5]
    s_add_u32 s4, s4, 4096
    s_addc_u32 s5, s5, 0
    global_store_dwordx4 v1, v[4:7], s[4:5]
    s_add_u32 s4, s4, 4096
    s_addc_u32 s5, s5, 0
    global_store_dwordx4 v1, v[4:7], s[4:5]
    s_add_u32 s4, s4, 4096
    s_addc_u32 s5, s5, 0
    global_store_dwordx4 v1, v[4:7], s[4:5]
    s_add_u32 s4, s4, 4096
    s_addc_u32 s5, s5, 0
    global_store_dwordx4 v1, v[4:7], s[4:5]
    s_add_u32 s4, s4, 4096
    s_addc_u32 s5, s5, 0
    global_store_dwordx4 v1, v[4:7], s[4:5]
    s_add_u32 s4, s4, 4096
    s_addc_u32 s5, s5, 0
k0_end:
    s_endpgm
.globl ln1_kernel
.p2align 8
.type ln1_kernel,@function
ln1_kernel:
    s_cmp_ge_u32 s2, 512
    s_cbranch_scc1 ln1_kernel_end
    s_load_dwordx2 s[4:5], s[0:1], 120
    s_load_dwordx2 s[6:7], s[0:1], 0
    s_waitcnt lgkmcnt(0)
    s_add_u32 s24, s4, 2375680
    s_addc_u32 s25, s5, 0
    s_add_u32 s26, s4, 0
    s_addc_u32 s27, s5, 0
    s_add_u32 s28, s4, 2304
    s_addc_u32 s29, s5, 0
    v_lshrrev_b32 v1, 6, v0
    s_lshl_b32 s3, s2, 2
    v_add_u32 v1, s3, v1
    v_and_b32 v2, 63, v0
    s_mov_b32 s20, 1152
    v_mul_lo_u32 v3, v1, s20
    v_lshl_add_u32 v3, v2, 1, v3
    v_lshlrev_b32 v4, 2, v2
    global_load_ushort v10, v3, s[6:7] offset:0
    global_load_ushort v11, v3, s[6:7] offset:128
    global_load_ushort v12, v3, s[6:7] offset:256
    global_load_ushort v13, v3, s[6:7] offset:384
    global_load_ushort v14, v3, s[6:7] offset:512
    global_load_ushort v15, v3, s[6:7] offset:640
    global_load_ushort v16, v3, s[6:7] offset:768
    global_load_ushort v17, v3, s[6:7] offset:896
    global_load_ushort v18, v3, s[6:7] offset:1024
    global_load_dword v20, v4, s[26:27] offset:0
    global_load_dword v30, v4, s[28:29] offset:0
    global_load_dword v21, v4, s[26:27] offset:256
    global_load_dword v31, v4, s[28:29] offset:256
    global_load_dword v22, v4, s[26:27] offset:512
    global_load_dword v32, v4, s[28:29] offset:512
    global_load_dword v23, v4, s[26:27] offset:768
    global_load_dword v33, v4, s[28:29] offset:768
    global_load_dword v24, v4, s[26:27] offset:1024
    global_load_dword v34, v4, s[28:29] offset:1024
    global_load_dword v25, v4, s[26:27] offset:1280
    global_load_dword v35, v4, s[28:29] offset:1280
    global_load_dword v26, v4, s[26:27] offset:1536
    global_load_dword v36, v4, s[28:29] offset:1536
    global_load_dword v27, v4, s[26:27] offset:1792
    global_load_dword v37, v4, s[28:29] offset:1792
    global_load_dword v28, v4, s[26:27] offset:2048
    global_load_dword v38, v4, s[28:29] offset:2048
    s_waitcnt vmcnt(18)
    v_mov_b32 v5, 0
    v_lshlrev_b32 v10, 16, v10
    v_add_f32 v5, v5, v10
    v_lshlrev_b32 v11, 16, v11
    v_add_f32 v5, v5, v11
    v_lshlrev_b32 v12, 16, v12
    v_add_f32 v5, v5, v12
    v_lshlrev_b32 v13, 16, v13
    v_add_f32 v5, v5, v13
    v_lshlrev_b32 v14, 16, v14
    v_add_f32 v5, v5, v14
    v_lshlrev_b32 v15, 16, v15
    v_add_f32 v5, v5, v15
    v_lshlrev_b32 v16, 16, v16
    v_add_f32 v5, v5, v16
    v_lshlrev_b32 v17, 16, v17
    v_add_f32 v5, v5, v17
    v_lshlrev_b32 v18, 16, v18
    v_add_f32 v5, v5, v18
    ds_swizzle_b32 v6, v5 offset:0x41f
    s_waitcnt lgkmcnt(0)
    v_add_f32 v5, v5, v6
    ds_swizzle_b32 v6, v5 offset:0x81f
    s_waitcnt lgkmcnt(0)
    v_add_f32 v5, v5, v6
    ds_swizzle_b32 v6, v5 offset:0x101f
    s_waitcnt lgkmcnt(0)
    v_add_f32 v5, v5, v6
    ds_swizzle_b32 v6, v5 offset:0x201f
    s_waitcnt lgkmcnt(0)
    v_add_f32 v5, v5, v6
    ds_swizzle_b32 v6, v5 offset:0x401f
    s_waitcnt lgkmcnt(0)
    v_add_f32 v5, v5, v6
    s_nop 1
    v_readlane_b32 s21, v5, 32
    s_nop 3
    v_add_f32 v5, s21, v5
    s_nop 1
    v_readlane_b32 s21, v5, 0
    s_nop 3
    v_mov_b32 v7, 0x3ae38e39
    v_mul_f32 v5, s21, v7
    v_mov_b32 v8, 0
    v_sub_f32 v6, v10, v5
    v_fmac_f32 v8, v6, v6
    v_sub_f32 v6, v11, v5
    v_fmac_f32 v8, v6, v6
    v_sub_f32 v6, v12, v5
    v_fmac_f32 v8, v6, v6
    v_sub_f32 v6, v13, v5
    v_fmac_f32 v8, v6, v6
    v_sub_f32 v6, v14, v5
    v_fmac_f32 v8, v6, v6
    v_sub_f32 v6, v15, v5
    v_fmac_f32 v8, v6, v6
    v_sub_f32 v6, v16, v5
    v_fmac_f32 v8, v6, v6
    v_sub_f32 v6, v17, v5
    v_fmac_f32 v8, v6, v6
    v_sub_f32 v6, v18, v5
    v_fmac_f32 v8, v6, v6
    ds_swizzle_b32 v6, v8 offset:0x41f
    s_waitcnt lgkmcnt(0)
    v_add_f32 v8, v8, v6
    ds_swizzle_b32 v6, v8 offset:0x81f
    s_waitcnt lgkmcnt(0)
    v_add_f32 v8, v8, v6
    ds_swizzle_b32 v6, v8 offset:0x101f
    s_waitcnt lgkmcnt(0)
    v_add_f32 v8, v8, v6
    ds_swizzle_b32 v6, v8 offset:0x201f
    s_waitcnt lgkmcnt(0)
    v_add_f32 v8, v8, v6
    ds_swizzle_b32 v6, v8 offset:0x401f
    s_waitcnt lgkmcnt(0)
    v_add_f32 v8, v8, v6
    s_nop 1
    v_readlane_b32 s22, v8, 32
    s_nop 3
    v_add_f32 v8, s22, v8
    s_nop 1
    v_readlane_b32 s22, v8, 0
    s_nop 3
    v_mul_f32 v8, s22, v7
    v_cvt_pk_bf16_f32 v5, v5, v5
    v_lshlrev_b32 v5, 16, v5
    v_cvt_pk_bf16_f32 v8, v8, v8
    v_lshlrev_b32 v8, 16, v8
    v_add_f32 v8, 0x3727c5ac, v8
    v_cvt_pk_bf16_f32 v8, v8, v8
    v_lshlrev_b32 v8, 16, v8
    v_sqrt_f32 v8, v8
    s_nop 0
    v_cvt_pk_bf16_f32 v8, v8, v8
    v_lshlrev_b32 v8, 16, v8
    v_rcp_f32 v8, v8
    s_waitcnt vmcnt(0)
    v_sub_f32 v6, v10, v5
    v_cvt_pk_bf16_f32 v6, v6, v6
    v_lshlrev_b32 v6, 16, v6
    v_mul_f32 v6, v6, v8
    v_cvt_pk_bf16_f32 v6, v6, v6
    v_lshlrev_b32 v6, 16, v6
    v_add_f32 v9, 1.0, v30
    v_cvt_pk_bf16_f32 v9, v9, v9
    v_lshlrev_b32 v9, 16, v9
    v_mul_f32 v6, v6, v9
    v_cvt_pk_bf16_f32 v6, v6, v6
    v_lshlrev_b32 v6, 16, v6
    v_add_f32 v6, v6, v20
    v_cvt_pk_bf16_f32 v6, v6, v6
    global_store_short v3, v6, s[24:25] offset:0
    v_sub_f32 v6, v11, v5
    v_cvt_pk_bf16_f32 v6, v6, v6
    v_lshlrev_b32 v6, 16, v6
    v_mul_f32 v6, v6, v8
    v_cvt_pk_bf16_f32 v6, v6, v6
    v_lshlrev_b32 v6, 16, v6
    v_add_f32 v9, 1.0, v31
    v_cvt_pk_bf16_f32 v9, v9, v9
    v_lshlrev_b32 v9, 16, v9
    v_mul_f32 v6, v6, v9
    v_cvt_pk_bf16_f32 v6, v6, v6
    v_lshlrev_b32 v6, 16, v6
    v_add_f32 v6, v6, v21
    v_cvt_pk_bf16_f32 v6, v6, v6
    global_store_short v3, v6, s[24:25] offset:128
    v_sub_f32 v6, v12, v5
    v_cvt_pk_bf16_f32 v6, v6, v6
    v_lshlrev_b32 v6, 16, v6
    v_mul_f32 v6, v6, v8
    v_cvt_pk_bf16_f32 v6, v6, v6
    v_lshlrev_b32 v6, 16, v6
    v_add_f32 v9, 1.0, v32
    v_cvt_pk_bf16_f32 v9, v9, v9
    v_lshlrev_b32 v9, 16, v9
    v_mul_f32 v6, v6, v9
    v_cvt_pk_bf16_f32 v6, v6, v6
    v_lshlrev_b32 v6, 16, v6
    v_add_f32 v6, v6, v22
    v_cvt_pk_bf16_f32 v6, v6, v6
    global_store_short v3, v6, s[24:25] offset:256
    v_sub_f32 v6, v13, v5
    v_cvt_pk_bf16_f32 v6, v6, v6
    v_lshlrev_b32 v6, 16, v6
    v_mul_f32 v6, v6, v8
    v_cvt_pk_bf16_f32 v6, v6, v6
    v_lshlrev_b32 v6, 16, v6
    v_add_f32 v9, 1.0, v33
    v_cvt_pk_bf16_f32 v9, v9, v9
    v_lshlrev_b32 v9, 16, v9
    v_mul_f32 v6, v6, v9
    v_cvt_pk_bf16_f32 v6, v6, v6
    v_lshlrev_b32 v6, 16, v6
    v_add_f32 v6, v6, v23
    v_cvt_pk_bf16_f32 v6, v6, v6
    global_store_short v3, v6, s[24:25] offset:384
    v_sub_f32 v6, v14, v5
    v_cvt_pk_bf16_f32 v6, v6, v6
    v_lshlrev_b32 v6, 16, v6
    v_mul_f32 v6, v6, v8
    v_cvt_pk_bf16_f32 v6, v6, v6
    v_lshlrev_b32 v6, 16, v6
    v_add_f32 v9, 1.0, v34
    v_cvt_pk_bf16_f32 v9, v9, v9
    v_lshlrev_b32 v9, 16, v9
    v_mul_f32 v6, v6, v9
    v_cvt_pk_bf16_f32 v6, v6, v6
    v_lshlrev_b32 v6, 16, v6
    v_add_f32 v6, v6, v24
    v_cvt_pk_bf16_f32 v6, v6, v6
    global_store_short v3, v6, s[24:25] offset:512
    v_sub_f32 v6, v15, v5
    v_cvt_pk_bf16_f32 v6, v6, v6
    v_lshlrev_b32 v6, 16, v6
    v_mul_f32 v6, v6, v8
    v_cvt_pk_bf16_f32 v6, v6, v6
    v_lshlrev_b32 v6, 16, v6
    v_add_f32 v9, 1.0, v35
    v_cvt_pk_bf16_f32 v9, v9, v9
    v_lshlrev_b32 v9, 16, v9
    v_mul_f32 v6, v6, v9
    v_cvt_pk_bf16_f32 v6, v6, v6
    v_lshlrev_b32 v6, 16, v6
    v_add_f32 v6, v6, v25
    v_cvt_pk_bf16_f32 v6, v6, v6
    global_store_short v3, v6, s[24:25] offset:640
    v_sub_f32 v6, v16, v5
    v_cvt_pk_bf16_f32 v6, v6, v6
    v_lshlrev_b32 v6, 16, v6
    v_mul_f32 v6, v6, v8
    v_cvt_pk_bf16_f32 v6, v6, v6
    v_lshlrev_b32 v6, 16, v6
    v_add_f32 v9, 1.0, v36
    v_cvt_pk_bf16_f32 v9, v9, v9
    v_lshlrev_b32 v9, 16, v9
    v_mul_f32 v6, v6, v9
    v_cvt_pk_bf16_f32 v6, v6, v6
    v_lshlrev_b32 v6, 16, v6
    v_add_f32 v6, v6, v26
    v_cvt_pk_bf16_f32 v6, v6, v6
    global_store_short v3, v6, s[24:25] offset:768
    v_sub_f32 v6, v17, v5
    v_cvt_pk_bf16_f32 v6, v6, v6
    v_lshlrev_b32 v6, 16, v6
    v_mul_f32 v6, v6, v8
    v_cvt_pk_bf16_f32 v6, v6, v6
    v_lshlrev_b32 v6, 16, v6
    v_add_f32 v9, 1.0, v37
    v_cvt_pk_bf16_f32 v9, v9, v9
    v_lshlrev_b32 v9, 16, v9
    v_mul_f32 v6, v6, v9
    v_cvt_pk_bf16_f32 v6, v6, v6
    v_lshlrev_b32 v6, 16, v6
    v_add_f32 v6, v6, v27
    v_cvt_pk_bf16_f32 v6, v6, v6
    global_store_short v3, v6, s[24:25] offset:896
    v_sub_f32 v6, v18, v5
    v_cvt_pk_bf16_f32 v6, v6, v6
    v_lshlrev_b32 v6, 16, v6
    v_mul_f32 v6, v6, v8
    v_cvt_pk_bf16_f32 v6, v6, v6
    v_lshlrev_b32 v6, 16, v6
    v_add_f32 v9, 1.0, v38
    v_cvt_pk_bf16_f32 v9, v9, v9
    v_lshlrev_b32 v9, 16, v9
    v_mul_f32 v6, v6, v9
    v_cvt_pk_bf16_f32 v6, v6, v6
    v_lshlrev_b32 v6, 16, v6
    v_add_f32 v6, v6, v28
    v_cvt_pk_bf16_f32 v6, v6, v6
    global_store_short v3, v6, s[24:25] offset:1024
ln1_kernel_end:
    s_endpgm
.globl qkv_kernel
.p2align 8
.type qkv_kernel,@function
qkv_kernel:
    s_cmp_ge_u32 s2, 1536
    s_cbranch_scc1 qkv_kernel_end
    s_load_dwordx2 s[4:5], s[0:1], 120
    s_load_dwordx2 s[6:7], s[0:1], 120
    s_load_dwordx2 s[8:9], s[0:1], 16
    s_load_dwordx2 s[10:11], s[0:1], 24
    s_load_dwordx2 s[14:15], s[0:1], 32
    s_and_b32 s16, s2, 15
    s_lshr_b32 s17, s2, 4
    s_waitcnt lgkmcnt(0)
    s_add_u32 s6, s6, 2375680
    s_addc_u32 s7, s7, 0
    s_mul_i32 s18, s16, 147456
    s_add_u32 s6, s6, s18
    s_addc_u32 s7, s7, 0
    s_lshr_b32 s18, s17, 5
    s_cmp_eq_u32 s18, 1
    s_cselect_b32 s8, s10, s8
    s_cselect_b32 s9, s11, s9
    s_cmp_eq_u32 s18, 2
    s_cselect_b32 s8, s14, s8
    s_cselect_b32 s9, s15, s9
    s_and_b32 s19, s17, 31
    s_lshl_b32 s19, s19, 8
    s_add_u32 s8, s8, s19
    s_addc_u32 s9, s9, 0
    v_lshrrev_b32 v1, 6, v0
    v_and_b32 v2, 63, v0
    s_nop 0
    v_readfirstlane_b32 s12, v1
    s_nop 3
    s_lshl_b32 s13, s12, 12
    v_lshrrev_b32 v3, 3, v2
    v_lshrrev_b32 v4, 4, v2
    v_and_b32 v5, 7, v2
    v_lshlrev_b32 v6, 5, v1
    s_mov_b32 s20, 1152
    v_add_u32 v7, 0, v4
    v_and_b32 v7, 7, v7
    v_xor_b32 v7, v5, v7
    v_add_u32 v8, 0, v3
    v_add_u32 v8, v8, v6
    v_mul_lo_u32 v8, v8, s20
    v_lshl_add_u32 v8, v7, 4, v8
    v_add_u32 v7, 4, v4
    v_and_b32 v7, 7, v7
    v_xor_b32 v7, v5, v7
    v_add_u32 v9, 8, v3
    v_add_u32 v9, v9, v6
    v_mul_lo_u32 v9, v9, s20
    v_lshl_add_u32 v9, v7, 4, v9
    v_add_u32 v7, 8, v4
    v_and_b32 v7, 7, v7
    v_xor_b32 v7, v5, v7
    v_add_u32 v10, 16, v3
    v_add_u32 v10, v10, v6
    v_mul_lo_u32 v10, v10, s20
    v_lshl_add_u32 v10, v7, 4, v10
    v_add_u32 v7, 12, v4
    v_and_b32 v7, 7, v7
    v_xor_b32 v7, v5, v7
    v_add_u32 v11, 24, v3
    v_add_u32 v11, v11, v6
    v_mul_lo_u32 v11, v11, s20
    v_lshl_add_u32 v11, v7, 4, v11
    v_and_b32 v5, 15, v2
    v_lshrrev_b32 v7, 2, v5
    v_xor_b32 v7, v7, v4
    v_and_b32 v5, 3, v5
    v_lshl_add_u32 v7, v7, 2, v5
    v_lshlrev_b32 v6, 4, v1
    s_mov_b32 s20, 8192
    v_add_u32 v3, 0, v4
    v_add_u32 v3, v3, v6
    v_mul_lo_u32 v3, v3, s20
    v_lshl_add_u32 v3, v7, 4, v3
    v_mov_b32 v21, s9
    v_add_co_u32 v12, vcc, s8, v3
    v_addc_co_u32 v13, vcc, 0, v21, vcc
    v_add_u32 v3, 4, v4
    v_add_u32 v3, v3, v6
    v_mul_lo_u32 v3, v3, s20
    v_lshl_add_u32 v3, v7, 4, v3
    v_mov_b32 v21, s9
    v_add_co_u32 v14, vcc, s8, v3
    v_addc_co_u32 v15, vcc, 0, v21, vcc
    v_add_u32 v3, 8, v4
    v_add_u32 v3, v3, v6
    v_mul_lo_u32 v3, v3, s20
    v_lshl_add_u32 v3, v7, 4, v3
    v_mov_b32 v21, s9
    v_add_co_u32 v16, vcc, s8, v3
    v_addc_co_u32 v17, vcc, 0, v21, vcc
    v_add_u32 v3, 12, v4
    v_add_u32 v3, v3, v6
    v_mul_lo_u32 v3, v3, s20
    v_lshl_add_u32 v3, v7, 4, v3
    v_mov_b32 v21, s9
    v_add_co_u32 v18, vcc, s8, v3
    v_addc_co_u32 v19, vcc, 0, v21, vcc
    v_and_b32 v3, 31, v2
    v_lshrrev_b32 v4, 5, v2
    v_and_b32 v5, 1, v1
    v_lshl_add_u32 v6, v5, 6, v3
    v_lshrrev_b32 v7, 1, v3
    v_and_b32 v7, 7, v7
    v_add_u32 v26, 0, v4
    v_xor_b32 v26, v26, v7
    v_lshlrev_b32 v26, 4, v26
    v_lshl_add_u32 v20, v6, 7, v26
    v_add_u32 v26, 2, v4
    v_xor_b32 v26, v26, v7
    v_lshlrev_b32 v26, 4, v26
    v_lshl_add_u32 v21, v6, 7, v26
    v_add_u32 v26, 4, v4
    v_xor_b32 v26, v26, v7
    v_lshlrev_b32 v26, 4, v26
    v_lshl_add_u32 v22, v6, 7, v26
    v_add_u32 v26, 6, v4
    v_xor_b32 v26, v26, v7
    v_lshlrev_b32 v26, 4, v26
    v_lshl_add_u32 v23, v6, 7, v26
    v_lshrrev_b32 v5, 1, v1
    v_and_b32 v6, 15, v2
    v_lshrrev_b32 v7, 2, v6
    v_lshl_add_u32 v26, v4, 3, v7
    v_lshrrev_b32 v27, 4, v2
    v_and_b32 v27, 1, v27
    v_and_b32 v28, 3, v2
    v_lshlrev_b32 v28, 3, v28
    v_lshl_add_u32 v28, v27, 5, v28
    v_lshl_add_u32 v29, v5, 1, 0
    v_xor_b32 v29, v29, v7
    v_lshl_add_u32 v29, v29, 6, v28
    v_lshl_add_u32 v24, v26, 8, v29
    v_add_u32 v24, 16384, v24
    v_lshl_add_u32 v29, v5, 1, 1
    v_xor_b32 v29, v29, v7
    v_lshl_add_u32 v29, v29, 6, v28
    v_lshl_add_u32 v25, v26, 8, v29
    v_add_u32 v25, 16384, v25
    v_mov_b32 v64, 0
    v_mov_b32 v65, 0
    v_mov_b32 v66, 0
    v_mov_b32 v67, 0
    v_mov_b32 v68, 0
    v_mov_b32 v69, 0
    v_mov_b32 v70, 0
    v_mov_b32 v71, 0
    v_mov_b32 v72, 0
    v_mov_b32 v73, 0
    v_mov_b32 v74, 0
    v_mov_b32 v75, 0
    v_mov_b32 v76, 0
    v_mov_b32 v77, 0
    v_mov_b32 v78, 0
    v_mov_b32 v79, 0
    v_mov_b32 v80, 0
    v_mov_b32 v81, 0
    v_mov_b32 v82, 0
    v_mov_b32 v83, 0
    v_mov_b32 v84, 0
    v_mov_b32 v85, 0
    v_mov_b32 v86, 0
    v_mov_b32 v87, 0
    v_mov_b32 v88, 0
    v_mov_b32 v89, 0
    v_mov_b32 v90, 0
    v_mov_b32 v91, 0
    v_mov_b32 v92, 0
    v_mov_b32 v93, 0
    v_mov_b32 v94, 0
    v_mov_b32 v95, 0
    v_mov_b32 v96, 0
    v_mov_b32 v97, 0
    v_mov_b32 v98, 0
    v_mov_b32 v99, 0
    v_mov_b32 v100, 0
    v_mov_b32 v101, 0
    v_mov_b32 v102, 0
    v_mov_b32 v103, 0
    v_mov_b32 v104, 0
    v_mov_b32 v105, 0
    v_mov_b32 v106, 0
    v_mov_b32 v107, 0
    v_mov_b32 v108, 0
    v_mov_b32 v109, 0
    v_mov_b32 v110, 0
    v_mov_b32 v111, 0
    v_mov_b32 v112, 0
    v_mov_b32 v113, 0
    v_mov_b32 v114, 0
    v_mov_b32 v115, 0
    v_mov_b32 v116, 0
    v_mov_b32 v117, 0
    v_mov_b32 v118, 0
    v_mov_b32 v119, 0
    v_mov_b32 v120, 0
    v_mov_b32 v121, 0
    v_mov_b32 v122, 0
    v_mov_b32 v123, 0
    v_mov_b32 v124, 0
    v_mov_b32 v125, 0
    v_mov_b32 v126, 0
    v_mov_b32 v127, 0
    s_add_u32 m0, s13, 0
    s_nop 0
    global_load_lds_dwordx4 v8, s[6:7]
    s_add_u32 m0, s13, 1024
    s_nop 0
    global_load_lds_dwordx4 v9, s[6:7]
    s_add_u32 m0, s13, 2048
    s_nop 0
    global_load_lds_dwordx4 v10, s[6:7]
    s_add_u32 m0, s13, 3072
    s_nop 0
    global_load_lds_dwordx4 v11, s[6:7]
    s_add_u32 m0, s13, 16384
    s_nop 0
    global_load_lds_dwordx4 v[12:13], off
    s_add_u32 m0, s13, 17408
    s_nop 0
    global_load_lds_dwordx4 v[14:15], off
    s_add_u32 m0, s13, 18432
    s_nop 0
    global_load_lds_dwordx4 v[16:17], off
    s_add_u32 m0, s13, 19456
    s_nop 0
    global_load_lds_dwordx4 v[18:19], off
    s_add_u32 s6, s6, 128
    s_addc_u32 s7, s7, 0
    v_add_co_u32 v12, vcc, 524288, v12
    v_addc_co_u32 v13, vcc, 0, v13, vcc
    v_add_co_u32 v14, vcc, 524288, v14
    v_addc_co_u32 v15, vcc, 0, v15, vcc
    v_add_co_u32 v16, vcc, 524288, v16
    v_addc_co_u32 v17, vcc, 0, v17, vcc
    v_add_co_u32 v18, vcc, 524288, v18
    v_addc_co_u32 v19, vcc, 0, v19, vcc
    s_cmp_ge_u32 s17, 64
    s_cbranch_scc1 qkv_kernel_vpath
    s_add_u32 m0, s13, 32768
    s_nop 0
    global_load_lds_dwordx4 v8, s[6:7]
    s_add_u32 m0, s13, 33792
    s_nop 0
    global_load_lds_dwordx4 v9, s[6:7]
    s_add_u32 m0, s13, 34816
    s_nop 0
    global_load_lds_dwordx4 v10, s[6:7]
    s_add_u32 m0, s13, 35840
    s_nop 0
    global_load_lds_dwordx4 v11, s[6:7]
    s_add_u32 m0, s13, 49152
    s_nop 0
    global_load_lds_dwordx4 v[12:13], off
    s_add_u32 m0, s13, 50176
    s_nop 0
    global_load_lds_dwordx4 v[14:15], off
    s_add_u32 m0, s13, 51200
    s_nop 0
    global_load_lds_dwordx4 v[16:17], off
    s_add_u32 m0, s13, 52224
    s_nop 0
    global_load_lds_dwordx4 v[18:19], off
    s_add_u32 s6, s6, 128
    s_addc_u32 s7, s7, 0
    v_add_co_u32 v12, vcc, 524288, v12
    v_addc_co_u32 v13, vcc, 0, v13, vcc
    v_add_co_u32 v14, vcc, 524288, v14
    v_addc_co_u32 v15, vcc, 0, v15, vcc
    v_add_co_u32 v16, vcc, 524288, v16
    v_addc_co_u32 v17, vcc, 0, v17, vcc
    v_add_co_u32 v18, vcc, 524288, v18
    v_addc_co_u32 v19, vcc, 0, v19, vcc
    s_waitcnt vmcnt(8)
    s_barrier
    ds_read_b128 v[32:35], v20 offset:0
    ds_read_b128 v[36:39], v20 offset:4096
    ds_read_b64_tr_b16 v[40:41], v24 offset:0
    ds_read_b64_tr_b16 v[42:43], v24 offset:1024
    ds_read_b64_tr_b16 v[44:45], v25 offset:0
    ds_read_b64_tr_b16 v[46:47], v25 offset:1024
    ds_read_b128 v[48:51], v21 offset:0
    ds_read_b128 v[52:55], v21 offset:4096
    ds_read_b64_tr_b16 v[56:57], v24 offset:4096
    ds_read_b64_tr_b16 v[58:59], v24 offset:5120
    ds_read_b64_tr_b16 v[60:61], v25 offset:4096
    ds_read_b64_tr_b16 v[62:63], v25 offset:5120
    s_waitcnt lgkmcnt(6)
    v_mfma_f32_32x32x16_bf16 v[64:79], v[40:43], v[32:35], v[64:79]
    v_mfma_f32_32x32x16_bf16 v[80:95], v[44:47], v[32:35], v[80:95]
    v_mfma_f32_32x32x16_bf16 v[96:111], v[40:43], v[36:39], v[96:111]
    v_mfma_f32_32x32x16_bf16 v[112:127], v[44:47], v[36:39], v[112:127]
    ds_read_b128 v[32:35], v22 offset:0
    ds_read_b128 v[36:39], v22 offset:4096
    ds_read_b64_tr_b16 v[40:41], v24 offset:8192
    ds_read_b64_tr_b16 v[42:43], v24 offset:9216
    ds_read_b64_tr_b16 v[44:45], v25 offset:8192
    ds_read_b64_tr_b16 v[46:47], v25 offset:9216
    s_waitcnt lgkmcnt(6)
    v_mfma_f32_32x32x16_bf16 v[64:79], v[56:59], v[48:51], v[64:79]
    v_mfma_f32_32x32x16_bf16 v[80:95], v[60:63], v[48:51], v[80:95]
    v_mfma_f32_32x32x16_bf16 v[96:111], v[56:59], v[52:55], v[96:111]
    v_mfma_f32_32x32x16_bf16 v[112:127], v[60:63], v[52:55], v[112:127]
    ds_read_b128 v[48:51], v23 offset:0
    ds_read_b128 v[52:55], v23 offset:4096
    ds_read_b64_tr_b16 v[56:57], v24 offset:12288
    ds_read_b64_tr_b16 v[58:59], v24 offset:13312
    ds_read_b64_tr_b16 v[60:61], v25 offset:12288
    ds_read_b64_tr_b16 v[62:63], v25 offset:13312
    s_waitcnt lgkmcnt(6)
    v_mfma_f32_32x32x16_bf16 v[64:79], v[40:43], v[32:35], v[64:79]
    v_mfma_f32_32x32x16_bf16 v[80:95], v[44:47], v[32:35], v[80:95]
    v_mfma_f32_32x32x16_bf16 v[96:111], v[40:43], v[36:39], v[96:111]
    v_mfma_f32_32x32x16_bf16 v[112:127], v[44:47], v[36:39], v[112:127]
    s_waitcnt lgkmcnt(0)
    v_mfma_f32_32x32x16_bf16 v[64:79], v[56:59], v[48:51], v[64:79]
    v_mfma_f32_32x32x16_bf16 v[80:95], v[60:63], v[48:51], v[80:95]
    v_mfma_f32_32x32x16_bf16 v[96:111], v[56:59], v[52:55], v[96:111]
    v_mfma_f32_32x32x16_bf16 v[112:127], v[60:63], v[52:55], v[112:127]
    s_barrier
    s_add_u32 m0, s13, 0
    s_nop 0
    global_load_lds_dwordx4 v8, s[6:7]
    s_add_u32 m0, s13, 1024
    s_nop 0
    global_load_lds_dwordx4 v9, s[6:7]
    s_add_u32 m0, s13, 2048
    s_nop 0
    global_load_lds_dwordx4 v10, s[6:7]
    s_add_u32 m0, s13, 3072
    s_nop 0
    global_load_lds_dwordx4 v11, s[6:7]
    s_add_u32 m0, s13, 16384
    s_nop 0
    global_load_lds_dwordx4 v[12:13], off
    s_add_u32 m0, s13, 17408
    s_nop 0
    global_load_lds_dwordx4 v[14:15], off
    s_add_u32 m0, s13, 18432
    s_nop 0
    global_load_lds_dwordx4 v[16:17], off
    s_add_u32 m0, s13, 19456
    s_nop 0
    global_load_lds_dwordx4 v[18:19], off
    s_add_u32 s6, s6, 128
    s_addc_u32 s7, s7, 0
    v_add_co_u32 v12, vcc, 524288, v12
    v_addc_co_u32 v13, vcc, 0, v13, vcc
    v_add_co_u32 v14, vcc, 524288, v14
    v_addc_co_u32 v15, vcc, 0, v15, vcc
    v_add_co_u32 v16, vcc, 524288, v16
    v_addc_co_u32 v17, vcc, 0, v17, vcc
    v_add_co_u32 v18, vcc, 524288, v18
    v_addc_co_u32 v19, vcc, 0, v19, vcc
    s_waitcnt vmcnt(8)
    s_barrier
    ds_read_b128 v[32:35], v20 offset:32768
    ds_read_b128 v[36:39], v20 offset:36864
    ds_read_b64_tr_b16 v[40:41], v24 offset:32768
    ds_read_b64_tr_b16 v[42:43], v24 offset:33792
    ds_read_b64_tr_b16 v[44:45], v25 offset:32768
    ds_read_b64_tr_b16 v[46:47], v25 offset:33792
    ds_read_b128 v[48:51], v21 offset:32768
    ds_read_b128 v[52:55], v21 offset:36864
    ds_read_b64_tr_b16 v[56:57], v24 offset:36864
    ds_read_b64_tr_b16 v[58:59], v24 offset:37888
    ds_read_b64_tr_b16 v[60:61], v25 offset:36864
    ds_read_b64_tr_b16 v[62:63], v25 offset:37888
    s_waitcnt lgkmcnt(6)
    v_mfma_f32_32x32x16_bf16 v[64:79], v[40:43], v[32:35], v[64:79]
    v_mfma_f32_32x32x16_bf16 v[80:95], v[44:47], v[32:35], v[80:95]
    v_mfma_f32_32x32x16_bf16 v[96:111], v[40:43], v[36:39], v[96:111]
    v_mfma_f32_32x32x16_bf16 v[112:127], v[44:47], v[36:39], v[112:127]
    ds_read_b128 v[32:35], v22 offset:32768
    ds_read_b128 v[36:39], v22 offset:36864
    ds_read_b64_tr_b16 v[40:41], v24 offset:40960
    ds_read_b64_tr_b16 v[42:43], v24 offset:41984
    ds_read_b64_tr_b16 v[44:45], v25 offset:40960
    ds_read_b64_tr_b16 v[46:47], v25 offset:41984
    s_waitcnt lgkmcnt(6)
    v_mfma_f32_32x32x16_bf16 v[64:79], v[56:59], v[48:51], v[64:79]
    v_mfma_f32_32x32x16_bf16 v[80:95], v[60:63], v[48:51], v[80:95]
    v_mfma_f32_32x32x16_bf16 v[96:111], v[56:59], v[52:55], v[96:111]
    v_mfma_f32_32x32x16_bf16 v[112:127], v[60:63], v[52:55], v[112:127]
    ds_read_b128 v[48:51], v23 offset:32768
    ds_read_b128 v[52:55], v23 offset:36864
    ds_read_b64_tr_b16 v[56:57], v24 offset:45056
    ds_read_b64_tr_b16 v[58:59], v24 offset:46080
    ds_read_b64_tr_b16 v[60:61], v25 offset:45056
    ds_read_b64_tr_b16 v[62:63], v25 offset:46080
    s_waitcnt lgkmcnt(6)
    v_mfma_f32_32x32x16_bf16 v[64:79], v[40:43], v[32:35], v[64:79]
    v_mfma_f32_32x32x16_bf16 v[80:95], v[44:47], v[32:35], v[80:95]
    v_mfma_f32_32x32x16_bf16 v[96:111], v[40:43], v[36:39], v[96:111]
    v_mfma_f32_32x32x16_bf16 v[112:127], v[44:47], v[36:39], v[112:127]
    s_waitcnt lgkmcnt(0)
    v_mfma_f32_32x32x16_bf16 v[64:79], v[56:59], v[48:51], v[64:79]
    v_mfma_f32_32x32x16_bf16 v[80:95], v[60:63], v[48:51], v[80:95]
    v_mfma_f32_32x32x16_bf16 v[96:111], v[56:59], v[52:55], v[96:111]
    v_mfma_f32_32x32x16_bf16 v[112:127], v[60:63], v[52:55], v[112:127]
    s_barrier
    s_add_u32 m0, s13, 32768
    s_nop 0
    global_load_lds_dwordx4 v8, s[6:7]
    s_add_u32 m0, s13, 33792
    s_nop 0
    global_load_lds_dwordx4 v9, s[6:7]
    s_add_u32 m0, s13, 34816
    s_nop 0
    global_load_lds_dwordx4 v10, s[6:7]
    s_add_u32 m0, s13, 35840
    s_nop 0
    global_load_lds_dwordx4 v11, s[6:7]
    s_add_u32 m0, s13, 49152
    s_nop 0
    global_load_lds_dwordx4 v[12:13], off
    s_add_u32 m0, s13, 50176
    s_nop 0
    global_load_lds_dwordx4 v[14:15], off
    s_add_u32 m0, s13, 51200
    s_nop 0
    global_load_lds_dwordx4 v[16:17], off
    s_add_u32 m0, s13, 52224
    s_nop 0
    global_load_lds_dwordx4 v[18:19], off
    s_add_u32 s6, s6, 128
    s_addc_u32 s7, s7, 0
    v_add_co_u32 v12, vcc, 524288, v12
    v_addc_co_u32 v13, vcc, 0, v13, vcc
    v_add_co_u32 v14, vcc, 524288, v14
    v_addc_co_u32 v15, vcc, 0, v15, vcc
    v_add_co_u32 v16, vcc, 524288, v16
    v_addc_co_u32 v17, vcc, 0, v17, vcc
    v_add_co_u32 v18, vcc, 524288, v18
    v_addc_co_u32 v19, vcc, 0, v19, vcc
    s_waitcnt vmcnt(8)
    s_barrier
    ds_read_b128 v[32:35], v20 offset:0
    ds_read_b128 v[36:39], v20 offset:4096
    ds_read_b64_tr_b16 v[40:41], v24 offset:0
    ds_read_b64_tr_b16 v[42:43], v24 offset:1024
    ds_read_b64_tr_b16 v[44:45], v25 offset:0
    ds_read_b64_tr_b16 v[46:47], v25 offset:1024
    ds_read_b128 v[48:51], v21 offset:0
    ds_read_b128 v[52:55], v21 offset:4096
    ds_read_b64_tr_b16 v[56:57], v24 offset:4096
    ds_read_b64_tr_b16 v[58:59], v24 offset:5120
    ds_read_b64_tr_b16 v[60:61], v25 offset:4096
    ds_read_b64_tr_b16 v[62:63], v25 offset:5120
    s_waitcnt lgkmcnt(6)
    v_mfma_f32_32x32x16_bf16 v[64:79], v[40:43], v[32:35], v[64:79]
    v_mfma_f32_32x32x16_bf16 v[80:95], v[44:47], v[32:35], v[80:95]
    v_mfma_f32_32x32x16_bf16 v[96:111], v[40:43], v[36:39], v[96:111]
    v_mfma_f32_32x32x16_bf16 v[112:127], v[44:47], v[36:39], v[112:127]
    ds_read_b128 v[32:35], v22 offset:0
    ds_read_b128 v[36:39], v22 offset:4096
    ds_read_b64_tr_b16 v[40:41], v24 offset:8192
    ds_read_b64_tr_b16 v[42:43], v24 offset:9216
    ds_read_b64_tr_b16 v[44:45], v25 offset:8192
    ds_read_b64_tr_b16 v[46:47], v25 offset:9216
    s_waitcnt lgkmcnt(6)
    v_mfma_f32_32x32x16_bf16 v[64:79], v[56:59], v[48:51], v[64:79]
    v_mfma_f32_32x32x16_bf16 v[80:95], v[60:63], v[48:51], v[80:95]
    v_mfma_f32_32x32x16_bf16 v[96:111], v[56:59], v[52:55], v[96:111]
    v_mfma_f32_32x32x16_bf16 v[112:127], v[60:63], v[52:55], v[112:127]
    ds_read_b128 v[48:51], v23 offset:0
    ds_read_b128 v[52:55], v23 offset:4096
    ds_read_b64_tr_b16 v[56:57], v24 offset:12288
    ds_read_b64_tr_b16 v[58:59], v24 offset:13312
    ds_read_b64_tr_b16 v[60:61], v25 offset:12288
    ds_read_b64_tr_b16 v[62:63], v25 offset:13312
    s_waitcnt lgkmcnt(6)
    v_mfma_f32_32x32x16_bf16 v[64:79], v[40:43], v[32:35], v[64:79]
    v_mfma_f32_32x32x16_bf16 v[80:95], v[44:47], v[32:35], v[80:95]
    v_mfma_f32_32x32x16_bf16 v[96:111], v[40:43], v[36:39], v[96:111]
    v_mfma_f32_32x32x16_bf16 v[112:127], v[44:47], v[36:39], v[112:127]
    s_waitcnt lgkmcnt(0)
    v_mfma_f32_32x32x16_bf16 v[64:79], v[56:59], v[48:51], v[64:79]
    v_mfma_f32_32x32x16_bf16 v[80:95], v[60:63], v[48:51], v[80:95]
    v_mfma_f32_32x32x16_bf16 v[96:111], v[56:59], v[52:55], v[96:111]
    v_mfma_f32_32x32x16_bf16 v[112:127], v[60:63], v[52:55], v[112:127]
    s_barrier
    s_add_u32 m0, s13, 0
    s_nop 0
    global_load_lds_dwordx4 v8, s[6:7]
    s_add_u32 m0, s13, 1024
    s_nop 0
    global_load_lds_dwordx4 v9, s[6:7]
    s_add_u32 m0, s13, 2048
    s_nop 0
    global_load_lds_dwordx4 v10, s[6:7]
    s_add_u32 m0, s13, 3072
    s_nop 0
    global_load_lds_dwordx4 v11, s[6:7]
    s_add_u32 m0, s13, 16384
    s_nop 0
    global_load_lds_dwordx4 v[12:13], off
    s_add_u32 m0, s13, 17408
    s_nop 0
    global_load_lds_dwordx4 v[14:15], off
    s_add_u32 m0, s13, 18432
    s_nop 0
    global_load_lds_dwordx4 v[16:17], off
    s_add_u32 m0, s13, 19456
    s_nop 0
    global_load_lds_dwordx4 v[18:19], off
    s_add_u32 s6, s6, 128
    s_addc_u32 s7, s7, 0
    v_add_co_u32 v12, vcc, 524288, v12
    v_addc_co_u32 v13, vcc, 0, v13, vcc
    v_add_co_u32 v14, vcc, 524288, v14
    v_addc_co_u32 v15, vcc, 0, v15, vcc
    v_add_co_u32 v16, vcc, 524288, v16
    v_addc_co_u32 v17, vcc, 0, v17, vcc
    v_add_co_u32 v18, vcc, 524288, v18
    v_addc_co_u32 v19, vcc, 0, v19, vcc
    s_waitcnt vmcnt(8)
    s_barrier
    ds_read_b128 v[32:35], v20 offset:32768
    ds_read_b128 v[36:39], v20 offset:36864
    ds_read_b64_tr_b16 v[40:41], v24 offset:32768
    ds_read_b64_tr_b16 v[42:43], v24 offset:33792
    ds_read_b64_tr_b16 v[44:45], v25 offset:32768
    ds_read_b64_tr_b16 v[46:47], v25 offset:33792
    ds_read_b128 v[48:51], v21 offset:32768
    ds_read_b128 v[52:55], v21 offset:36864
    ds_read_b64_tr_b16 v[56:57], v24 offset:36864
    ds_read_b64_tr_b16 v[58:59], v24 offset:37888
    ds_read_b64_tr_b16 v[60:61], v25 offset:36864
    ds_read_b64_tr_b16 v[62:63], v25 offset:37888
    s_waitcnt lgkmcnt(6)
    v_mfma_f32_32x32x16_bf16 v[64:79], v[40:43], v[32:35], v[64:79]
    v_mfma_f32_32x32x16_bf16 v[80:95], v[44:47], v[32:35], v[80:95]
    v_mfma_f32_32x32x16_bf16 v[96:111], v[40:43], v[36:39], v[96:111]
    v_mfma_f32_32x32x16_bf16 v[112:127], v[44:47], v[36:39], v[112:127]
    ds_read_b128 v[32:35], v22 offset:32768
    ds_read_b128 v[36:39], v22 offset:36864
    ds_read_b64_tr_b16 v[40:41], v24 offset:40960
    ds_read_b64_tr_b16 v[42:43], v24 offset:41984
    ds_read_b64_tr_b16 v[44:45], v25 offset:40960
    ds_read_b64_tr_b16 v[46:47], v25 offset:41984
    s_waitcnt lgkmcnt(6)
    v_mfma_f32_32x32x16_bf16 v[64:79], v[56:59], v[48:51], v[64:79]
    v_mfma_f32_32x32x16_bf16 v[80:95], v[60:63], v[48:51], v[80:95]
    v_mfma_f32_32x32x16_bf16 v[96:111], v[56:59], v[52:55], v[96:111]
    v_mfma_f32_32x32x16_bf16 v[112:127], v[60:63], v[52:55], v[112:127]
    ds_read_b128 v[48:51], v23 offset:32768
    ds_read_b128 v[52:55], v23 offset:36864
    ds_read_b64_tr_b16 v[56:57], v24 offset:45056
    ds_read_b64_tr_b16 v[58:59], v24 offset:46080
    ds_read_b64_tr_b16 v[60:61], v25 offset:45056
    ds_read_b64_tr_b16 v[62:63], v25 offset:46080
    s_waitcnt lgkmcnt(6)
    v_mfma_f32_32x32x16_bf16 v[64:79], v[40:43], v[32:35], v[64:79]
    v_mfma_f32_32x32x16_bf16 v[80:95], v[44:47], v[32:35], v[80:95]
    v_mfma_f32_32x32x16_bf16 v[96:111], v[40:43], v[36:39], v[96:111]
    v_mfma_f32_32x32x16_bf16 v[112:127], v[44:47], v[36:39], v[112:127]
    s_waitcnt lgkmcnt(0)
    v_mfma_f32_32x32x16_bf16 v[64:79], v[56:59], v[48:51], v[64:79]
    v_mfma_f32_32x32x16_bf16 v[80:95], v[60:63], v[48:51], v[80:95]
    v_mfma_f32_32x32x16_bf16 v[96:111], v[56:59], v[52:55], v[96:111]
    v_mfma_f32_32x32x16_bf16 v[112:127], v[60:63], v[52:55], v[112:127]
    s_barrier
    s_add_u32 m0, s13, 32768
    s_nop 0
    global_load_lds_dwordx4 v8, s[6:7]
    s_add_u32 m0, s13, 33792
    s_nop 0
    global_load_lds_dwordx4 v9, s[6:7]
    s_add_u32 m0, s13, 34816
    s_nop 0
    global_load_lds_dwordx4 v10, s[6:7]
    s_add_u32 m0, s13, 35840
    s_nop 0
    global_load_lds_dwordx4 v11, s[6:7]
    s_add_u32 m0, s13, 49152
    s_nop 0
    global_load_lds_dwordx4 v[12:13], off
    s_add_u32 m0, s13, 50176
    s_nop 0
    global_load_lds_dwordx4 v[14:15], off
    s_add_u32 m0, s13, 51200
    s_nop 0
    global_load_lds_dwordx4 v[16:17], off
    s_add_u32 m0, s13, 52224
    s_nop 0
    global_load_lds_dwordx4 v[18:19], off
    s_add_u32 s6, s6, 128
    s_addc_u32 s7, s7, 0
    v_add_co_u32 v12, vcc, 524288, v12
    v_addc_co_u32 v13, vcc, 0, v13, vcc
    v_add_co_u32 v14, vcc, 524288, v14
    v_addc_co_u32 v15, vcc, 0, v15, vcc
    v_add_co_u32 v16, vcc, 524288, v16
    v_addc_co_u32 v17, vcc, 0, v17, vcc
    v_add_co_u32 v18, vcc, 524288, v18
    v_addc_co_u32 v19, vcc, 0, v19, vcc
    s_waitcnt vmcnt(8)
    s_barrier
    ds_read_b128 v[32:35], v20 offset:0
    ds_read_b128 v[36:39], v20 offset:4096
    ds_read_b64_tr_b16 v[40:41], v24 offset:0
    ds_read_b64_tr_b16 v[42:43], v24 offset:1024
    ds_read_b64_tr_b16 v[44:45], v25 offset:0
    ds_read_b64_tr_b16 v[46:47], v25 offset:1024
    ds_read_b128 v[48:51], v21 offset:0
    ds_read_b128 v[52:55], v21 offset:4096
    ds_read_b64_tr_b16 v[56:57], v24 offset:4096
    ds_read_b64_tr_b16 v[58:59], v24 offset:5120
    ds_read_b64_tr_b16 v[60:61], v25 offset:4096
    ds_read_b64_tr_b16 v[62:63], v25 offset:5120
    s_waitcnt lgkmcnt(6)
    v_mfma_f32_32x32x16_bf16 v[64:79], v[40:43], v[32:35], v[64:79]
    v_mfma_f32_32x32x16_bf16 v[80:95], v[44:47], v[32:35], v[80:95]
    v_mfma_f32_32x32x16_bf16 v[96:111], v[40:43], v[36:39], v[96:111]
    v_mfma_f32_32x32x16_bf16 v[112:127], v[44:47], v[36:39], v[112:127]
    ds_read_b128 v[32:35], v22 offset:0
    ds_read_b128 v[36:39], v22 offset:4096
    ds_read_b64_tr_b16 v[40:41], v24 offset:8192
    ds_read_b64_tr_b16 v[42:43], v24 offset:9216
    ds_read_b64_tr_b16 v[44:45], v25 offset:8192
    ds_read_b64_tr_b16 v[46:47], v25 offset:9216
    s_waitcnt lgkmcnt(6)
    v_mfma_f32_32x32x16_bf16 v[64:79], v[56:59], v[48:51], v[64:79]
    v_mfma_f32_32x32x16_bf16 v[80:95], v[60:63], v[48:51], v[80:95]
    v_mfma_f32_32x32x16_bf16 v[96:111], v[56:59], v[52:55], v[96:111]
    v_mfma_f32_32x32x16_bf16 v[112:127], v[60:63], v[52:55], v[112:127]
    ds_read_b128 v[48:51], v23 offset:0
    ds_read_b128 v[52:55], v23 offset:4096
    ds_read_b64_tr_b16 v[56:57], v24 offset:12288
    ds_read_b64_tr_b16 v[58:59], v24 offset:13312
    ds_read_b64_tr_b16 v[60:61], v25 offset:12288
    ds_read_b64_tr_b16 v[62:63], v25 offset:13312
    s_waitcnt lgkmcnt(6)
    v_mfma_f32_32x32x16_bf16 v[64:79], v[40:43], v[32:35], v[64:79]
    v_mfma_f32_32x32x16_bf16 v[80:95], v[44:47], v[32:35], v[80:95]
    v_mfma_f32_32x32x16_bf16 v[96:111], v[40:43], v[36:39], v[96:111]
    v_mfma_f32_32x32x16_bf16 v[112:127], v[44:47], v[36:39], v[112:127]
    s_waitcnt lgkmcnt(0)
    v_mfma_f32_32x32x16_bf16 v[64:79], v[56:59], v[48:51], v[64:79]
    v_mfma_f32_32x32x16_bf16 v[80:95], v[60:63], v[48:51], v[80:95]
    v_mfma_f32_32x32x16_bf16 v[96:111], v[56:59], v[52:55], v[96:111]
    v_mfma_f32_32x32x16_bf16 v[112:127], v[60:63], v[52:55], v[112:127]
    s_barrier
    s_add_u32 m0, s13, 0
    s_nop 0
    global_load_lds_dwordx4 v8, s[6:7]
    s_add_u32 m0, s13, 1024
    s_nop 0
    global_load_lds_dwordx4 v9, s[6:7]
    s_add_u32 m0, s13, 2048
    s_nop 0
    global_load_lds_dwordx4 v10, s[6:7]
    s_add_u32 m0, s13, 3072
    s_nop 0
    global_load_lds_dwordx4 v11, s[6:7]
    s_add_u32 m0, s13, 16384
    s_nop 0
    global_load_lds_dwordx4 v[12:13], off
    s_add_u32 m0, s13, 17408
    s_nop 0
    global_load_lds_dwordx4 v[14:15], off
    s_add_u32 m0, s13, 18432
    s_nop 0
    global_load_lds_dwordx4 v[16:17], off
    s_add_u32 m0, s13, 19456
    s_nop 0
    global_load_lds_dwordx4 v[18:19], off
    s_add_u32 s6, s6, 128
    s_addc_u32 s7, s7, 0
    v_add_co_u32 v12, vcc, 524288, v12
    v_addc_co_u32 v13, vcc, 0, v13, vcc
    v_add_co_u32 v14, vcc, 524288, v14
    v_addc_co_u32 v15, vcc, 0, v15, vcc
    v_add_co_u32 v16, vcc, 524288, v16
    v_addc_co_u32 v17, vcc, 0, v17, vcc
    v_add_co_u32 v18, vcc, 524288, v18
    v_addc_co_u32 v19, vcc, 0, v19, vcc
    s_waitcnt vmcnt(8)
    s_barrier
    ds_read_b128 v[32:35], v20 offset:32768
    ds_read_b128 v[36:39], v20 offset:36864
    ds_read_b64_tr_b16 v[40:41], v24 offset:32768
    ds_read_b64_tr_b16 v[42:43], v24 offset:33792
    ds_read_b64_tr_b16 v[44:45], v25 offset:32768
    ds_read_b64_tr_b16 v[46:47], v25 offset:33792
    ds_read_b128 v[48:51], v21 offset:32768
    ds_read_b128 v[52:55], v21 offset:36864
    ds_read_b64_tr_b16 v[56:57], v24 offset:36864
    ds_read_b64_tr_b16 v[58:59], v24 offset:37888
    ds_read_b64_tr_b16 v[60:61], v25 offset:36864
    ds_read_b64_tr_b16 v[62:63], v25 offset:37888
    s_waitcnt lgkmcnt(6)
    v_mfma_f32_32x32x16_bf16 v[64:79], v[40:43], v[32:35], v[64:79]
    v_mfma_f32_32x32x16_bf16 v[80:95], v[44:47], v[32:35], v[80:95]
    v_mfma_f32_32x32x16_bf16 v[96:111], v[40:43], v[36:39], v[96:111]
    v_mfma_f32_32x32x16_bf16 v[112:127], v[44:47], v[36:39], v[112:127]
    ds_read_b128 v[32:35], v22 offset:32768
    ds_read_b128 v[36:39], v22 offset:36864
    ds_read_b64_tr_b16 v[40:41], v24 offset:40960
    ds_read_b64_tr_b16 v[42:43], v24 offset:41984
    ds_read_b64_tr_b16 v[44:45], v25 offset:40960
    ds_read_b64_tr_b16 v[46:47], v25 offset:41984
    s_waitcnt lgkmcnt(6)
    v_mfma_f32_32x32x16_bf16 v[64:79], v[56:59], v[48:51], v[64:79]
    v_mfma_f32_32x32x16_bf16 v[80:95], v[60:63], v[48:51], v[80:95]
    v_mfma_f32_32x32x16_bf16 v[96:111], v[56:59], v[52:55], v[96:111]
    v_mfma_f32_32x32x16_bf16 v[112:127], v[60:63], v[52:55], v[112:127]
    ds_read_b128 v[48:51], v23 offset:32768
    ds_read_b128 v[52:55], v23 offset:36864
    ds_read_b64_tr_b16 v[56:57], v24 offset:45056
    ds_read_b64_tr_b16 v[58:59], v24 offset:46080
    ds_read_b64_tr_b16 v[60:61], v25 offset:45056
    ds_read_b64_tr_b16 v[62:63], v25 offset:46080
    s_waitcnt lgkmcnt(6)
    v_mfma_f32_32x32x16_bf16 v[64:79], v[40:43], v[32:35], v[64:79]
    v_mfma_f32_32x32x16_bf16 v[80:95], v[44:47], v[32:35], v[80:95]
    v_mfma_f32_32x32x16_bf16 v[96:111], v[40:43], v[36:39], v[96:111]
    v_mfma_f32_32x32x16_bf16 v[112:127], v[44:47], v[36:39], v[112:127]
    s_waitcnt lgkmcnt(0)
    v_mfma_f32_32x32x16_bf16 v[64:79], v[56:59], v[48:51], v[64:79]
    v_mfma_f32_32x32x16_bf16 v[80:95], v[60:63], v[48:51], v[80:95]
    v_mfma_f32_32x32x16_bf16 v[96:111], v[56:59], v[52:55], v[96:111]
    v_mfma_f32_32x32x16_bf16 v[112:127], v[60:63], v[52:55], v[112:127]
    s_barrier
    s_add_u32 m0, s13, 32768
    s_nop 0
    global_load_lds_dwordx4 v8, s[6:7]
    s_add_u32 m0, s13, 33792
    s_nop 0
    global_load_lds_dwordx4 v9, s[6:7]
    s_add_u32 m0, s13, 34816
    s_nop 0
    global_load_lds_dwordx4 v10, s[6:7]
    s_add_u32 m0, s13, 35840
    s_nop 0
    global_load_lds_dwordx4 v11, s[6:7]
    s_add_u32 m0, s13, 49152
    s_nop 0
    global_load_lds_dwordx4 v[12:13], off
    s_add_u32 m0, s13, 50176
    s_nop 0
    global_load_lds_dwordx4 v[14:15], off
    s_add_u32 m0, s13, 51200
    s_nop 0
    global_load_lds_dwordx4 v[16:17], off
    s_add_u32 m0, s13, 52224
    s_nop 0
    global_load_lds_dwordx4 v[18:19], off
    s_add_u32 s6, s6, 128
    s_addc_u32 s7, s7, 0
    v_add_co_u32 v12, vcc, 524288, v12
    v_addc_co_u32 v13, vcc, 0, v13, vcc
    v_add_co_u32 v14, vcc, 524288, v14
    v_addc_co_u32 v15, vcc, 0, v15, vcc
    v_add_co_u32 v16, vcc, 524288, v16
    v_addc_co_u32 v17, vcc, 0, v17, vcc
    v_add_co_u32 v18, vcc, 524288, v18
    v_addc_co_u32 v19, vcc, 0, v19, vcc
    s_waitcnt vmcnt(8)
    s_barrier
    ds_read_b128 v[32:35], v20 offset:0
    ds_read_b128 v[36:39], v20 offset:4096
    ds_read_b64_tr_b16 v[40:41], v24 offset:0
    ds_read_b64_tr_b16 v[42:43], v24 offset:1024
    ds_read_b64_tr_b16 v[44:45], v25 offset:0
    ds_read_b64_tr_b16 v[46:47], v25 offset:1024
    ds_read_b128 v[48:51], v21 offset:0
    ds_read_b128 v[52:55], v21 offset:4096
    ds_read_b64_tr_b16 v[56:57], v24 offset:4096
    ds_read_b64_tr_b16 v[58:59], v24 offset:5120
    ds_read_b64_tr_b16 v[60:61], v25 offset:4096
    ds_read_b64_tr_b16 v[62:63], v25 offset:5120
    s_waitcnt lgkmcnt(6)
    v_mfma_f32_32x32x16_bf16 v[64:79], v[40:43], v[32:35], v[64:79]
    v_mfma_f32_32x32x16_bf16 v[80:95], v[44:47], v[32:35], v[80:95]
    v_mfma_f32_32x32x16_bf16 v[96:111], v[40:43], v[36:39], v[96:111]
    v_mfma_f32_32x32x16_bf16 v[112:127], v[44:47], v[36:39], v[112:127]
    ds_read_b128 v[32:35], v22 offset:0
    ds_read_b128 v[36:39], v22 offset:4096
    ds_read_b64_tr_b16 v[40:41], v24 offset:8192
    ds_read_b64_tr_b16 v[42:43], v24 offset:9216
    ds_read_b64_tr_b16 v[44:45], v25 offset:8192
    ds_read_b64_tr_b16 v[46:47], v25 offset:9216
    s_waitcnt lgkmcnt(6)
    v_mfma_f32_32x32x16_bf16 v[64:79], v[56:59], v[48:51], v[64:79]
    v_mfma_f32_32x32x16_bf16 v[80:95], v[60:63], v[48:51], v[80:95]
    v_mfma_f32_32x32x16_bf16 v[96:111], v[56:59], v[52:55], v[96:111]
    v_mfma_f32_32x32x16_bf16 v[112:127], v[60:63], v[52:55], v[112:127]
    ds_read_b128 v[48:51], v23 offset:0
    ds_read_b128 v[52:55], v23 offset:4096
    ds_read_b64_tr_b16 v[56:57], v24 offset:12288
    ds_read_b64_tr_b16 v[58:59], v24 offset:13312
    ds_read_b64_tr_b16 v[60:61], v25 offset:12288
    ds_read_b64_tr_b16 v[62:63], v25 offset:13312
    s_waitcnt lgkmcnt(6)
    v_mfma_f32_32x32x16_bf16 v[64:79], v[40:43], v[32:35], v[64:79]
    v_mfma_f32_32x32x16_bf16 v[80:95], v[44:47], v[32:35], v[80:95]
    v_mfma_f32_32x32x16_bf16 v[96:111], v[40:43], v[36:39], v[96:111]
    v_mfma_f32_32x32x16_bf16 v[112:127], v[44:47], v[36:39], v[112:127]
    s_waitcnt lgkmcnt(0)
    v_mfma_f32_32x32x16_bf16 v[64:79], v[56:59], v[48:51], v[64:79]
    v_mfma_f32_32x32x16_bf16 v[80:95], v[60:63], v[48:51], v[80:95]
    v_mfma_f32_32x32x16_bf16 v[96:111], v[56:59], v[52:55], v[96:111]
    v_mfma_f32_32x32x16_bf16 v[112:127], v[60:63], v[52:55], v[112:127]
    s_barrier
    s_add_u32 m0, s13, 0
    s_nop 0
    global_load_lds_dwordx4 v8, s[6:7]
    s_add_u32 m0, s13, 1024
    s_nop 0
    global_load_lds_dwordx4 v9, s[6:7]
    s_add_u32 m0, s13, 2048
    s_nop 0
    global_load_lds_dwordx4 v10, s[6:7]
    s_add_u32 m0, s13, 3072
    s_nop 0
    global_load_lds_dwordx4 v11, s[6:7]
    s_add_u32 m0, s13, 16384
    s_nop 0
    global_load_lds_dwordx4 v[12:13], off
    s_add_u32 m0, s13, 17408
    s_nop 0
    global_load_lds_dwordx4 v[14:15], off
    s_add_u32 m0, s13, 18432
    s_nop 0
    global_load_lds_dwordx4 v[16:17], off
    s_add_u32 m0, s13, 19456
    s_nop 0
    global_load_lds_dwordx4 v[18:19], off
    s_add_u32 s6, s6, 128
    s_addc_u32 s7, s7, 0
    v_add_co_u32 v12, vcc, 524288, v12
    v_addc_co_u32 v13, vcc, 0, v13, vcc
    v_add_co_u32 v14, vcc, 524288, v14
    v_addc_co_u32 v15, vcc, 0, v15, vcc
    v_add_co_u32 v16, vcc, 524288, v16
    v_addc_co_u32 v17, vcc, 0, v17, vcc
    v_add_co_u32 v18, vcc, 524288, v18
    v_addc_co_u32 v19, vcc, 0, v19, vcc
    s_waitcnt vmcnt(8)
    s_barrier
    ds_read_b128 v[32:35], v20 offset:32768
    ds_read_b128 v[36:39], v20 offset:36864
    ds_read_b64_tr_b16 v[40:41], v24 offset:32768
    ds_read_b64_tr_b16 v[42:43], v24 offset:33792
    ds_read_b64_tr_b16 v[44:45], v25 offset:32768
    ds_read_b64_tr_b16 v[46:47], v25 offset:33792
    ds_read_b128 v[48:51], v21 offset:32768
    ds_read_b128 v[52:55], v21 offset:36864
    ds_read_b64_tr_b16 v[56:57], v24 offset:36864
    ds_read_b64_tr_b16 v[58:59], v24 offset:37888
    ds_read_b64_tr_b16 v[60:61], v25 offset:36864
    ds_read_b64_tr_b16 v[62:63], v25 offset:37888
    s_waitcnt lgkmcnt(6)
    v_mfma_f32_32x32x16_bf16 v[64:79], v[40:43], v[32:35], v[64:79]
    v_mfma_f32_32x32x16_bf16 v[80:95], v[44:47], v[32:35], v[80:95]
    v_mfma_f32_32x32x16_bf16 v[96:111], v[40:43], v[36:39], v[96:111]
    v_mfma_f32_32x32x16_bf16 v[112:127], v[44:47], v[36:39], v[112:127]
    ds_read_b128 v[32:35], v22 offset:32768
    ds_read_b128 v[36:39], v22 offset:36864
    ds_read_b64_tr_b16 v[40:41], v24 offset:40960
    ds_read_b64_tr_b16 v[42:43], v24 offset:41984
    ds_read_b64_tr_b16 v[44:45], v25 offset:40960
    ds_read_b64_tr_b16 v[46:47], v25 offset:41984
    s_waitcnt lgkmcnt(6)
    v_mfma_f32_32x32x16_bf16 v[64:79], v[56:59], v[48:51], v[64:79]
    v_mfma_f32_32x32x16_bf16 v[80:95], v[60:63], v[48:51], v[80:95]
    v_mfma_f32_32x32x16_bf16 v[96:111], v[56:59], v[52:55], v[96:111]
    v_mfma_f32_32x32x16_bf16 v[112:127], v[60:63], v[52:55], v[112:127]
    ds_read_b128 v[48:51], v23 offset:32768
    ds_read_b128 v[52:55], v23 offset:36864
    ds_read_b64_tr_b16 v[56:57], v24 offset:45056
    ds_read_b64_tr_b16 v[58:59], v24 offset:46080
    ds_read_b64_tr_b16 v[60:61], v25 offset:45056
    ds_read_b64_tr_b16 v[62:63], v25 offset:46080
    s_waitcnt lgkmcnt(6)
    v_mfma_f32_32x32x16_bf16 v[64:79], v[40:43], v[32:35], v[64:79]
    v_mfma_f32_32x32x16_bf16 v[80:95], v[44:47], v[32:35], v[80:95]
    v_mfma_f32_32x32x16_bf16 v[96:111], v[40:43], v[36:39], v[96:111]
    v_mfma_f32_32x32x16_bf16 v[112:127], v[44:47], v[36:39], v[112:127]
    s_waitcnt lgkmcnt(0)
    v_mfma_f32_32x32x16_bf16 v[64:79], v[56:59], v[48:51], v[64:79]
    v_mfma_f32_32x32x16_bf16 v[80:95], v[60:63], v[48:51], v[80:95]
    v_mfma_f32_32x32x16_bf16 v[96:111], v[56:59], v[52:55], v[96:111]
    v_mfma_f32_32x32x16_bf16 v[112:127], v[60:63], v[52:55], v[112:127]
    s_barrier
    s_waitcnt vmcnt(0)
    s_barrier
    ds_read_b128 v[32:35], v20 offset:0
    ds_read_b128 v[36:39], v20 offset:4096
    ds_read_b64_tr_b16 v[40:41], v24 offset:0
    ds_read_b64_tr_b16 v[42:43], v24 offset:1024
    ds_read_b64_tr_b16 v[44:45], v25 offset:0
    ds_read_b64_tr_b16 v[46:47], v25 offset:1024
    ds_read_b128 v[48:51], v21 offset:0
    ds_read_b128 v[52:55], v21 offset:4096
    ds_read_b64_tr_b16 v[56:57], v24 offset:4096
    ds_read_b64_tr_b16 v[58:59], v24 offset:5120
    ds_read_b64_tr_b16 v[60:61], v25 offset:4096
    ds_read_b64_tr_b16 v[62:63], v25 offset:5120
    s_waitcnt lgkmcnt(6)
    v_mfma_f32_32x32x16_bf16 v[64:79], v[40:43], v[32:35], v[64:79]
    v_mfma_f32_32x32x16_bf16 v[80:95], v[44:47], v[32:35], v[80:95]
    v_mfma_f32_32x32x16_bf16 v[96:111], v[40:43], v[36:39], v[96:111]
    v_mfma_f32_32x32x16_bf16 v[112:127], v[44:47], v[36:39], v[112:127]
    ds_read_b128 v[32:35], v22 offset:0
    ds_read_b128 v[36:39], v22 offset:4096
    ds_read_b64_tr_b16 v[40:41], v24 offset:8192
    ds_read_b64_tr_b16 v[42:43], v24 offset:9216
    ds_read_b64_tr_b16 v[44:45], v25 offset:8192
    ds_read_b64_tr_b16 v[46:47], v25 offset:9216
    s_waitcnt lgkmcnt(6)
    v_mfma_f32_32x32x16_bf16 v[64:79], v[56:59], v[48:51], v[64:79]
    v_mfma_f32_32x32x16_bf16 v[80:95], v[60:63], v[48:51], v[80:95]
    v_mfma_f32_32x32x16_bf16 v[96:111], v[56:59], v[52:55], v[96:111]
    v_mfma_f32_32x32x16_bf16 v[112:127], v[60:63], v[52:55], v[112:127]
    ds_read_b128 v[48:51], v23 offset:0
    ds_read_b128 v[52:55], v23 offset:4096
    ds_read_b64_tr_b16 v[56:57], v24 offset:12288
    ds_read_b64_tr_b16 v[58:59], v24 offset:13312
    ds_read_b64_tr_b16 v[60:61], v25 offset:12288
    ds_read_b64_tr_b16 v[62:63], v25 offset:13312
    s_waitcnt lgkmcnt(6)
    v_mfma_f32_32x32x16_bf16 v[64:79], v[40:43], v[32:35], v[64:79]
    v_mfma_f32_32x32x16_bf16 v[80:95], v[44:47], v[32:35], v[80:95]
    v_mfma_f32_32x32x16_bf16 v[96:111], v[40:43], v[36:39], v[96:111]
    v_mfma_f32_32x32x16_bf16 v[112:127], v[44:47], v[36:39], v[112:127]
    s_waitcnt lgkmcnt(0)
    v_mfma_f32_32x32x16_bf16 v[64:79], v[56:59], v[48:51], v[64:79]
    v_mfma_f32_32x32x16_bf16 v[80:95], v[60:63], v[48:51], v[80:95]
    v_mfma_f32_32x32x16_bf16 v[96:111], v[56:59], v[52:55], v[96:111]
    v_mfma_f32_32x32x16_bf16 v[112:127], v[60:63], v[52:55], v[112:127]
    s_barrier
    s_branch qkv_kernel_epi
qkv_kernel_vpath:
    s_add_u32 m0, s13, 32768
    s_nop 0
    global_load_lds_dwordx4 v8, s[6:7]
    s_add_u32 m0, s13, 33792
    s_nop 0
    global_load_lds_dwordx4 v9, s[6:7]
    s_add_u32 m0, s13, 34816
    s_nop 0
    global_load_lds_dwordx4 v10, s[6:7]
    s_add_u32 m0, s13, 35840
    s_nop 0
    global_load_lds_dwordx4 v11, s[6:7]
    s_add_u32 m0, s13, 49152
    s_nop 0
    global_load_lds_dwordx4 v[12:13], off
    s_add_u32 m0, s13, 50176
    s_nop 0
    global_load_lds_dwordx4 v[14:15], off
    s_add_u32 m0, s13, 51200
    s_nop 0
    global_load_lds_dwordx4 v[16:17], off
    s_add_u32 m0, s13, 52224
    s_nop 0
    global_load_lds_dwordx4 v[18:19], off
    s_add_u32 s6, s6, 128
    s_addc_u32 s7, s7, 0
    v_add_co_u32 v12, vcc, 524288, v12
    v_addc_co_u32 v13, vcc, 0, v13, vcc
    v_add_co_u32 v14, vcc, 524288, v14
    v_addc_co_u32 v15, vcc, 0, v15, vcc
    v_add_co_u32 v16, vcc, 524288, v16
    v_addc_co_u32 v17, vcc, 0, v17, vcc
    v_add_co_u32 v18, vcc, 524288, v18
    v_addc_co_u32 v19, vcc, 0, v19, vcc
    s_waitcnt vmcnt(8)
    s_barrier
    ds_read_b128 v[32:35], v20 offset:0
    ds_read_b128 v[36:39], v20 offset:4096
    ds_read_b64_tr_b16 v[40:41], v24 offset:0
    ds_read_b64_tr_b16 v[42:43], v24 offset:1024
    ds_read_b64_tr_b16 v[44:45], v25 offset:0
    ds_read_b64_tr_b16 v[46:47], v25 offset:1024
    ds_read_b128 v[48:51], v21 offset:0
    ds_read_b128 v[52:55], v21 offset:4096
    ds_read_b64_tr_b16 v[56:57], v24 offset:4096
    ds_read_b64_tr_b16 v[58:59], v24 offset:5120
    ds_read_b64_tr_b16 v[60:61], v25 offset:4096
    ds_read_b64_tr_b16 v[62:63], v25 offset:5120
    s_waitcnt lgkmcnt(6)
    v_mfma_f32_32x32x16_bf16 v[64:79], v[32:35], v[40:43], v[64:79]
    v_mfma_f32_32x32x16_bf16 v[80:95], v[32:35], v[44:47], v[80:95]
    v_mfma_f32_32x32x16_bf16 v[96:111], v[36:39], v[40:43], v[96:111]
    v_mfma_f32_32x32x16_bf16 v[112:127], v[36:39], v[44:47], v[112:127]
    ds_read_b128 v[32:35], v22 offset:0
    ds_read_b128 v[36:39], v22 offset:4096
    ds_read_b64_tr_b16 v[40:41], v24 offset:8192
    ds_read_b64_tr_b16 v[42:43], v24 offset:9216
    ds_read_b64_tr_b16 v[44:45], v25 offset:8192
    ds_read_b64_tr_b16 v[46:47], v25 offset:9216
    s_waitcnt lgkmcnt(6)
    v_mfma_f32_32x32x16_bf16 v[64:79], v[48:51], v[56:59], v[64:79]
    v_mfma_f32_32x32x16_bf16 v[80:95], v[48:51], v[60:63], v[80:95]
    v_mfma_f32_32x32x16_bf16 v[96:111], v[52:55], v[56:59], v[96:111]
    v_mfma_f32_32x32x16_bf16 v[112:127], v[52:55], v[60:63], v[112:127]
    ds_read_b128 v[48:51], v23 offset:0
    ds_read_b128 v[52:55], v23 offset:4096
    ds_read_b64_tr_b16 v[56:57], v24 offset:12288
    ds_read_b64_tr_b16 v[58:59], v24 offset:13312
    ds_read_b64_tr_b16 v[60:61], v25 offset:12288
    ds_read_b64_tr_b16 v[62:63], v25 offset:13312
    s_waitcnt lgkmcnt(6)
    v_mfma_f32_32x32x16_bf16 v[64:79], v[32:35], v[40:43], v[64:79]
    v_mfma_f32_32x32x16_bf16 v[80:95], v[32:35], v[44:47], v[80:95]
    v_mfma_f32_32x32x16_bf16 v[96:111], v[36:39], v[40:43], v[96:111]
    v_mfma_f32_32x32x16_bf16 v[112:127], v[36:39], v[44:47], v[112:127]
    s_waitcnt lgkmcnt(0)
    v_mfma_f32_32x32x16_bf16 v[64:79], v[48:51], v[56:59], v[64:79]
    v_mfma_f32_32x32x16_bf16 v[80:95], v[48:51], v[60:63], v[80:95]
    v_mfma_f32_32x32x16_bf16 v[96:111], v[52:55], v[56:59], v[96:111]
    v_mfma_f32_32x32x16_bf16 v[112:127], v[52:55], v[60:63], v[112:127]
    s_barrier
    s_add_u32 m0, s13, 0
    s_nop 0
    global_load_lds_dwordx4 v8, s[6:7]
    s_add_u32 m0, s13, 1024
    s_nop 0
    global_load_lds_dwordx4 v9, s[6:7]
    s_add_u32 m0, s13, 2048
    s_nop 0
    global_load_lds_dwordx4 v10, s[6:7]
    s_add_u32 m0, s13, 3072
    s_nop 0
    global_load_lds_dwordx4 v11, s[6:7]
    s_add_u32 m0, s13, 16384
    s_nop 0
    global_load_lds_dwordx4 v[12:13], off
    s_add_u32 m0, s13, 17408
    s_nop 0
    global_load_lds_dwordx4 v[14:15], off
    s_add_u32 m0, s13, 18432
    s_nop 0
    global_load_lds_dwordx4 v[16:17], off
    s_add_u32 m0, s13, 19456
    s_nop 0
    global_load_lds_dwordx4 v[18:19], off
    s_add_u32 s6, s6, 128
    s_addc_u32 s7, s7, 0
    v_add_co_u32 v12, vcc, 524288, v12
    v_addc_co_u32 v13, vcc, 0, v13, vcc
    v_add_co_u32 v14, vcc, 524288, v14
    v_addc_co_u32 v15, vcc, 0, v15, vcc
    v_add_co_u32 v16, vcc, 524288, v16
    v_addc_co_u32 v17, vcc, 0, v17, vcc
    v_add_co_u32 v18, vcc, 524288, v18
    v_addc_co_u32 v19, vcc, 0, v19, vcc
    s_waitcnt vmcnt(8)
    s_barrier
    ds_read_b128 v[32:35], v20 offset:32768
    ds_read_b128 v[36:39], v20 offset:36864
    ds_read_b64_tr_b16 v[40:41], v24 offset:32768
    ds_read_b64_tr_b16 v[42:43], v24 offset:33792
    ds_read_b64_tr_b16 v[44:45], v25 offset:32768
    ds_read_b64_tr_b16 v[46:47], v25 offset:33792
    ds_read_b128 v[48:51], v21 offset:32768
    ds_read_b128 v[52:55], v21 offset:36864
    ds_read_b64_tr_b16 v[56:57], v24 offset:36864
    ds_read_b64_tr_b16 v[58:59], v24 offset:37888
    ds_read_b64_tr_b16 v[60:61], v25 offset:36864
    ds_read_b64_tr_b16 v[62:63], v25 offset:37888
    s_waitcnt lgkmcnt(6)
    v_mfma_f32_32x32x16_bf16 v[64:79], v[32:35], v[40:43], v[64:79]
    v_mfma_f32_32x32x16_bf16 v[80:95], v[32:35], v[44:47], v[80:95]
    v_mfma_f32_32x32x16_bf16 v[96:111], v[36:39], v[40:43], v[96:111]
    v_mfma_f32_32x32x16_bf16 v[112:127], v[36:39], v[44:47], v[112:127]
    ds_read_b128 v[32:35], v22 offset:32768
    ds_read_b128 v[36:39], v22 offset:36864
    ds_read_b64_tr_b16 v[40:41], v24 offset:40960
    ds_read_b64_tr_b16 v[42:43], v24 offset:41984
    ds_read_b64_tr_b16 v[44:45], v25 offset:40960
    ds_read_b64_tr_b16 v[46:47], v25 offset:41984
    s_waitcnt lgkmcnt(6)
    v_mfma_f32_32x32x16_bf16 v[64:79], v[48:51], v[56:59], v[64:79]
    v_mfma_f32_32x32x16_bf16 v[80:95], v[48:51], v[60:63], v[80:95]
    v_mfma_f32_32x32x16_bf16 v[96:111], v[52:55], v[56:59], v[96:111]
    v_mfma_f32_32x32x16_bf16 v[112:127], v[52:55], v[60:63], v[112:127]
    ds_read_b128 v[48:51], v23 offset:32768
    ds_read_b128 v[52:55], v23 offset:36864
    ds_read_b64_tr_b16 v[56:57], v24 offset:45056
    ds_read_b64_tr_b16 v[58:59], v24 offset:46080
    ds_read_b64_tr_b16 v[60:61], v25 offset:45056
    ds_read_b64_tr_b16 v[62:63], v25 offset:46080
    s_waitcnt lgkmcnt(6)
    v_mfma_f32_32x32x16_bf16 v[64:79], v[32:35], v[40:43], v[64:79]
    v_mfma_f32_32x32x16_bf16 v[80:95], v[32:35], v[44:47], v[80:95]
    v_mfma_f32_32x32x16_bf16 v[96:111], v[36:39], v[40:43], v[96:111]
    v_mfma_f32_32x32x16_bf16 v[112:127], v[36:39], v[44:47], v[112:127]
    s_waitcnt lgkmcnt(0)
    v_mfma_f32_32x32x16_bf16 v[64:79], v[48:51], v[56:59], v[64:79]
    v_mfma_f32_32x32x16_bf16 v[80:95], v[48:51], v[60:63], v[80:95]
    v_mfma_f32_32x32x16_bf16 v[96:111], v[52:55], v[56:59], v[96:111]
    v_mfma_f32_32x32x16_bf16 v[112:127], v[52:55], v[60:63], v[112:127]
    s_barrier
    s_add_u32 m0, s13, 32768
    s_nop 0
    global_load_lds_dwordx4 v8, s[6:7]
    s_add_u32 m0, s13, 33792
    s_nop 0
    global_load_lds_dwordx4 v9, s[6:7]
    s_add_u32 m0, s13, 34816
    s_nop 0
    global_load_lds_dwordx4 v10, s[6:7]
    s_add_u32 m0, s13, 35840
    s_nop 0
    global_load_lds_dwordx4 v11, s[6:7]
    s_add_u32 m0, s13, 49152
    s_nop 0
    global_load_lds_dwordx4 v[12:13], off
    s_add_u32 m0, s13, 50176
    s_nop 0
    global_load_lds_dwordx4 v[14:15], off
    s_add_u32 m0, s13, 51200
    s_nop 0
    global_load_lds_dwordx4 v[16:17], off
    s_add_u32 m0, s13, 52224
    s_nop 0
    global_load_lds_dwordx4 v[18:19], off
    s_add_u32 s6, s6, 128
    s_addc_u32 s7, s7, 0
    v_add_co_u32 v12, vcc, 524288, v12
    v_addc_co_u32 v13, vcc, 0, v13, vcc
    v_add_co_u32 v14, vcc, 524288, v14
    v_addc_co_u32 v15, vcc, 0, v15, vcc
    v_add_co_u32 v16, vcc, 524288, v16
    v_addc_co_u32 v17, vcc, 0, v17, vcc
    v_add_co_u32 v18, vcc, 524288, v18
    v_addc_co_u32 v19, vcc, 0, v19, vcc
    s_waitcnt vmcnt(8)
    s_barrier
    ds_read_b128 v[32:35], v20 offset:0
    ds_read_b128 v[36:39], v20 offset:4096
    ds_read_b64_tr_b16 v[40:41], v24 offset:0
    ds_read_b64_tr_b16 v[42:43], v24 offset:1024
    ds_read_b64_tr_b16 v[44:45], v25 offset:0
    ds_read_b64_tr_b16 v[46:47], v25 offset:1024
    ds_read_b128 v[48:51], v21 offset:0
    ds_read_b128 v[52:55], v21 offset:4096
    ds_read_b64_tr_b16 v[56:57], v24 offset:4096
    ds_read_b64_tr_b16 v[58:59], v24 offset:5120
    ds_read_b64_tr_b16 v[60:61], v25 offset:4096
    ds_read_b64_tr_b16 v[62:63], v25 offset:5120
    s_waitcnt lgkmcnt(6)
    v_mfma_f32_32x32x16_bf16 v[64:79], v[32:35], v[40:43], v[64:79]
    v_mfma_f32_32x32x16_bf16 v[80:95], v[32:35], v[44:47], v[80:95]
    v_mfma_f32_32x32x16_bf16 v[96:111], v[36:39], v[40:43], v[96:111]
    v_mfma_f32_32x32x16_bf16 v[112:127], v[36:39], v[44:47], v[112:127]
    ds_read_b128 v[32:35], v22 offset:0
    ds_read_b128 v[36:39], v22 offset:4096
    ds_read_b64_tr_b16 v[40:41], v24 offset:8192
    ds_read_b64_tr_b16 v[42:43], v24 offset:9216
    ds_read_b64_tr_b16 v[44:45], v25 offset:8192
    ds_read_b64_tr_b16 v[46:47], v25 offset:9216
    s_waitcnt lgkmcnt(6)
    v_mfma_f32_32x32x16_bf16 v[64:79], v[48:51], v[56:59], v[64:79]
    v_mfma_f32_32x32x16_bf16 v[80:95], v[48:51], v[60:63], v[80:95]
    v_mfma_f32_32x32x16_bf16 v[96:111], v[52:55], v[56:59], v[96:111]
    v_mfma_f32_32x32x16_bf16 v[112:127], v[52:55], v[60:63], v[112:127]
    ds_read_b128 v[48:51], v23 offset:0
    ds_read_b128 v[52:55], v23 offset:4096
    ds_read_b64_tr_b16 v[56:57], v24 offset:12288
    ds_read_b64_tr_b16 v[58:59], v24 offset:13312
    ds_read_b64_tr_b16 v[60:61], v25 offset:12288
    ds_read_b64_tr_b16 v[62:63], v25 offset:13312
    s_waitcnt lgkmcnt(6)
    v_mfma_f32_32x32x16_bf16 v[64:79], v[32:35], v[40:43], v[64:79]
    v_mfma_f32_32x32x16_bf16 v[80:95], v[32:35], v[44:47], v[80:95]
    v_mfma_f32_32x32x16_bf16 v[96:111], v[36:39], v[40:43], v[96:111]
    v_mfma_f32_32x32x16_bf16 v[112:127], v[36:39], v[44:47], v[112:127]
    s_waitcnt lgkmcnt(0)
    v_mfma_f32_32x32x16_bf16 v[64:79], v[48:51], v[56:59], v[64:79]
    v_mfma_f32_32x32x16_bf16 v[80:95], v[48:51], v[60:63], v[80:95]
    v_mfma_f32_32x32x16_bf16 v[96:111], v[52:55], v[56:59], v[96:111]
    v_mfma_f32_32x32x16_bf16 v[112:127], v[52:55], v[60:63], v[112:127]
    s_barrier
    s_add_u32 m0, s13, 0
    s_nop 0
    global_load_lds_dwordx4 v8, s[6:7]
    s_add_u32 m0, s13, 1024
    s_nop 0
    global_load_lds_dwordx4 v9, s[6:7]
    s_add_u32 m0, s13, 2048
    s_nop 0
    global_load_lds_dwordx4 v10, s[6:7]
    s_add_u32 m0, s13, 3072
    s_nop 0
    global_load_lds_dwordx4 v11, s[6:7]
    s_add_u32 m0, s13, 16384
    s_nop 0
    global_load_lds_dwordx4 v[12:13], off
    s_add_u32 m0, s13, 17408
    s_nop 0
    global_load_lds_dwordx4 v[14:15], off
    s_add_u32 m0, s13, 18432
    s_nop 0
    global_load_lds_dwordx4 v[16:17], off
    s_add_u32 m0, s13, 19456
    s_nop 0
    global_load_lds_dwordx4 v[18:19], off
    s_add_u32 s6, s6, 128
    s_addc_u32 s7, s7, 0
    v_add_co_u32 v12, vcc, 524288, v12
    v_addc_co_u32 v13, vcc, 0, v13, vcc
    v_add_co_u32 v14, vcc, 524288, v14
    v_addc_co_u32 v15, vcc, 0, v15, vcc
    v_add_co_u32 v16, vcc, 524288, v16
    v_addc_co_u32 v17, vcc, 0, v17, vcc
    v_add_co_u32 v18, vcc, 524288, v18
    v_addc_co_u32 v19, vcc, 0, v19, vcc
    s_waitcnt vmcnt(8)
    s_barrier
    ds_read_b128 v[32:35], v20 offset:32768
    ds_read_b128 v[36:39], v20 offset:36864
    ds_read_b64_tr_b16 v[40:41], v24 offset:32768
    ds_read_b64_tr_b16 v[42:43], v24 offset:33792
    ds_read_b64_tr_b16 v[44:45], v25 offset:32768
    ds_read_b64_tr_b16 v[46:47], v25 offset:33792
    ds_read_b128 v[48:51], v21 offset:32768
    ds_read_b128 v[52:55], v21 offset:36864
    ds_read_b64_tr_b16 v[56:57], v24 offset:36864
    ds_read_b64_tr_b16 v[58:59], v24 offset:37888
    ds_read_b64_tr_b16 v[60:61], v25 offset:36864
    ds_read_b64_tr_b16 v[62:63], v25 offset:37888
    s_waitcnt lgkmcnt(6)
    v_mfma_f32_32x32x16_bf16 v[64:79], v[32:35], v[40:43], v[64:79]
    v_mfma_f32_32x32x16_bf16 v[80:95], v[32:35], v[44:47], v[80:95]
    v_mfma_f32_32x32x16_bf16 v[96:111], v[36:39], v[40:43], v[96:111]
    v_mfma_f32_32x32x16_bf16 v[112:127], v[36:39], v[44:47], v[112:127]
    ds_read_b128 v[32:35], v22 offset:32768
    ds_read_b128 v[36:39], v22 offset:36864
    ds_read_b64_tr_b16 v[40:41], v24 offset:40960
    ds_read_b64_tr_b16 v[42:43], v24 offset:41984
    ds_read_b64_tr_b16 v[44:45], v25 offset:40960
    ds_read_b64_tr_b16 v[46:47], v25 offset:41984
    s_waitcnt lgkmcnt(6)
    v_mfma_f32_32x32x16_bf16 v[64:79], v[48:51], v[56:59], v[64:79]
    v_mfma_f32_32x32x16_bf16 v[80:95], v[48:51], v[60:63], v[80:95]
    v_mfma_f32_32x32x16_bf16 v[96:111], v[52:55], v[56:59], v[96:111]
    v_mfma_f32_32x32x16_bf16 v[112:127], v[52:55], v[60:63], v[112:127]
    ds_read_b128 v[48:51], v23 offset:32768
    ds_read_b128 v[52:55], v23 offset:36864
    ds_read_b64_tr_b16 v[56:57], v24 offset:45056
    ds_read_b64_tr_b16 v[58:59], v24 offset:46080
    ds_read_b64_tr_b16 v[60:61], v25 offset:45056
    ds_read_b64_tr_b16 v[62:63], v25 offset:46080
    s_waitcnt lgkmcnt(6)
    v_mfma_f32_32x32x16_bf16 v[64:79], v[32:35], v[40:43], v[64:79]
    v_mfma_f32_32x32x16_bf16 v[80:95], v[32:35], v[44:47], v[80:95]
    v_mfma_f32_32x32x16_bf16 v[96:111], v[36:39], v[40:43], v[96:111]
    v_mfma_f32_32x32x16_bf16 v[112:127], v[36:39], v[44:47], v[112:127]
    s_waitcnt lgkmcnt(0)
    v_mfma_f32_32x32x16_bf16 v[64:79], v[48:51], v[56:59], v[64:79]
    v_mfma_f32_32x32x16_bf16 v[80:95], v[48:51], v[60:63], v[80:95]
    v_mfma_f32_32x32x16_bf16 v[96:111], v[52:55], v[56:59], v[96:111]
    v_mfma_f32_32x32x16_bf16 v[112:127], v[52:55], v[60:63], v[112:127]
    s_barrier
    s_add_u32 m0, s13, 32768
    s_nop 0
    global_load_lds_dwordx4 v8, s[6:7]
    s_add_u32 m0, s13, 33792
    s_nop 0
    global_load_lds_dwordx4 v9, s[6:7]
    s_add_u32 m0, s13, 34816
    s_nop 0
    global_load_lds_dwordx4 v10, s[6:7]
    s_add_u32 m0, s13, 35840
    s_nop 0
    global_load_lds_dwordx4 v11, s[6:7]
    s_add_u32 m0, s13, 49152
    s_nop 0
    global_load_lds_dwordx4 v[12:13], off
    s_add_u32 m0, s13, 50176
    s_nop 0
    global_load_lds_dwordx4 v[14:15], off
    s_add_u32 m0, s13, 51200
    s_nop 0
    global_load_lds_dwordx4 v[16:17], off
    s_add_u32 m0, s13, 52224
    s_nop 0
    global_load_lds_dwordx4 v[18:19], off
    s_add_u32 s6, s6, 128
    s_addc_u32 s7, s7, 0
    v_add_co_u32 v12, vcc, 524288, v12
    v_addc_co_u32 v13, vcc, 0, v13, vcc
    v_add_co_u32 v14, vcc, 524288, v14
    v_addc_co_u32 v15, vcc, 0, v15, vcc
    v_add_co_u32 v16, vcc, 524288, v16
    v_addc_co_u32 v17, vcc, 0, v17, vcc
    v_add_co_u32 v18, vcc, 524288, v18
    v_addc_co_u32 v19, vcc, 0, v19, vcc
    s_waitcnt vmcnt(8)
    s_barrier
    ds_read_b128 v[32:35], v20 offset:0
    ds_read_b128 v[36:39], v20 offset:4096
    ds_read_b64_tr_b16 v[40:41], v24 offset:0
    ds_read_b64_tr_b16 v[42:43], v24 offset:1024
    ds_read_b64_tr_b16 v[44:45], v25 offset:0
    ds_read_b64_tr_b16 v[46:47], v25 offset:1024
    ds_read_b128 v[48:51], v21 offset:0
    ds_read_b128 v[52:55], v21 offset:4096
    ds_read_b64_tr_b16 v[56:57], v24 offset:4096
    ds_read_b64_tr_b16 v[58:59], v24 offset:5120
    ds_read_b64_tr_b16 v[60:61], v25 offset:4096
    ds_read_b64_tr_b16 v[62:63], v25 offset:5120
    s_waitcnt lgkmcnt(6)
    v_mfma_f32_32x32x16_bf16 v[64:79], v[32:35], v[40:43], v[64:79]
    v_mfma_f32_32x32x16_bf16 v[80:95], v[32:35], v[44:47], v[80:95]
    v_mfma_f32_32x32x16_bf16 v[96:111], v[36:39], v[40:43], v[96:111]
    v_mfma_f32_32x32x16_bf16 v[112:127], v[36:39], v[44:47], v[112:127]
    ds_read_b128 v[32:35], v22 offset:0
    ds_read_b128 v[36:39], v22 offset:4096
    ds_read_b64_tr_b16 v[40:41], v24 offset:8192
    ds_read_b64_tr_b16 v[42:43], v24 offset:9216
    ds_read_b64_tr_b16 v[44:45], v25 offset:8192
    ds_read_b64_tr_b16 v[46:47], v25 offset:9216
    s_waitcnt lgkmcnt(6)
    v_mfma_f32_32x32x16_bf16 v[64:79], v[48:51], v[56:59], v[64:79]
    v_mfma_f32_32x32x16_bf16 v[80:95], v[48:51], v[60:63], v[80:95]
    v_mfma_f32_32x32x16_bf16 v[96:111], v[52:55], v[56:59], v[96:111]
    v_mfma_f32_32x32x16_bf16 v[112:127], v[52:55], v[60:63], v[112:127]
    ds_read_b128 v[48:51], v23 offset:0
    ds_read_b128 v[52:55], v23 offset:4096
    ds_read_b64_tr_b16 v[56:57], v24 offset:12288
    ds_read_b64_tr_b16 v[58:59], v24 offset:13312
    ds_read_b64_tr_b16 v[60:61], v25 offset:12288
    ds_read_b64_tr_b16 v[62:63], v25 offset:13312
    s_waitcnt lgkmcnt(6)
    v_mfma_f32_32x32x16_bf16 v[64:79], v[32:35], v[40:43], v[64:79]
    v_mfma_f32_32x32x16_bf16 v[80:95], v[32:35], v[44:47], v[80:95]
    v_mfma_f32_32x32x16_bf16 v[96:111], v[36:39], v[40:43], v[96:111]
    v_mfma_f32_32x32x16_bf16 v[112:127], v[36:39], v[44:47], v[112:127]
    s_waitcnt lgkmcnt(0)
    v_mfma_f32_32x32x16_bf16 v[64:79], v[48:51], v[56:59], v[64:79]
    v_mfma_f32_32x32x16_bf16 v[80:95], v[48:51], v[60:63], v[80:95]
    v_mfma_f32_32x32x16_bf16 v[96:111], v[52:55], v[56:59], v[96:111]
    v_mfma_f32_32x32x16_bf16 v[112:127], v[52:55], v[60:63], v[112:127]
    s_barrier
    s_add_u32 m0, s13, 0
    s_nop 0
    global_load_lds_dwordx4 v8, s[6:7]
    s_add_u32 m0, s13, 1024
    s_nop 0
    global_load_lds_dwordx4 v9, s[6:7]
    s_add_u32 m0, s13, 2048
    s_nop 0
    global_load_lds_dwordx4 v10, s[6:7]
    s_add_u32 m0, s13, 3072
    s_nop 0
    global_load_lds_dwordx4 v11, s[6:7]
    s_add_u32 m0, s13, 16384
    s_nop 0
    global_load_lds_dwordx4 v[12:13], off
    s_add_u32 m0, s13, 17408
    s_nop 0
    global_load_lds_dwordx4 v[14:15], off
    s_add_u32 m0, s13, 18432
    s_nop 0
    global_load_lds_dwordx4 v[16:17], off
    s_add_u32 m0, s13, 19456
    s_nop 0
    global_load_lds_dwordx4 v[18:19], off
    s_add_u32 s6, s6, 128
    s_addc_u32 s7, s7, 0
    v_add_co_u32 v12, vcc, 524288, v12
    v_addc_co_u32 v13, vcc, 0, v13, vcc
    v_add_co_u32 v14, vcc, 524288, v14
    v_addc_co_u32 v15, vcc, 0, v15, vcc
    v_add_co_u32 v16, vcc, 524288, v16
    v_addc_co_u32 v17, vcc, 0, v17, vcc
    v_add_co_u32 v18, vcc, 524288, v18
    v_addc_co_u32 v19, vcc, 0, v19, vcc
    s_waitcnt vmcnt(8)
    s_barrier
    ds_read_b128 v[32:35], v20 offset:32768
    ds_read_b128 v[36:39], v20 offset:36864
    ds_read_b64_tr_b16 v[40:41], v24 offset:32768
    ds_read_b64_tr_b16 v[42:43], v24 offset:33792
    ds_read_b64_tr_b16 v[44:45], v25 offset:32768
    ds_read_b64_tr_b16 v[46:47], v25 offset:33792
    ds_read_b128 v[48:51], v21 offset:32768
    ds_read_b128 v[52:55], v21 offset:36864
    ds_read_b64_tr_b16 v[56:57], v24 offset:36864
    ds_read_b64_tr_b16 v[58:59], v24 offset:37888
    ds_read_b64_tr_b16 v[60:61], v25 offset:36864
    ds_read_b64_tr_b16 v[62:63], v25 offset:37888
    s_waitcnt lgkmcnt(6)
    v_mfma_f32_32x32x16_bf16 v[64:79], v[32:35], v[40:43], v[64:79]
    v_mfma_f32_32x32x16_bf16 v[80:95], v[32:35], v[44:47], v[80:95]
    v_mfma_f32_32x32x16_bf16 v[96:111], v[36:39], v[40:43], v[96:111]
    v_mfma_f32_32x32x16_bf16 v[112:127], v[36:39], v[44:47], v[112:127]
    ds_read_b128 v[32:35], v22 offset:32768
    ds_read_b128 v[36:39], v22 offset:36864
    ds_read_b64_tr_b16 v[40:41], v24 offset:40960
    ds_read_b64_tr_b16 v[42:43], v24 offset:41984
    ds_read_b64_tr_b16 v[44:45], v25 offset:40960
    ds_read_b64_tr_b16 v[46:47], v25 offset:41984
    s_waitcnt lgkmcnt(6)
    v_mfma_f32_32x32x16_bf16 v[64:79], v[48:51], v[56:59], v[64:79]
    v_mfma_f32_32x32x16_bf16 v[80:95], v[48:51], v[60:63], v[80:95]
    v_mfma_f32_32x32x16_bf16 v[96:111], v[52:55], v[56:59], v[96:111]
    v_mfma_f32_32x32x16_bf16 v[112:127], v[52:55], v[60:63], v[112:127]
    ds_read_b128 v[48:51], v23 offset:32768
    ds_read_b128 v[52:55], v23 offset:36864
    ds_read_b64_tr_b16 v[56:57], v24 offset:45056
    ds_read_b64_tr_b16 v[58:59], v24 offset:46080
    ds_read_b64_tr_b16 v[60:61], v25 offset:45056
    ds_read_b64_tr_b16 v[62:63], v25 offset:46080
    s_waitcnt lgkmcnt(6)
    v_mfma_f32_32x32x16_bf16 v[64:79], v[32:35], v[40:43], v[64:79]
    v_mfma_f32_32x32x16_bf16 v[80:95], v[32:35], v[44:47], v[80:95]
    v_mfma_f32_32x32x16_bf16 v[96:111], v[36:39], v[40:43], v[96:111]
    v_mfma_f32_32x32x16_bf16 v[112:127], v[36:39], v[44:47], v[112:127]
    s_waitcnt lgkmcnt(0)
    v_mfma_f32_32x32x16_bf16 v[64:79], v[48:51], v[56:59], v[64:79]
    v_mfma_f32_32x32x16_bf16 v[80:95], v[48:51], v[60:63], v[80:95]
    v_mfma_f32_32x32x16_bf16 v[96:111], v[52:55], v[56:59], v[96:111]
    v_mfma_f32_32x32x16_bf16 v[112:127], v[52:55], v[60:63], v[112:127]
    s_barrier
    s_add_u32 m0, s13, 32768
    s_nop 0
    global_load_lds_dwordx4 v8, s[6:7]
    s_add_u32 m0, s13, 33792
    s_nop 0
    global_load_lds_dwordx4 v9, s[6:7]
    s_add_u32 m0, s13, 34816
    s_nop 0
    global_load_lds_dwordx4 v10, s[6:7]
    s_add_u32 m0, s13, 35840
    s_nop 0
    global_load_lds_dwordx4 v11, s[6:7]
    s_add_u32 m0, s13, 49152
    s_nop 0
    global_load_lds_dwordx4 v[12:13], off
    s_add_u32 m0, s13, 50176
    s_nop 0
    global_load_lds_dwordx4 v[14:15], off
    s_add_u32 m0, s13, 51200
    s_nop 0
    global_load_lds_dwordx4 v[16:17], off
    s_add_u32 m0, s13, 52224
    s_nop 0
    global_load_lds_dwordx4 v[18:19], off
    s_add_u32 s6, s6, 128
    s_addc_u32 s7, s7, 0
    v_add_co_u32 v12, vcc, 524288, v12
    v_addc_co_u32 v13, vcc, 0, v13, vcc
    v_add_co_u32 v14, vcc, 524288, v14
    v_addc_co_u32 v15, vcc, 0, v15, vcc
    v_add_co_u32 v16, vcc, 524288, v16
    v_addc_co_u32 v17, vcc, 0, v17, vcc
    v_add_co_u32 v18, vcc, 524288, v18
    v_addc_co_u32 v19, vcc, 0, v19, vcc
    s_waitcnt vmcnt(8)
    s_barrier
    ds_read_b128 v[32:35], v20 offset:0
    ds_read_b128 v[36:39], v20 offset:4096
    ds_read_b64_tr_b16 v[40:41], v24 offset:0
    ds_read_b64_tr_b16 v[42:43], v24 offset:1024
    ds_read_b64_tr_b16 v[44:45], v25 offset:0
    ds_read_b64_tr_b16 v[46:47], v25 offset:1024
    ds_read_b128 v[48:51], v21 offset:0
    ds_read_b128 v[52:55], v21 offset:4096
    ds_read_b64_tr_b16 v[56:57], v24 offset:4096
    ds_read_b64_tr_b16 v[58:59], v24 offset:5120
    ds_read_b64_tr_b16 v[60:61], v25 offset:4096
    ds_read_b64_tr_b16 v[62:63], v25 offset:5120
    s_waitcnt lgkmcnt(6)
    v_mfma_f32_32x32x16_bf16 v[64:79], v[32:35], v[40:43], v[64:79]
    v_mfma_f32_32x32x16_bf16 v[80:95], v[32:35], v[44:47], v[80:95]
    v_mfma_f32_32x32x16_bf16 v[96:111], v[36:39], v[40:43], v[96:111]
    v_mfma_f32_32x32x16_bf16 v[112:127], v[36:39], v[44:47], v[112:127]
    ds_read_b128 v[32:35], v22 offset:0
    ds_read_b128 v[36:39], v22 offset:4096
    ds_read_b64_tr_b16 v[40:41], v24 offset:8192
    ds_read_b64_tr_b16 v[42:43], v24 offset:9216
    ds_read_b64_tr_b16 v[44:45], v25 offset:8192
    ds_read_b64_tr_b16 v[46:47], v25 offset:9216
    s_waitcnt lgkmcnt(6)
    v_mfma_f32_32x32x16_bf16 v[64:79], v[48:51], v[56:59], v[64:79]
    v_mfma_f32_32x32x16_bf16 v[80:95], v[48:51], v[60:63], v[80:95]
    v_mfma_f32_32x32x16_bf16 v[96:111], v[52:55], v[56:59], v[96:111]
    v_mfma_f32_32x32x16_bf16 v[112:127], v[52:55], v[60:63], v[112:127]
    ds_read_b128 v[48:51], v23 offset:0
    ds_read_b128 v[52:55], v23 offset:4096
    ds_read_b64_tr_b16 v[56:57], v24 offset:12288
    ds_read_b64_tr_b16 v[58:59], v24 offset:13312
    ds_read_b64_tr_b16 v[60:61], v25 offset:12288
    ds_read_b64_tr_b16 v[62:63], v25 offset:13312
    s_waitcnt lgkmcnt(6)
    v_mfma_f32_32x32x16_bf16 v[64:79], v[32:35], v[40:43], v[64:79]
    v_mfma_f32_32x32x16_bf16 v[80:95], v[32:35], v[44:47], v[80:95]
    v_mfma_f32_32x32x16_bf16 v[96:111], v[36:39], v[40:43], v[96:111]
    v_mfma_f32_32x32x16_bf16 v[112:127], v[36:39], v[44:47], v[112:127]
    s_waitcnt lgkmcnt(0)
    v_mfma_f32_32x32x16_bf16 v[64:79], v[48:51], v[56:59], v[64:79]
    v_mfma_f32_32x32x16_bf16 v[80:95], v[48:51], v[60:63], v[80:95]
    v_mfma_f32_32x32x16_bf16 v[96:111], v[52:55], v[56:59], v[96:111]
    v_mfma_f32_32x32x16_bf16 v[112:127], v[52:55], v[60:63], v[112:127]
    s_barrier
    s_add_u32 m0, s13, 0
    s_nop 0
    global_load_lds_dwordx4 v8, s[6:7]
    s_add_u32 m0, s13, 1024
    s_nop 0
    global_load_lds_dwordx4 v9, s[6:7]
    s_add_u32 m0, s13, 2048
    s_nop 0
    global_load_lds_dwordx4 v10, s[6:7]
    s_add_u32 m0, s13, 3072
    s_nop 0
    global_load_lds_dwordx4 v11, s[6:7]
    s_add_u32 m0, s13, 16384
    s_nop 0
    global_load_lds_dwordx4 v[12:13], off
    s_add_u32 m0, s13, 17408
    s_nop 0
    global_load_lds_dwordx4 v[14:15], off
    s_add_u32 m0, s13, 18432
    s_nop 0
    global_load_lds_dwordx4 v[16:17], off
    s_add_u32 m0, s13, 19456
    s_nop 0
    global_load_lds_dwordx4 v[18:19], off
    s_add_u32 s6, s6, 128
    s_addc_u32 s7, s7, 0
    v_add_co_u32 v12, vcc, 524288, v12
    v_addc_co_u32 v13, vcc, 0, v13, vcc
    v_add_co_u32 v14, vcc, 524288, v14
    v_addc_co_u32 v15, vcc, 0, v15, vcc
    v_add_co_u32 v16, vcc, 524288, v16
    v_addc_co_u32 v17, vcc, 0, v17, vcc
    v_add_co_u32 v18, vcc, 524288, v18
    v_addc_co_u32 v19, vcc, 0, v19, vcc
    s_waitcnt vmcnt(8)
    s_barrier
    ds_read_b128 v[32:35], v20 offset:32768
    ds_read_b128 v[36:39], v20 offset:36864
    ds_read_b64_tr_b16 v[40:41], v24 offset:32768
    ds_read_b64_tr_b16 v[42:43], v24 offset:33792
    ds_read_b64_tr_b16 v[44:45], v25 offset:32768
    ds_read_b64_tr_b16 v[46:47], v25 offset:33792
    ds_read_b128 v[48:51], v21 offset:32768
    ds_read_b128 v[52:55], v21 offset:36864
    ds_read_b64_tr_b16 v[56:57], v24 offset:36864
    ds_read_b64_tr_b16 v[58:59], v24 offset:37888
    ds_read_b64_tr_b16 v[60:61], v25 offset:36864
    ds_read_b64_tr_b16 v[62:63], v25 offset:37888
    s_waitcnt lgkmcnt(6)
    v_mfma_f32_32x32x16_bf16 v[64:79], v[32:35], v[40:43], v[64:79]
    v_mfma_f32_32x32x16_bf16 v[80:95], v[32:35], v[44:47], v[80:95]
    v_mfma_f32_32x32x16_bf16 v[96:111], v[36:39], v[40:43], v[96:111]
    v_mfma_f32_32x32x16_bf16 v[112:127], v[36:39], v[44:47], v[112:127]
    ds_read_b128 v[32:35], v22 offset:32768
    ds_read_b128 v[36:39], v22 offset:36864
    ds_read_b64_tr_b16 v[40:41], v24 offset:40960
    ds_read_b64_tr_b16 v[42:43], v24 offset:41984
    ds_read_b64_tr_b16 v[44:45], v25 offset:40960
    ds_read_b64_tr_b16 v[46:47], v25 offset:41984
    s_waitcnt lgkmcnt(6)
    v_mfma_f32_32x32x16_bf16 v[64:79], v[48:51], v[56:59], v[64:79]
    v_mfma_f32_32x32x16_bf16 v[80:95], v[48:51], v[60:63], v[80:95]
    v_mfma_f32_32x32x16_bf16 v[96:111], v[52:55], v[56:59], v[96:111]
    v_mfma_f32_32x32x16_bf16 v[112:127], v[52:55], v[60:63], v[112:127]
    ds_read_b128 v[48:51], v23 offset:32768
    ds_read_b128 v[52:55], v23 offset:36864
    ds_read_b64_tr_b16 v[56:57], v24 offset:45056
    ds_read_b64_tr_b16 v[58:59], v24 offset:46080
    ds_read_b64_tr_b16 v[60:61], v25 offset:45056
    ds_read_b64_tr_b16 v[62:63], v25 offset:46080
    s_waitcnt lgkmcnt(6)
    v_mfma_f32_32x32x16_bf16 v[64:79], v[32:35], v[40:43], v[64:79]
    v_mfma_f32_32x32x16_bf16 v[80:95], v[32:35], v[44:47], v[80:95]
    v_mfma_f32_32x32x16_bf16 v[96:111], v[36:39], v[40:43], v[96:111]
    v_mfma_f32_32x32x16_bf16 v[112:127], v[36:39], v[44:47], v[112:127]
    s_waitcnt lgkmcnt(0)
    v_mfma_f32_32x32x16_bf16 v[64:79], v[48:51], v[56:59], v[64:79]
    v_mfma_f32_32x32x16_bf16 v[80:95], v[48:51], v[60:63], v[80:95]
    v_mfma_f32_32x32x16_bf16 v[96:111], v[52:55], v[56:59], v[96:111]
    v_mfma_f32_32x32x16_bf16 v[112:127], v[52:55], v[60:63], v[112:127]
    s_barrier
    s_waitcnt vmcnt(0)
    s_barrier
    ds_read_b128 v[32:35], v20 offset:0
    ds_read_b128 v[36:39], v20 offset:4096
    ds_read_b64_tr_b16 v[40:41], v24 offset:0
    ds_read_b64_tr_b16 v[42:43], v24 offset:1024
    ds_read_b64_tr_b16 v[44:45], v25 offset:0
    ds_read_b64_tr_b16 v[46:47], v25 offset:1024
    ds_read_b128 v[48:51], v21 offset:0
    ds_read_b128 v[52:55], v21 offset:4096
    ds_read_b64_tr_b16 v[56:57], v24 offset:4096
    ds_read_b64_tr_b16 v[58:59], v24 offset:5120
    ds_read_b64_tr_b16 v[60:61], v25 offset:4096
    ds_read_b64_tr_b16 v[62:63], v25 offset:5120
    s_waitcnt lgkmcnt(6)
    v_mfma_f32_32x32x16_bf16 v[64:79], v[32:35], v[40:43], v[64:79]
    v_mfma_f32_32x32x16_bf16 v[80:95], v[32:35], v[44:47], v[80:95]
    v_mfma_f32_32x32x16_bf16 v[96:111], v[36:39], v[40:43], v[96:111]
    v_mfma_f32_32x32x16_bf16 v[112:127], v[36:39], v[44:47], v[112:127]
    ds_read_b128 v[32:35], v22 offset:0
    ds_read_b128 v[36:39], v22 offset:4096
    ds_read_b64_tr_b16 v[40:41], v24 offset:8192
    ds_read_b64_tr_b16 v[42:43], v24 offset:9216
    ds_read_b64_tr_b16 v[44:45], v25 offset:8192
    ds_read_b64_tr_b16 v[46:47], v25 offset:9216
    s_waitcnt lgkmcnt(6)
    v_mfma_f32_32x32x16_bf16 v[64:79], v[48:51], v[56:59], v[64:79]
    v_mfma_f32_32x32x16_bf16 v[80:95], v[48:51], v[60:63], v[80:95]
    v_mfma_f32_32x32x16_bf16 v[96:111], v[52:55], v[56:59], v[96:111]
    v_mfma_f32_32x32x16_bf16 v[112:127], v[52:55], v[60:63], v[112:127]
    ds_read_b128 v[48:51], v23 offset:0
    ds_read_b128 v[52:55], v23 offset:4096
    ds_read_b64_tr_b16 v[56:57], v24 offset:12288
    ds_read_b64_tr_b16 v[58:59], v24 offset:13312
    ds_read_b64_tr_b16 v[60:61], v25 offset:12288
    ds_read_b64_tr_b16 v[62:63], v25 offset:13312
    s_waitcnt lgkmcnt(6)
    v_mfma_f32_32x32x16_bf16 v[64:79], v[32:35], v[40:43], v[64:79]
    v_mfma_f32_32x32x16_bf16 v[80:95], v[32:35], v[44:47], v[80:95]
    v_mfma_f32_32x32x16_bf16 v[96:111], v[36:39], v[40:43], v[96:111]
    v_mfma_f32_32x32x16_bf16 v[112:127], v[36:39], v[44:47], v[112:127]
    s_waitcnt lgkmcnt(0)
    v_mfma_f32_32x32x16_bf16 v[64:79], v[48:51], v[56:59], v[64:79]
    v_mfma_f32_32x32x16_bf16 v[80:95], v[48:51], v[60:63], v[80:95]
    v_mfma_f32_32x32x16_bf16 v[96:111], v[52:55], v[56:59], v[96:111]
    v_mfma_f32_32x32x16_bf16 v[112:127], v[52:55], v[60:63], v[112:127]
    s_barrier
    s_nop 15
    v_and_b32 v3, 31, v2
    v_lshrrev_b32 v4, 5, v2
    v_and_b32 v5, 1, v1
    v_lshrrev_b32 v6, 1, v1
    v_lshl_add_u32 v7, v6, 6, v3
    s_sub_u32 s18, s17, 64
    s_lshl_b32 s18, s18, 7
    v_add_u32 v7, s18, v7
    v_lshlrev_b32 v8, 12, v7
    v_lshl_add_u32 v8, v5, 7, v8
    v_lshl_add_u32 v8, v4, 3, v8
    s_lshl_b32 s18, s16, 8
    s_add_u32 s18, s18, 38289408
    s_add_u32 s22, s4, s18
    s_addc_u32 s23, s5, 0
    v_cvt_pk_bf16_f32 v10, v64, v65
    v_cvt_pk_bf16_f32 v11, v66, v67
    global_store_dwordx2 v8, v[10:11], s[22:23] offset:0
    v_cvt_pk_bf16_f32 v10, v68, v69
    v_cvt_pk_bf16_f32 v11, v70, v71
    global_store_dwordx2 v8, v[10:11], s[22:23] offset:16
    v_cvt_pk_bf16_f32 v10, v72, v73
    v_cvt_pk_bf16_f32 v11, v74, v75
    global_store_dwordx2 v8, v[10:11], s[22:23] offset:32
    v_cvt_pk_bf16_f32 v10, v76, v77
    v_cvt_pk_bf16_f32 v11, v78, v79
    global_store_dwordx2 v8, v[10:11], s[22:23] offset:48
    v_cvt_pk_bf16_f32 v10, v80, v81
    v_cvt_pk_bf16_f32 v11, v82, v83
    v_add_u32 v12, 131072, v8
    global_store_dwordx2 v12, v[10:11], s[22:23] offset:0
    v_cvt_pk_bf16_f32 v10, v84, v85
    v_cvt_pk_bf16_f32 v11, v86, v87
    v_add_u32 v12, 131072, v8
    global_store_dwordx2 v12, v[10:11], s[22:23] offset:16
    v_cvt_pk_bf16_f32 v10, v88, v89
    v_cvt_pk_bf16_f32 v11, v90, v91
    v_add_u32 v12, 131072, v8
    global_store_dwordx2 v12, v[10:11], s[22:23] offset:32
    v_cvt_pk_bf16_f32 v10, v92, v93
    v_cvt_pk_bf16_f32 v11, v94, v95
    v_add_u32 v12, 131072, v8
    global_store_dwordx2 v12, v[10:11], s[22:23] offset:48
    v_cvt_pk_bf16_f32 v10, v96, v97
    v_cvt_pk_bf16_f32 v11, v98, v99
    global_store_dwordx2 v8, v[10:11], s[22:23] offset:64
    v_cvt_pk_bf16_f32 v10, v100, v101
    v_cvt_pk_bf16_f32 v11, v102, v103
    global_store_dwordx2 v8, v[10:11], s[22:23] offset:80
    v_cvt_pk_bf16_f32 v10, v104, v105
    v_cvt_pk_bf16_f32 v11, v106, v107
    global_store_dwordx2 v8, v[10:11], s[22:23] offset:96
    v_cvt_pk_bf16_f32 v10, v108, v109
    v_cvt_pk_bf16_f32 v11, v110, v111
    global_store_dwordx2 v8, v[10:11], s[22:23] offset:112
    v_cvt_pk_bf16_f32 v10, v112, v113
    v_cvt_pk_bf16_f32 v11, v114, v115
    v_add_u32 v12, 131072, v8
    global_store_dwordx2 v12, v[10:11], s[22:23] offset:64
    v_cvt_pk_bf16_f32 v10, v116, v117
    v_cvt_pk_bf16_f32 v11, v118, v119
    v_add_u32 v12, 131072, v8
    global_store_dwordx2 v12, v[10:11], s[22:23] offset:80
    v_cvt_pk_bf16_f32 v10, v120, v121
    v_cvt_pk_bf16_f32 v11, v122, v123
    v_add_u32 v12, 131072, v8
    global_store_dwordx2 v12, v[10:11], s[22:23] offset:96
    v_cvt_pk_bf16_f32 v10, v124, v125
    v_cvt_pk_bf16_f32 v11, v126, v127
    v_add_u32 v12, 131072, v8
    global_store_dwordx2 v12, v[10:11], s[22:23] offset:112
    s_branch qkv_kernel_end
qkv_kernel_epi:
    s_nop 15
    v_and_b32 v3, 31, v2
    v_lshrrev_b32 v4, 5, v2
    v_and_b32 v5, 1, v1
    v_lshrrev_b32 v6, 1, v1
    v_lshl_add_u32 v7, v5, 6, v3
    s_lshl_b32 s18, s16, 7
    v_add_u32 v7, s18, v7
    s_lshr_b32 s18, s17, 5
    s_mul_i32 s18, s18, 16777216
    s_add_u32 s18, s18, 4734976
    s_and_b32 s19, s17, 31
    s_lshl_b32 s19, s19, 8
    s_add_u32 s18, s18, s19
    s_add_u32 s22, s4, s18
    s_addc_u32 s23, s5, 0
    s_mov_b32 s20, 8192
    v_mul_lo_u32 v8, v7, s20
    v_lshl_add_u32 v9, v6, 7, v8
    v_lshl_add_u32 v9, v4, 3, v9
    v_cvt_pk_bf16_f32 v10, v64, v65
    v_cvt_pk_bf16_f32 v11, v66, v67
    global_store_dwordx2 v9, v[10:11], s[22:23] offset:0
    v_cvt_pk_bf16_f32 v10, v68, v69
    v_cvt_pk_bf16_f32 v11, v70, v71
    global_store_dwordx2 v9, v[10:11], s[22:23] offset:16
    v_cvt_pk_bf16_f32 v10, v72, v73
    v_cvt_pk_bf16_f32 v11, v74, v75
    global_store_dwordx2 v9, v[10:11], s[22:23] offset:32
    v_cvt_pk_bf16_f32 v10, v76, v77
    v_cvt_pk_bf16_f32 v11, v78, v79
    global_store_dwordx2 v9, v[10:11], s[22:23] offset:48
    v_cvt_pk_bf16_f32 v10, v80, v81
    v_cvt_pk_bf16_f32 v11, v82, v83
    global_store_dwordx2 v9, v[10:11], s[22:23] offset:64
    v_cvt_pk_bf16_f32 v10, v84, v85
    v_cvt_pk_bf16_f32 v11, v86, v87
    global_store_dwordx2 v9, v[10:11], s[22:23] offset:80
    v_cvt_pk_bf16_f32 v10, v88, v89
    v_cvt_pk_bf16_f32 v11, v90, v91
    global_store_dwordx2 v9, v[10:11], s[22:23] offset:96
    v_cvt_pk_bf16_f32 v10, v92, v93
    v_cvt_pk_bf16_f32 v11, v94, v95
    global_store_dwordx2 v9, v[10:11], s[22:23] offset:112
    v_cvt_pk_bf16_f32 v10, v96, v97
    v_cvt_pk_bf16_f32 v11, v98, v99
    v_add_u32 v12, 262144, v9
    global_store_dwordx2 v12, v[10:11], s[22:23] offset:0
    v_cvt_pk_bf16_f32 v10, v100, v101
    v_cvt_pk_bf16_f32 v11, v102, v103
    v_add_u32 v12, 262144, v9
    global_store_dwordx2 v12, v[10:11], s[22:23] offset:16
    v_cvt_pk_bf16_f32 v10, v104, v105
    v_cvt_pk_bf16_f32 v11, v106, v107
    v_add_u32 v12, 262144, v9
    global_store_dwordx2 v12, v[10:11], s[22:23] offset:32
    v_cvt_pk_bf16_f32 v10, v108, v109
    v_cvt_pk_bf16_f32 v11, v110, v111
    v_add_u32 v12, 262144, v9
    global_store_dwordx2 v12, v[10:11], s[22:23] offset:48
    v_cvt_pk_bf16_f32 v10, v112, v113
    v_cvt_pk_bf16_f32 v11, v114, v115
    v_add_u32 v12, 262144, v9
    global_store_dwordx2 v12, v[10:11], s[22:23] offset:64
    v_cvt_pk_bf16_f32 v10, v116, v117
    v_cvt_pk_bf16_f32 v11, v118, v119
    v_add_u32 v12, 262144, v9
    global_store_dwordx2 v12, v[10:11], s[22:23] offset:80
    v_cvt_pk_bf16_f32 v10, v120, v121
    v_cvt_pk_bf16_f32 v11, v122, v123
    v_add_u32 v12, 262144, v9
    global_store_dwordx2 v12, v[10:11], s[22:23] offset:96
    v_cvt_pk_bf16_f32 v10, v124, v125
    v_cvt_pk_bf16_f32 v11, v126, v127
    v_add_u32 v12, 262144, v9
    global_store_dwordx2 v12, v[10:11], s[22:23] offset:112
qkv_kernel_end:
    s_endpgm
.globl rec_kernel
.p2align 8
.type rec_kernel,@function
rec_kernel:
    s_cmp_ge_u32 s2, 32
    s_cbranch_scc1 rec_end
    s_load_dwordx2 s[4:5], s[0:1], 120
    s_load_dwordx2 s[6:7], s[0:1], 16
    s_load_dwordx2 s[8:9], s[0:1], 24
    s_load_dwordx2 s[10:11], s[0:1], 32
    s_load_dwordx2 s[12:13], s[0:1], 40
    s_load_dwordx2 s[14:15], s[0:1], 8
    s_load_dwordx2 s[52:53], s[0:1], 112
    v_lshrrev_b32 v1, 6, v0
    v_and_b32 v2, 63, v0
    s_nop 0
    v_readfirstlane_b32 s16, v1
    s_waitcnt lgkmcnt(0)
    s_lshl_b32 s17, s16, 10
    s_mov_b32 s30, 0
    s_mov_b32 s31, 0x41400000
    s_mov_b32 s32, 0
    s_mov_b32 s33, 0x40f00000
    s_mov_b32 s34, 0
    s_mov_b32 s35, 0x40e00000
    s_mov_b32 s36, 0
    s_mov_b32 s37, 0xc1400000
    v_lshrrev_b32 v3, 4, v2
    v_and_b32 v4, 15, v2
    v_lshlrev_b32 v5, 13, v3
    v_lshl_add_u32 v5, v4, 4, v5
    v_lshl_add_u32 v5, v1, 15, v5
    v_lshrrev_b32 v6, 2, v4
    v_lshl_add_u32 v6, v3, 3, v6
    v_lshlrev_b32 v6, 8, v6
    v_and_b32 v7, 3, v2
    v_lshl_add_u32 v6, v7, 3, v6
    v_lshl_add_u32 v6, v1, 6, v6
    v_add_u32 v36, 16384, v6
    v_add_u32 v37, 65536, v6
    v_add_u32 v38, 114688, v6
    s_lshl_b32 s18, s2, 8
    s_add_u32 s6, s6, s18
    s_addc_u32 s7, s7, 0
    s_add_u32 m0, s17, 16384
    s_nop 0
    global_load_lds_dwordx4 v5, s[6:7]
    s_add_u32 s6, s6, 131072
    s_addc_u32 s7, s7, 0
    s_add_u32 m0, s17, 20480
    s_nop 0
    global_load_lds_dwordx4 v5, s[6:7]
    s_add_u32 s6, s6, 131072
    s_addc_u32 s7, s7, 0
    s_add_u32 m0, s17, 24576
    s_nop 0
    global_load_lds_dwordx4 v5, s[6:7]
    s_add_u32 s6, s6, 131072
    s_addc_u32 s7, s7, 0
    s_add_u32 m0, s17, 28672
    s_nop 0
    global_load_lds_dwordx4 v5, s[6:7]
    s_add_u32 s6, s6, 131072
    s_addc_u32 s7, s7, 0
    s_add_u32 m0, s17, 32768
    s_nop 0
    global_load_lds_dwordx4 v5, s[6:7]
    s_add_u32 s6, s6, 131072
    s_addc_u32 s7, s7, 0
    s_add_u32 m0, s17, 36864
    s_nop 0
    global_load_lds_dwordx4 v5, s[6:7]
    s_add_u32 s6, s6, 131072
    s_addc_u32 s7, s7, 0
    s_add_u32 m0, s17, 40960
    s_nop 0
    global_load_lds_dwordx4 v5, s[6:7]
    s_add_u32 s6, s6, 131072
    s_addc_u32 s7, s7, 0
    s_add_u32 m0, s17, 45056
    s_nop 0
    global_load_lds_dwordx4 v5, s[6:7]
    s_add_u32 s6, s6, 131072
    s_addc_u32 s7, s7, 0
    s_add_u32 m0, s17, 49152
    s_nop 0
    global_load_lds_dwordx4 v5, s[6:7]
    s_add_u32 s6, s6, 131072
    s_addc_u32 s7, s7, 0
    s_add_u32 m0, s17, 53248
    s_nop 0
    global_load_lds_dwordx4 v5, s[6:7]
    s_add_u32 s6, s6, 131072
    s_addc_u32 s7, s7, 0
    s_add_u32 m0, s17, 57344
    s_nop 0
    global_load_lds_dwordx4 v5, s[6:7]
    s_add_u32 s6, s6, 131072
    s_addc_u32 s7, s7, 0
    s_add_u32 m0, s17, 61440
    s_nop 0
    global_load_lds_dwordx4 v5, s[6:7]
    s_add_u32 s6, s6, 131072
    s_addc_u32 s7, s7, 0
    s_add_u32 m0, s17, 65536
    s_nop 0
    global_load_lds_dwordx4 v5, s[6:7]
    s_add_u32 s6, s6, 131072
    s_addc_u32 s7, s7, 0
    s_add_u32 m0, s17, 69632
    s_nop 0
    global_load_lds_dwordx4 v5, s[6:7]
    s_add_u32 s6, s6, 131072
    s_addc_u32 s7, s7, 0
    s_add_u32 m0, s17, 73728
    s_nop 0
    global_load_lds_dwordx4 v5, s[6:7]
    s_add_u32 s6, s6, 131072
    s_addc_u32 s7, s7, 0
    s_add_u32 m0, s17, 77824
    s_nop 0
    global_load_lds_dwordx4 v5, s[6:7]
    s_add_u32 s6, s6, 131072
    s_addc_u32 s7, s7, 0
    s_add_u32 m0, s17, 81920
    s_nop 0
    global_load_lds_dwordx4 v5, s[6:7]
    s_add_u32 s6, s6, 131072
    s_addc_u32 s7, s7, 0
    s_add_u32 m0, s17, 86016
    s_nop 0
    global_load_lds_dwordx4 v5, s[6:7]
    s_add_u32 s6, s6, 131072
    s_addc_u32 s7, s7, 0
    s_add_u32 m0, s17, 90112
    s_nop 0
    global_load_lds_dwordx4 v5, s[6:7]
    s_add_u32 s6, s6, 131072
    s_addc_u32 s7, s7, 0
    s_add_u32 m0, s17, 94208
    s_nop 0
    global_load_lds_dwordx4 v5, s[6:7]
    s_add_u32 s6, s6, 131072
    s_addc_u32 s7, s7, 0
    s_add_u32 m0, s17, 98304
    s_nop 0
    global_load_lds_dwordx4 v5, s[6:7]
    s_add_u32 s6, s6, 131072
    s_addc_u32 s7, s7, 0
    s_add_u32 m0, s17, 102400
    s_nop 0
    global_load_lds_dwordx4 v5, s[6:7]
    s_add_u32 s6, s6, 131072
    s_addc_u32 s7, s7, 0
    s_add_u32 m0, s17, 106496
    s_nop 0
    global_load_lds_dwordx4 v5, s[6:7]
    s_add_u32 s6, s6, 131072
    s_addc_u32 s7, s7, 0
    s_add_u32 m0, s17, 110592
    s_nop 0
    global_load_lds_dwordx4 v5, s[6:7]
    s_add_u32 s6, s6, 131072
    s_addc_u32 s7, s7, 0
    s_add_u32 m0, s17, 114688
    s_nop 0
    global_load_lds_dwordx4 v5, s[6:7]
    s_add_u32 s6, s6, 131072
    s_addc_u32 s7, s7, 0
    s_add_u32 m0, s17, 118784
    s_nop 0
    global_load_lds_dwordx4 v5, s[6:7]
    s_add_u32 s6, s6, 131072
    s_addc_u32 s7, s7, 0
    s_add_u32 m0, s17, 122880
    s_nop 0
    global_load_lds_dwordx4 v5, s[6:7]
    s_add_u32 s6, s6, 131072
    s_addc_u32 s7, s7, 0
    s_add_u32 m0, s17, 126976
    s_nop 0
    global_load_lds_dwordx4 v5, s[6:7]
    s_add_u32 s6, s6, 131072
    s_addc_u32 s7, s7, 0
    s_add_u32 m0, s17, 131072
    s_nop 0
    global_load_lds_dwordx4 v5, s[6:7]
    s_add_u32 s6, s6, 131072
    s_addc_u32 s7, s7, 0
    s_add_u32 m0, s17, 135168
    s_nop 0
    global_load_lds_dwordx4 v5, s[6:7]
    s_add_u32 s6, s6, 131072
    s_addc_u32 s7, s7, 0
    s_add_u32 m0, s17, 139264
    s_nop 0
    global_load_lds_dwordx4 v5, s[6:7]
    s_add_u32 s6, s6, 131072
    s_addc_u32 s7, s7, 0
    s_add_u32 m0, s17, 143360
    s_nop 0
    global_load_lds_dwordx4 v5, s[6:7]
    s_add_u32 s6, s6, 131072
    s_addc_u32 s7, s7, 0
    s_add_u32 m0, s17, 147456
    s_nop 0
    global_load_lds_dwordx4 v5, s[6:7]
    s_add_u32 s6, s6, 131072
    s_addc_u32 s7, s7, 0
    s_add_u32 m0, s17, 151552
    s_nop 0
    global_load_lds_dwordx4 v5, s[6:7]
    s_add_u32 s6, s6, 131072
    s_addc_u32 s7, s7, 0
    s_add_u32 m0, s17, 155648
    s_nop 0
    global_load_lds_dwordx4 v5, s[6:7]
    s_add_u32 s6, s6, 131072
    s_addc_u32 s7, s7, 0
    s_add_u32 m0, s17, 159744
    s_nop 0
    global_load_lds_dwordx4 v5, s[6:7]
    s_add_u32 s6, s6, 131072
    s_addc_u32 s7, s7, 0
    s_waitcnt vmcnt(0)
    s_barrier
    ds_read_b64_tr_b16 a[0:1], v36 offset:0
    ds_read_b64_tr_b16 a[2:3], v36 offset:1024
    ds_read_b64_tr_b16 a[4:5], v36 offset:8192
    ds_read_b64_tr_b16 a[6:7], v36 offset:9216
    ds_read_b64_tr_b16 a[8:9], v36 offset:16384
    ds_read_b64_tr_b16 a[10:11], v36 offset:17408
    ds_read_b64_tr_b16 a[12:13], v36 offset:24576
    ds_read_b64_tr_b16 a[14:15], v36 offset:25600
    ds_read_b64_tr_b16 a[16:17], v36 offset:32768
    ds_read_b64_tr_b16 a[18:19], v36 offset:33792
    ds_read_b64_tr_b16 a[20:21], v36 offset:40960
    ds_read_b64_tr_b16 a[22:23], v36 offset:41984
    ds_read_b64_tr_b16 a[24:25], v37 offset:0
    ds_read_b64_tr_b16 a[26:27], v37 offset:1024
    ds_read_b64_tr_b16 a[28:29], v37 offset:8192
    ds_read_b64_tr_b16 a[30:31], v37 offset:9216
    ds_read_b64_tr_b16 a[32:33], v37 offset:16384
    ds_read_b64_tr_b16 a[34:35], v37 offset:17408
    ds_read_b64_tr_b16 a[36:37], v37 offset:24576
    ds_read_b64_tr_b16 a[38:39], v37 offset:25600
    ds_read_b64_tr_b16 a[40:41], v37 offset:32768
    ds_read_b64_tr_b16 a[42:43], v37 offset:33792
    ds_read_b64_tr_b16 a[44:45], v37 offset:40960
    ds_read_b64_tr_b16 a[46:47], v37 offset:41984
    ds_read_b64_tr_b16 a[48:49], v38 offset:0
    ds_read_b64_tr_b16 a[50:51], v38 offset:1024
    ds_read_b64_tr_b16 a[52:53], v38 offset:8192
    ds_read_b64_tr_b16 a[54:55], v38 offset:9216
    ds_read_b64_tr_b16 a[56:57], v38 offset:16384
    ds_read_b64_tr_b16 a[58:59], v38 offset:17408
    ds_read_b64_tr_b16 a[60:61], v38 offset:24576
    ds_read_b64_tr_b16 a[62:63], v38 offset:25600
    ds_read_b64_tr_b16 a[64:65], v38 offset:32768
    ds_read_b64_tr_b16 a[66:67], v38 offset:33792
    ds_read_b64_tr_b16 a[68:69], v38 offset:40960
    ds_read_b64_tr_b16 a[70:71], v38 offset:41984
    ds_read_b64_tr_b16 a[72:73], v36 offset:32
    ds_read_b64_tr_b16 a[74:75], v36 offset:1056
    ds_read_b64_tr_b16 a[76:77], v36 offset:8224
    ds_read_b64_tr_b16 a[78:79], v36 offset:9248
    ds_read_b64_tr_b16 a[80:81], v36 offset:16416
    ds_read_b64_tr_b16 a[82:83], v36 offset:17440
    ds_read_b64_tr_b16 a[84:85], v36 offset:24608
    ds_read_b64_tr_b16 a[86:87], v36 offset:25632
    ds_read_b64_tr_b16 a[88:89], v36 offset:32800
    ds_read_b64_tr_b16 a[90:91], v36 offset:33824
    ds_read_b64_tr_b16 a[92:93], v36 offset:40992
    ds_read_b64_tr_b16 a[94:95], v36 offset:42016
    ds_read_b64_tr_b16 a[96:97], v37 offset:32
    ds_read_b64_tr_b16 a[98:99], v37 offset:1056
    ds_read_b64_tr_b16 a[100:101], v37 offset:8224
    ds_read_b64_tr_b16 a[102:103], v37 offset:9248
    ds_read_b64_tr_b16 a[104:105], v37 offset:16416
    ds_read_b64_tr_b16 a[106:107], v37 offset:17440
    ds_read_b64_tr_b16 a[108:109], v37 offset:24608
    ds_read_b64_tr_b16 a[110:111], v37 offset:25632
    ds_read_b64_tr_b16 a[112:113], v37 offset:32800
    ds_read_b64_tr_b16 a[114:115], v37 offset:33824
    ds_read_b64_tr_b16 a[116:117], v37 offset:40992
    ds_read_b64_tr_b16 a[118:119], v37 offset:42016
    ds_read_b64_tr_b16 a[120:121], v38 offset:32
    ds_read_b64_tr_b16 a[122:123], v38 offset:1056
    ds_read_b64_tr_b16 a[124:125], v38 offset:8224
    ds_read_b64_tr_b16 a[126:127], v38 offset:9248
    ds_read_b64_tr_b16 a[128:129], v38 offset:16416
    ds_read_b64_tr_b16 a[130:131], v38 offset:17440
    ds_read_b64_tr_b16 a[132:133], v38 offset:24608
    ds_read_b64_tr_b16 a[134:135], v38 offset:25632
    ds_read_b64_tr_b16 a[136:137], v38 offset:32800
    ds_read_b64_tr_b16 a[138:139], v38 offset:33824
    ds_read_b64_tr_b16 a[140:141], v38 offset:40992
    ds_read_b64_tr_b16 a[142:143], v38 offset:42016
    s_waitcnt lgkmcnt(0)
    s_barrier
    s_lshl_b32 s18, s2, 8
    s_add_u32 s8, s8, s18
    s_addc_u32 s9, s9, 0
    s_add_u32 m0, s17, 16384
    s_nop 0
    global_load_lds_dwordx4 v5, s[8:9]
    s_add_u32 s8, s8, 131072
    s_addc_u32 s9, s9, 0
    s_add_u32 m0, s17, 20480
    s_nop 0
    global_load_lds_dwordx4 v5, s[8:9]
    s_add_u32 s8, s8, 131072
    s_addc_u32 s9, s9, 0
    s_add_u32 m0, s17, 24576
    s_nop 0
    global_load_lds_dwordx4 v5, s[8:9]
    s_add_u32 s8, s8, 131072
    s_addc_u32 s9, s9, 0
    s_add_u32 m0, s17, 28672
    s_nop 0
    global_load_lds_dwordx4 v5, s[8:9]
    s_add_u32 s8, s8, 131072
    s_addc_u32 s9, s9, 0
    s_add_u32 m0, s17, 32768
    s_nop 0
    global_load_lds_dwordx4 v5, s[8:9]
    s_add_u32 s8, s8, 131072
    s_addc_u32 s9, s9, 0
    s_add_u32 m0, s17, 36864
    s_nop 0
    global_load_lds_dwordx4 v5, s[8:9]
    s_add_u32 s8, s8, 131072
    s_addc_u32 s9, s9, 0
    s_add_u32 m0, s17, 40960
    s_nop 0
    global_load_lds_dwordx4 v5, s[8:9]
    s_add_u32 s8, s8, 131072
    s_addc_u32 s9, s9, 0
    s_add_u32 m0, s17, 45056
    s_nop 0
    global_load_lds_dwordx4 v5, s[8:9]
    s_add_u32 s8, s8, 131072
    s_addc_u32 s9, s9, 0
    s_add_u32 m0, s17, 49152
    s_nop 0
    global_load_lds_dwordx4 v5, s[8:9]
    s_add_u32 s8, s8, 131072
    s_addc_u32 s9, s9, 0
    s_add_u32 m0, s17, 53248
    s_nop 0
    global_load_lds_dwordx4 v5, s[8:9]
    s_add_u32 s8, s8, 131072
    s_addc_u32 s9, s9, 0
    s_add_u32 m0, s17, 57344
    s_nop 0
    global_load_lds_dwordx4 v5, s[8:9]
    s_add_u32 s8, s8, 131072
    s_addc_u32 s9, s9, 0
    s_add_u32 m0, s17, 61440
    s_nop 0
    global_load_lds_dwordx4 v5, s[8:9]
    s_add_u32 s8, s8, 131072
    s_addc_u32 s9, s9, 0
    s_add_u32 m0, s17, 65536
    s_nop 0
    global_load_lds_dwordx4 v5, s[8:9]
    s_add_u32 s8, s8, 131072
    s_addc_u32 s9, s9, 0
    s_add_u32 m0, s17, 69632
    s_nop 0
    global_load_lds_dwordx4 v5, s[8:9]
    s_add_u32 s8, s8, 131072
    s_addc_u32 s9, s9, 0
    s_add_u32 m0, s17, 73728
    s_nop 0
    global_load_lds_dwordx4 v5, s[8:9]
    s_add_u32 s8, s8, 131072
    s_addc_u32 s9, s9, 0
    s_add_u32 m0, s17, 77824
    s_nop 0
    global_load_lds_dwordx4 v5, s[8:9]
    s_add_u32 s8, s8, 131072
    s_addc_u32 s9, s9, 0
    s_add_u32 m0, s17, 81920
    s_nop 0
    global_load_lds_dwordx4 v5, s[8:9]
    s_add_u32 s8, s8, 131072
    s_addc_u32 s9, s9, 0
    s_add_u32 m0, s17, 86016
    s_nop 0
    global_load_lds_dwordx4 v5, s[8:9]
    s_add_u32 s8, s8, 131072
    s_addc_u32 s9, s9, 0
    s_add_u32 m0, s17, 90112
    s_nop 0
    global_load_lds_dwordx4 v5, s[8:9]
    s_add_u32 s8, s8, 131072
    s_addc_u32 s9, s9, 0
    s_add_u32 m0, s17, 94208
    s_nop 0
    global_load_lds_dwordx4 v5, s[8:9]
    s_add_u32 s8, s8, 131072
    s_addc_u32 s9, s9, 0
    s_add_u32 m0, s17, 98304
    s_nop 0
    global_load_lds_dwordx4 v5, s[8:9]
    s_add_u32 s8, s8, 131072
    s_addc_u32 s9, s9, 0
    s_add_u32 m0, s17, 102400
    s_nop 0
    global_load_lds_dwordx4 v5, s[8:9]
    s_add_u32 s8, s8, 131072
    s_addc_u32 s9, s9, 0
    s_add_u32 m0, s17, 106496
    s_nop 0
    global_load_lds_dwordx4 v5, s[8:9]
    s_add_u32 s8, s8, 131072
    s_addc_u32 s9, s9, 0
    s_add_u32 m0, s17, 110592
    s_nop 0
    global_load_lds_dwordx4 v5, s[8:9]
    s_add_u32 s8, s8, 131072
    s_addc_u32 s9, s9, 0
    s_add_u32 m0, s17, 114688
    s_nop 0
    global_load_lds_dwordx4 v5, s[8:9]
    s_add_u32 s8, s8, 131072
    s_addc_u32 s9, s9, 0
    s_add_u32 m0, s17, 118784
    s_nop 0
    global_load_lds_dwordx4 v5, s[8:9]
    s_add_u32 s8, s8, 131072
    s_addc_u32 s9, s9, 0
    s_add_u32 m0, s17, 122880
    s_nop 0
    global_load_lds_dwordx4 v5, s[8:9]
    s_add_u32 s8, s8, 131072
    s_addc_u32 s9, s9, 0
    s_add_u32 m0, s17, 126976
    s_nop 0
    global_load_lds_dwordx4 v5, s[8:9]
    s_add_u32 s8, s8, 131072
    s_addc_u32 s9, s9, 0
    s_add_u32 m0, s17, 131072
    s_nop 0
    global_load_lds_dwordx4 v5, s[8:9]
    s_add_u32 s8, s8, 131072
    s_addc_u32 s9, s9, 0
    s_add_u32 m0, s17, 135168
    s_nop 0
    global_load_lds_dwordx4 v5, s[8:9]
    s_add_u32 s8, s8, 131072
    s_addc_u32 s9, s9, 0
    s_add_u32 m0, s17, 139264
    s_nop 0
    global_load_lds_dwordx4 v5, s[8:9]
    s_add_u32 s8, s8, 131072
    s_addc_u32 s9, s9, 0
    s_add_u32 m0, s17, 143360
    s_nop 0
    global_load_lds_dwordx4 v5, s[8:9]
    s_add_u32 s8, s8, 131072
    s_addc_u32 s9, s9, 0
    s_add_u32 m0, s17, 147456
    s_nop 0
    global_load_lds_dwordx4 v5, s[8:9]
    s_add_u32 s8, s8, 131072
    s_addc_u32 s9, s9, 0
    s_add_u32 m0, s17, 151552
    s_nop 0
    global_load_lds_dwordx4 v5, s[8:9]
    s_add_u32 s8, s8, 131072
    s_addc_u32 s9, s9, 0
    s_add_u32 m0, s17, 155648
    s_nop 0
    global_load_lds_dwordx4 v5, s[8:9]
    s_add_u32 s8, s8, 131072
    s_addc_u32 s9, s9, 0
    s_add_u32 m0, s17, 159744
    s_nop 0
    global_load_lds_dwordx4 v5, s[8:9]
    s_add_u32 s8, s8, 131072
    s_addc_u32 s9, s9, 0
    s_waitcnt vmcnt(0)
    s_barrier
    ds_read_b64_tr_b16 a[144:145], v36 offset:0
    ds_read_b64_tr_b16 a[146:147], v36 offset:1024
    ds_read_b64_tr_b16 a[148:149], v36 offset:8192
    ds_read_b64_tr_b16 a[150:151], v36 offset:9216
    ds_read_b64_tr_b16 a[152:153], v36 offset:16384
    ds_read_b64_tr_b16 a[154:155], v36 offset:17408
    ds_read_b64_tr_b16 a[156:157], v36 offset:24576
    ds_read_b64_tr_b16 a[158:159], v36 offset:25600
    ds_read_b64_tr_b16 a[160:161], v36 offset:32768
    ds_read_b64_tr_b16 a[162:163], v36 offset:33792
    ds_read_b64_tr_b16 a[164:165], v36 offset:40960
    ds_read_b64_tr_b16 a[166:167], v36 offset:41984
    ds_read_b64_tr_b16 a[168:169], v37 offset:0
    ds_read_b64_tr_b16 a[170:171], v37 offset:1024
    ds_read_b64_tr_b16 a[172:173], v37 offset:8192
    ds_read_b64_tr_b16 a[174:175], v37 offset:9216
    ds_read_b64_tr_b16 a[176:177], v37 offset:16384
    ds_read_b64_tr_b16 a[178:179], v37 offset:17408
    ds_read_b64_tr_b16 a[180:181], v37 offset:24576
    ds_read_b64_tr_b16 a[182:183], v37 offset:25600
    ds_read_b64_tr_b16 a[184:185], v37 offset:32768
    ds_read_b64_tr_b16 a[186:187], v37 offset:33792
    ds_read_b64_tr_b16 a[188:189], v37 offset:40960
    ds_read_b64_tr_b16 a[190:191], v37 offset:41984
    ds_read_b64_tr_b16 a[192:193], v38 offset:0
    ds_read_b64_tr_b16 a[194:195], v38 offset:1024
    ds_read_b64_tr_b16 a[196:197], v38 offset:8192
    ds_read_b64_tr_b16 a[198:199], v38 offset:9216
    ds_read_b64_tr_b16 a[200:201], v38 offset:16384
    ds_read_b64_tr_b16 a[202:203], v38 offset:17408
    ds_read_b64_tr_b16 a[204:205], v38 offset:24576
    ds_read_b64_tr_b16 a[206:207], v38 offset:25600
    ds_read_b64_tr_b16 a[208:209], v38 offset:32768
    ds_read_b64_tr_b16 a[210:211], v38 offset:33792
    ds_read_b64_tr_b16 a[212:213], v38 offset:40960
    ds_read_b64_tr_b16 a[214:215], v38 offset:41984
    ds_read_b64_tr_b16 a[216:217], v36 offset:32
    ds_read_b64_tr_b16 a[218:219], v36 offset:1056
    ds_read_b64_tr_b16 a[220:221], v36 offset:8224
    ds_read_b64_tr_b16 a[222:223], v36 offset:9248
    ds_read_b64_tr_b16 a[224:225], v36 offset:16416
    ds_read_b64_tr_b16 a[226:227], v36 offset:17440
    ds_read_b64_tr_b16 a[228:229], v36 offset:24608
    ds_read_b64_tr_b16 a[230:231], v36 offset:25632
    ds_read_b64_tr_b16 a[232:233], v36 offset:32800
    ds_read_b64_tr_b16 a[234:235], v36 offset:33824
    ds_read_b64_tr_b16 a[236:237], v36 offset:40992
    ds_read_b64_tr_b16 a[238:239], v36 offset:42016
    ds_read_b64_tr_b16 a[240:241], v37 offset:32
    ds_read_b64_tr_b16 a[242:243], v37 offset:1056
    ds_read_b64_tr_b16 a[244:245], v37 offset:8224
    ds_read_b64_tr_b16 a[246:247], v37 offset:9248
    ds_read_b64_tr_b16 a[248:249], v37 offset:16416
    ds_read_b64_tr_b16 a[250:251], v37 offset:17440
    ds_read_b64_tr_b16 a[252:253], v37 offset:24608
    ds_read_b64_tr_b16 a[254:255], v37 offset:25632
    ds_read_b64_tr_b16 v[80:81], v37 offset:32800
    ds_read_b64_tr_b16 v[82:83], v37 offset:33824
    ds_read_b64_tr_b16 v[84:85], v37 offset:40992
    ds_read_b64_tr_b16 v[86:87], v37 offset:42016
    ds_read_b64_tr_b16 v[88:89], v38 offset:32
    ds_read_b64_tr_b16 v[90:91], v38 offset:1056
    ds_read_b64_tr_b16 v[92:93], v38 offset:8224
    ds_read_b64_tr_b16 v[94:95], v38 offset:9248
    ds_read_b64_tr_b16 v[96:97], v38 offset:16416
    ds_read_b64_tr_b16 v[98:99], v38 offset:17440
    ds_read_b64_tr_b16 v[100:101], v38 offset:24608
    ds_read_b64_tr_b16 v[102:103], v38 offset:25632
    ds_read_b64_tr_b16 v[104:105], v38 offset:32800
    ds_read_b64_tr_b16 v[106:107], v38 offset:33824
    ds_read_b64_tr_b16 v[108:109], v38 offset:40992
    ds_read_b64_tr_b16 v[110:111], v38 offset:42016
    s_waitcnt lgkmcnt(0)
    s_barrier
    s_lshl_b32 s18, s2, 8
    s_add_u32 s10, s10, s18
    s_addc_u32 s11, s11, 0
    s_add_u32 m0, s17, 16384
    s_nop 0
    global_load_lds_dwordx4 v5, s[10:11]
    s_add_u32 s10, s10, 131072
    s_addc_u32 s11, s11, 0
    s_add_u32 m0, s17, 20480
    s_nop 0
    global_load_lds_dwordx4 v5, s[10:11]
    s_add_u32 s10, s10, 131072
    s_addc_u32 s11, s11, 0
    s_add_u32 m0, s17, 24576
    s_nop 0
    global_load_lds_dwordx4 v5, s[10:11]
    s_add_u32 s10, s10, 131072
    s_addc_u32 s11, s11, 0
    s_add_u32 m0, s17, 28672
    s_nop 0
    global_load_lds_dwordx4 v5, s[10:11]
    s_add_u32 s10, s10, 131072
    s_addc_u32 s11, s11, 0
    s_add_u32 m0, s17, 32768
    s_nop 0
    global_load_lds_dwordx4 v5, s[10:11]
    s_add_u32 s10, s10, 131072
    s_addc_u32 s11, s11, 0
    s_add_u32 m0, s17, 36864
    s_nop 0
    global_load_lds_dwordx4 v5, s[10:11]
    s_add_u32 s10, s10, 131072
    s_addc_u32 s11, s11, 0
    s_add_u32 m0, s17, 40960
    s_nop 0
    global_load_lds_dwordx4 v5, s[10:11]
    s_add_u32 s10, s10, 131072
    s_addc_u32 s11, s11, 0
    s_add_u32 m0, s17, 45056
    s_nop 0
    global_load_lds_dwordx4 v5, s[10:11]
    s_add_u32 s10, s10, 131072
    s_addc_u32 s11, s11, 0
    s_add_u32 m0, s17, 49152
    s_nop 0
    global_load_lds_dwordx4 v5, s[10:11]
    s_add_u32 s10, s10, 131072
    s_addc_u32 s11, s11, 0
    s_add_u32 m0, s17, 53248
    s_nop 0
    global_load_lds_dwordx4 v5, s[10:11]
    s_add_u32 s10, s10, 131072
    s_addc_u32 s11, s11, 0
    s_add_u32 m0, s17, 57344
    s_nop 0
    global_load_lds_dwordx4 v5, s[10:11]
    s_add_u32 s10, s10, 131072
    s_addc_u32 s11, s11, 0
    s_add_u32 m0, s17, 61440
    s_nop 0
    global_load_lds_dwordx4 v5, s[10:11]
    s_add_u32 s10, s10, 131072
    s_addc_u32 s11, s11, 0
    s_add_u32 m0, s17, 65536
    s_nop 0
    global_load_lds_dwordx4 v5, s[10:11]
    s_add_u32 s10, s10, 131072
    s_addc_u32 s11, s11, 0
    s_add_u32 m0, s17, 69632
    s_nop 0
    global_load_lds_dwordx4 v5, s[10:11]
    s_add_u32 s10, s10, 131072
    s_addc_u32 s11, s11, 0
    s_add_u32 m0, s17, 73728
    s_nop 0
    global_load_lds_dwordx4 v5, s[10:11]
    s_add_u32 s10, s10, 131072
    s_addc_u32 s11, s11, 0
    s_add_u32 m0, s17, 77824
    s_nop 0
    global_load_lds_dwordx4 v5, s[10:11]
    s_add_u32 s10, s10, 131072
    s_addc_u32 s11, s11, 0
    s_add_u32 m0, s17, 81920
    s_nop 0
    global_load_lds_dwordx4 v5, s[10:11]
    s_add_u32 s10, s10, 131072
    s_addc_u32 s11, s11, 0
    s_add_u32 m0, s17, 86016
    s_nop 0
    global_load_lds_dwordx4 v5, s[10:11]
    s_add_u32 s10, s10, 131072
    s_addc_u32 s11, s11, 0
    s_add_u32 m0, s17, 90112
    s_nop 0
    global_load_lds_dwordx4 v5, s[10:11]
    s_add_u32 s10, s10, 131072
    s_addc_u32 s11, s11, 0
    s_add_u32 m0, s17, 94208
    s_nop 0
    global_load_lds_dwordx4 v5, s[10:11]
    s_add_u32 s10, s10, 131072
    s_addc_u32 s11, s11, 0
    s_add_u32 m0, s17, 98304
    s_nop 0
    global_load_lds_dwordx4 v5, s[10:11]
    s_add_u32 s10, s10, 131072
    s_addc_u32 s11, s11, 0
    s_add_u32 m0, s17, 102400
    s_nop 0
    global_load_lds_dwordx4 v5, s[10:11]
    s_add_u32 s10, s10, 131072
    s_addc_u32 s11, s11, 0
    s_add_u32 m0, s17, 106496
    s_nop 0
    global_load_lds_dwordx4 v5, s[10:11]
    s_add_u32 s10, s10, 131072
    s_addc_u32 s11, s11, 0
    s_add_u32 m0, s17, 110592
    s_nop 0
    global_load_lds_dwordx4 v5, s[10:11]
    s_add_u32 s10, s10, 131072
    s_addc_u32 s11, s11, 0
    s_add_u32 m0, s17, 114688
    s_nop 0
    global_load_lds_dwordx4 v5, s[10:11]
    s_add_u32 s10, s10, 131072
    s_addc_u32 s11, s11, 0
    s_add_u32 m0, s17, 118784
    s_nop 0
    global_load_lds_dwordx4 v5, s[10:11]
    s_add_u32 s10, s10, 131072
    s_addc_u32 s11, s11, 0
    s_add_u32 m0, s17, 122880
    s_nop 0
    global_load_lds_dwordx4 v5, s[10:11]
    s_add_u32 s10, s10, 131072
    s_addc_u32 s11, s11, 0
    s_add_u32 m0, s17, 126976
    s_nop 0
    global_load_lds_dwordx4 v5, s[10:11]
    s_add_u32 s10, s10, 131072
    s_addc_u32 s11, s11, 0
    s_add_u32 m0, s17, 131072
    s_nop 0
    global_load_lds_dwordx4 v5, s[10:11]
    s_add_u32 s10, s10, 131072
    s_addc_u32 s11, s11, 0
    s_add_u32 m0, s17, 135168
    s_nop 0
    global_load_lds_dwordx4 v5, s[10:11]
    s_add_u32 s10, s10, 131072
    s_addc_u32 s11, s11, 0
    s_add_u32 m0, s17, 139264
    s_nop 0
    global_load_lds_dwordx4 v5, s[10:11]
    s_add_u32 s10, s10, 131072
    s_addc_u32 s11, s11, 0
    s_add_u32 m0, s17, 143360
    s_nop 0
    global_load_lds_dwordx4 v5, s[10:11]
    s_add_u32 s10, s10, 131072
    s_addc_u32 s11, s11, 0
    s_add_u32 m0, s17, 147456
    s_nop 0
    global_load_lds_dwordx4 v5, s[10:11]
    s_add_u32 s10, s10, 131072
    s_addc_u32 s11, s11, 0
    s_add_u32 m0, s17, 151552
    s_nop 0
    global_load_lds_dwordx4 v5, s[10:11]
    s_add_u32 s10, s10, 131072
    s_addc_u32 s11, s11, 0
    s_add_u32 m0, s17, 155648
    s_nop 0
    global_load_lds_dwordx4 v5, s[10:11]
    s_add_u32 s10, s10, 131072
    s_addc_u32 s11, s11, 0
    s_add_u32 m0, s17, 159744
    s_nop 0
    global_load_lds_dwordx4 v5, s[10:11]
    s_add_u32 s10, s10, 131072
    s_addc_u32 s11, s11, 0
    s_waitcnt vmcnt(0)
    s_barrier
    ds_read_b64_tr_b16 v[112:113], v36 offset:0
    ds_read_b64_tr_b16 v[114:115], v36 offset:1024
    ds_read_b64_tr_b16 v[116:117], v36 offset:8192
    ds_read_b64_tr_b16 v[118:119], v36 offset:9216
    ds_read_b64_tr_b16 v[120:121], v36 offset:16384
    ds_read_b64_tr_b16 v[122:123], v36 offset:17408
    ds_read_b64_tr_b16 v[124:125], v36 offset:24576
    ds_read_b64_tr_b16 v[126:127], v36 offset:25600
    ds_read_b64_tr_b16 v[128:129], v36 offset:32768
    ds_read_b64_tr_b16 v[130:131], v36 offset:33792
    ds_read_b64_tr_b16 v[132:133], v36 offset:40960
    ds_read_b64_tr_b16 v[134:135], v36 offset:41984
    ds_read_b64_tr_b16 v[136:137], v37 offset:0
    ds_read_b64_tr_b16 v[138:139], v37 offset:1024
    ds_read_b64_tr_b16 v[140:141], v37 offset:8192
    ds_read_b64_tr_b16 v[142:143], v37 offset:9216
    ds_read_b64_tr_b16 v[144:145], v37 offset:16384
    ds_read_b64_tr_b16 v[146:147], v37 offset:17408
    ds_read_b64_tr_b16 v[148:149], v37 offset:24576
    ds_read_b64_tr_b16 v[150:151], v37 offset:25600
    ds_read_b64_tr_b16 v[152:153], v37 offset:32768
    ds_read_b64_tr_b16 v[154:155], v37 offset:33792
    ds_read_b64_tr_b16 v[156:157], v37 offset:40960
    ds_read_b64_tr_b16 v[158:159], v37 offset:41984
    ds_read_b64_tr_b16 v[160:161], v38 offset:0
    ds_read_b64_tr_b16 v[162:163], v38 offset:1024
    ds_read_b64_tr_b16 v[164:165], v38 offset:8192
    ds_read_b64_tr_b16 v[166:167], v38 offset:9216
    ds_read_b64_tr_b16 v[168:169], v38 offset:16384
    ds_read_b64_tr_b16 v[170:171], v38 offset:17408
    ds_read_b64_tr_b16 v[172:173], v38 offset:24576
    ds_read_b64_tr_b16 v[174:175], v38 offset:25600
    ds_read_b64_tr_b16 v[176:177], v38 offset:32768
    ds_read_b64_tr_b16 v[178:179], v38 offset:33792
    ds_read_b64_tr_b16 v[180:181], v38 offset:40960
    ds_read_b64_tr_b16 v[182:183], v38 offset:41984
    ds_read_b64_tr_b16 v[184:185], v36 offset:32
    ds_read_b64_tr_b16 v[186:187], v36 offset:1056
    ds_read_b64_tr_b16 v[188:189], v36 offset:8224
    ds_read_b64_tr_b16 v[190:191], v36 offset:9248
    ds_read_b64_tr_b16 v[192:193], v36 offset:16416
    ds_read_b64_tr_b16 v[194:195], v36 offset:17440
    ds_read_b64_tr_b16 v[196:197], v36 offset:24608
    ds_read_b64_tr_b16 v[198:199], v36 offset:25632
    ds_read_b64_tr_b16 v[200:201], v36 offset:32800
    ds_read_b64_tr_b16 v[202:203], v36 offset:33824
    ds_read_b64_tr_b16 v[204:205], v36 offset:40992
    ds_read_b64_tr_b16 v[206:207], v36 offset:42016
    ds_read_b64_tr_b16 v[208:209], v37 offset:32
    ds_read_b64_tr_b16 v[210:211], v37 offset:1056
    ds_read_b64_tr_b16 v[212:213], v37 offset:8224
    ds_read_b64_tr_b16 v[214:215], v37 offset:9248
    ds_read_b64_tr_b16 v[216:217], v37 offset:16416
    ds_read_b64_tr_b16 v[218:219], v37 offset:17440
    ds_read_b64_tr_b16 v[220:221], v37 offset:24608
    ds_read_b64_tr_b16 v[222:223], v37 offset:25632
    ds_read_b64_tr_b16 v[224:225], v37 offset:32800
    ds_read_b64_tr_b16 v[226:227], v37 offset:33824
    ds_read_b64_tr_b16 v[228:229], v37 offset:40992
    ds_read_b64_tr_b16 v[230:231], v37 offset:42016
    ds_read_b64_tr_b16 v[232:233], v38 offset:32
    ds_read_b64_tr_b16 v[234:235], v38 offset:1056
    ds_read_b64_tr_b16 v[236:237], v38 offset:8224
    ds_read_b64_tr_b16 v[238:239], v38 offset:9248
    ds_read_b64_tr_b16 v[240:241], v38 offset:16416
    ds_read_b64_tr_b16 v[242:243], v38 offset:17440
    ds_read_b64_tr_b16 v[244:245], v38 offset:24608
    ds_read_b64_tr_b16 v[246:247], v38 offset:25632
    ds_read_b64_tr_b16 v[248:249], v38 offset:32800
    ds_read_b64_tr_b16 v[250:251], v38 offset:33824
    ds_read_b64_tr_b16 v[252:253], v38 offset:40992
    ds_read_b64_tr_b16 v[254:255], v38 offset:42016
    s_waitcnt lgkmcnt(0)
    s_barrier
    s_mul_i32 s18, s2, 147456
    s_add_u32 s12, s12, s18
    s_addc_u32 s13, s13, 0
    v_lshlrev_b32 v5, 4, v2
    v_lshl_add_u32 v5, v1, 10, v5
    s_add_u32 m0, s17, 16384
    s_nop 0
    global_load_lds_dwordx4 v5, s[12:13]
    s_add_u32 s12, s12, 4096
    s_addc_u32 s13, s13, 0
    s_add_u32 m0, s17, 20480
    s_nop 0
    global_load_lds_dwordx4 v5, s[12:13]
    s_add_u32 s12, s12, 4096
    s_addc_u32 s13, s13, 0
    s_add_u32 m0, s17, 24576
    s_nop 0
    global_load_lds_dwordx4 v5, s[12:13]
    s_add_u32 s12, s12, 4096
    s_addc_u32 s13, s13, 0
    s_add_u32 m0, s17, 28672
    s_nop 0
    global_load_lds_dwordx4 v5, s[12:13]
    s_add_u32 s12, s12, 4096
    s_addc_u32 s13, s13, 0
    s_add_u32 m0, s17, 32768
    s_nop 0
    global_load_lds_dwordx4 v5, s[12:13]
    s_add_u32 s12, s12, 4096
    s_addc_u32 s13, s13, 0
    s_add_u32 m0, s17, 36864
    s_nop 0
    global_load_lds_dwordx4 v5, s[12:13]
    s_add_u32 s12, s12, 4096
    s_addc_u32 s13, s13, 0
    s_add_u32 m0, s17, 40960
    s_nop 0
    global_load_lds_dwordx4 v5, s[12:13]
    s_add_u32 s12, s12, 4096
    s_addc_u32 s13, s13, 0
    s_add_u32 m0, s17, 45056
    s_nop 0
    global_load_lds_dwordx4 v5, s[12:13]
    s_add_u32 s12, s12, 4096
    s_addc_u32 s13, s13, 0
    s_add_u32 m0, s17, 49152
    s_nop 0
    global_load_lds_dwordx4 v5, s[12:13]
    s_add_u32 s12, s12, 4096
    s_addc_u32 s13, s13, 0
    s_add_u32 m0, s17, 53248
    s_nop 0
    global_load_lds_dwordx4 v5, s[12:13]
    s_add_u32 s12, s12, 4096
    s_addc_u32 s13, s13, 0
    s_add_u32 m0, s17, 57344
    s_nop 0
    global_load_lds_dwordx4 v5, s[12:13]
    s_add_u32 s12, s12, 4096
    s_addc_u32 s13, s13, 0
    s_add_u32 m0, s17, 61440
    s_nop 0
    global_load_lds_dwordx4 v5, s[12:13]
    s_add_u32 s12, s12, 4096
    s_addc_u32 s13, s13, 0
    s_add_u32 m0, s17, 65536
    s_nop 0
    global_load_lds_dwordx4 v5, s[12:13]
    s_add_u32 s12, s12, 4096
    s_addc_u32 s13, s13, 0
    s_add_u32 m0, s17, 69632
    s_nop 0
    global_load_lds_dwordx4 v5, s[12:13]
    s_add_u32 s12, s12, 4096
    s_addc_u32 s13, s13, 0
    s_add_u32 m0, s17, 73728
    s_nop 0
    global_load_lds_dwordx4 v5, s[12:13]
    s_add_u32 s12, s12, 4096
    s_addc_u32 s13, s13, 0
    s_add_u32 m0, s17, 77824
    s_nop 0
    global_load_lds_dwordx4 v5, s[12:13]
    s_add_u32 s12, s12, 4096
    s_addc_u32 s13, s13, 0
    s_add_u32 m0, s17, 81920
    s_nop 0
    global_load_lds_dwordx4 v5, s[12:13]
    s_add_u32 s12, s12, 4096
    s_addc_u32 s13, s13, 0
    s_add_u32 m0, s17, 86016
    s_nop 0
    global_load_lds_dwordx4 v5, s[12:13]
    s_add_u32 s12, s12, 4096
    s_addc_u32 s13, s13, 0
    s_add_u32 m0, s17, 90112
    s_nop 0
    global_load_lds_dwordx4 v5, s[12:13]
    s_add_u32 s12, s12, 4096
    s_addc_u32 s13, s13, 0
    s_add_u32 m0, s17, 94208
    s_nop 0
    global_load_lds_dwordx4 v5, s[12:13]
    s_add_u32 s12, s12, 4096
    s_addc_u32 s13, s13, 0
    s_add_u32 m0, s17, 98304
    s_nop 0
    global_load_lds_dwordx4 v5, s[12:13]
    s_add_u32 s12, s12, 4096
    s_addc_u32 s13, s13, 0
    s_add_u32 m0, s17, 102400
    s_nop 0
    global_load_lds_dwordx4 v5, s[12:13]
    s_add_u32 s12, s12, 4096
    s_addc_u32 s13, s13, 0
    s_add_u32 m0, s17, 106496
    s_nop 0
    global_load_lds_dwordx4 v5, s[12:13]
    s_add_u32 s12, s12, 4096
    s_addc_u32 s13, s13, 0
    s_add_u32 m0, s17, 110592
    s_nop 0
    global_load_lds_dwordx4 v5, s[12:13]
    s_add_u32 s12, s12, 4096
    s_addc_u32 s13, s13, 0
    s_add_u32 m0, s17, 114688
    s_nop 0
    global_load_lds_dwordx4 v5, s[12:13]
    s_add_u32 s12, s12, 4096
    s_addc_u32 s13, s13, 0
    s_add_u32 m0, s17, 118784
    s_nop 0
    global_load_lds_dwordx4 v5, s[12:13]
    s_add_u32 s12, s12, 4096
    s_addc_u32 s13, s13, 0
    s_add_u32 m0, s17, 122880
    s_nop 0
    global_load_lds_dwordx4 v5, s[12:13]
    s_add_u32 s12, s12, 4096
    s_addc_u32 s13, s13, 0
    s_add_u32 m0, s17, 126976
    s_nop 0
    global_load_lds_dwordx4 v5, s[12:13]
    s_add_u32 s12, s12, 4096
    s_addc_u32 s13, s13, 0
    s_add_u32 m0, s17, 131072
    s_nop 0
    global_load_lds_dwordx4 v5, s[12:13]
    s_add_u32 s12, s12, 4096
    s_addc_u32 s13, s13, 0
    s_add_u32 m0, s17, 135168
    s_nop 0
    global_load_lds_dwordx4 v5, s[12:13]
    s_add_u32 s12, s12, 4096
    s_addc_u32 s13, s13, 0
    s_add_u32 m0, s17, 139264
    s_nop 0
    global_load_lds_dwordx4 v5, s[12:13]
    s_add_u32 s12, s12, 4096
    s_addc_u32 s13, s13, 0
    s_add_u32 m0, s17, 143360
    s_nop 0
    global_load_lds_dwordx4 v5, s[12:13]
    s_add_u32 s12, s12, 4096
    s_addc_u32 s13, s13, 0
    s_add_u32 m0, s17, 147456
    s_nop 0
    global_load_lds_dwordx4 v5, s[12:13]
    s_add_u32 s12, s12, 4096
    s_addc_u32 s13, s13, 0
    s_add_u32 m0, s17, 151552
    s_nop 0
    global_load_lds_dwordx4 v5, s[12:13]
    s_add_u32 s12, s12, 4096
    s_addc_u32 s13, s13, 0
    s_add_u32 m0, s17, 155648
    s_nop 0
    global_load_lds_dwordx4 v5, s[12:13]
    s_add_u32 s12, s12, 4096
    s_addc_u32 s13, s13, 0
    s_add_u32 m0, s17, 159744
    s_nop 0
    global_load_lds_dwordx4 v5, s[12:13]
    s_add_u32 s12, s12, 4096
    s_addc_u32 s13, s13, 0
    s_add_u32 s40, s4, 16384
    s_addc_u32 s41, s5, 0
    s_lshl_b32 s18, s2, 8
    s_add_u32 s18, s18, 21512192
    s_add_u32 s42, s4, s18
    s_addc_u32 s43, s5, 0
    s_mul_i32 s18, s2, 524288
    s_add_u32 s18, s18, 38289408
    s_add_u32 s44, s4, s18
    s_addc_u32 s45, s5, 0
    s_lshl_b32 s18, s2, 11
    s_add_u32 s18, s18, 55066624
    s_add_u32 s46, s4, s18
    s_addc_u32 s47, s5, 0
    s_lshl_b32 s18, s2, 11
    s_add_u32 s18, s18, 59260928
    s_add_u32 s48, s4, s18
    s_addc_u32 s49, s5, 0
    s_mov_b32 s20, 0
    v_lshlrev_b32 v3, 4, v0
    global_load_dwordx4 v[8:11], v3, s[14:15] offset:0
    s_waitcnt vmcnt(0)
    ds_write_b128 v3, v[8:11] offset:0
    v_add_u32 v4, 4096, v3
    global_load_dwordx4 v[8:11], v4, s[14:15]
    s_waitcnt vmcnt(0)
    ds_write_b128 v3, v[8:11] offset:4096
    v_cmp_gt_u32 vcc, 64, v0
    s_and_saveexec_b64 s[24:25], vcc
    v_add_u32 v4, 8192, v3
    global_load_dwordx4 v[8:11], v4, s[14:15]
    s_waitcnt vmcnt(0)
    ds_write_b128 v3, v[8:11] offset:8192
    s_mov_b64 exec, s[24:25]
    s_waitcnt vmcnt(0) lgkmcnt(0)
    s_barrier
    s_branch rec_compute
rec_loop:
    v_lshlrev_b32 v3, 4, v0
    s_mov_b32 s56, s40
    s_mov_b32 s57, s41
    s_mov_b32 s58, 0
    v_mov_b32 v44, 0
    v_mov_b32 v45, 0
    v_mov_b32 v46, 0
    v_mov_b32 v47, 0
    v_mov_b32 v48, 0
    v_mov_b32 v49, 0
    v_mov_b32 v50, 0
    v_mov_b32 v51, 0
    v_mov_b32 v52, 0
    v_mov_b32 v53, 0
    v_mov_b32 v54, 0
    v_mov_b32 v55, 0
    v_mov_b32 v56, 0
    v_mov_b32 v57, 0
    v_mov_b32 v58, 0
    v_mov_b32 v59, 0
    v_mov_b32 v60, 0
    v_mov_b32 v61, 0
    v_mov_b32 v62, 0
    v_mov_b32 v63, 0
    v_mov_b32 v64, 0
    v_mov_b32 v65, 0
    v_mov_b32 v66, 0
    v_mov_b32 v67, 0
    v_mov_b32 v68, 0
    v_mov_b32 v69, 0
    v_mov_b32 v70, 0
    v_mov_b32 v71, 0
    v_mov_b32 v72, 0
    v_mov_b32 v73, 0
    v_mov_b32 v74, 0
    v_mov_b32 v75, 0
    v_mov_b32 v76, 0
    v_mov_b32 v77, 0
    v_mov_b32 v78, 0
    v_mov_b32 v79, 0
rec_rep:
    s_mov_b32 s21, 0
rec_poll:
    global_load_dwordx4 v[8:11], v3, s[56:57] offset:0 sc1
    v_add_u32 v4, 4096, v3
    global_load_dwordx4 v[12:15], v4, s[56:57] sc1
    v_add_u32 v4, 8192, v3
    global_load_dwordx4 v[16:19], v4, s[56:57] sc1
    v_add_u32 v4, 12288, v3
    global_load_dwordx4 v[20:23], v4, s[56:57] sc1
    v_add_u32 v4, 16384, v3
    global_load_dwordx4 v[24:27], v4, s[56:57] sc1
    v_add_u32 v4, 20480, v3
    global_load_dwordx4 v[28:31], v4, s[56:57] sc1
    v_add_u32 v4, 24576, v3
    global_load_dwordx4 v[32:35], v4, s[56:57] sc1
    v_add_u32 v4, 28672, v3
    global_load_dwordx4 v[36:39], v4, s[56:57] sc1
    v_add_u32 v4, 32768, v3
    global_load_dwordx4 v[40:43], v4, s[56:57] sc1
    s_waitcnt vmcnt(0)
    s_mov_b64 s[26:27], -1
    v_add_f64 v[8:9], v[8:9], s[36:37]
    v_cmp_lt_f64 vcc, |v[8:9]|, s[34:35]
    s_and_b64 s[26:27], s[26:27], vcc
    v_add_f64 v[10:11], v[10:11], s[36:37]
    v_cmp_lt_f64 vcc, |v[10:11]|, s[34:35]
    s_and_b64 s[26:27], s[26:27], vcc
    v_add_f64 v[12:13], v[12:13], s[36:37]
    v_cmp_lt_f64 vcc, |v[12:13]|, s[34:35]
    s_and_b64 s[26:27], s[26:27], vcc
    v_add_f64 v[14:15], v[14:15], s[36:37]
    v_cmp_lt_f64 vcc, |v[14:15]|, s[34:35]
    s_and_b64 s[26:27], s[26:27], vcc
    v_add_f64 v[16:17], v[16:17], s[36:37]
    v_cmp_lt_f64 vcc, |v[16:17]|, s[34:35]
    s_and_b64 s[26:27], s[26:27], vcc
    v_add_f64 v[18:19], v[18:19], s[36:37]
    v_cmp_lt_f64 vcc, |v[18:19]|, s[34:35]
    s_and_b64 s[26:27], s[26:27], vcc
    v_add_f64 v[20:21], v[20:21], s[36:37]
    v_cmp_lt_f64 vcc, |v[20:21]|, s[34:35]
    s_and_b64 s[26:27], s[26:27], vcc
    v_add_f64 v[22:23], v[22:23], s[36:37]
    v_cmp_lt_f64 vcc, |v[22:23]|, s[34:35]
    s_and_b64 s[26:27], s[26:27], vcc
    v_add_f64 v[24:25], v[24:25], s[36:37]
    v_cmp_lt_f64 vcc, |v[24:25]|, s[34:35]
    s_and_b64 s[26:27], s[26:27], vcc
    v_add_f64 v[26:27], v[26:27], s[36:37]
    v_cmp_lt_f64 vcc, |v[26:27]|, s[34:35]
    s_and_b64 s[26:27], s[26:27], vcc
    v_add_f64 v[28:29], v[28:29], s[36:37]
    v_cmp_lt_f64 vcc, |v[28:29]|, s[34:35]
    s_and_b64 s[26:27], s[26:27], vcc
    v_add_f64 v[30:31], v[30:31], s[36:37]
    v_cmp_lt_f64 vcc, |v[30:31]|, s[34:35]
    s_and_b64 s[26:27], s[26:27], vcc
    v_add_f64 v[32:33], v[32:33], s[36:37]
    v_cmp_lt_f64 vcc, |v[32:33]|, s[34:35]
    s_and_b64 s[26:27], s[26:27], vcc
    v_add_f64 v[34:35], v[34:35], s[36:37]
    v_cmp_lt_f64 vcc, |v[34:35]|, s[34:35]
    s_and_b64 s[26:27], s[26:27], vcc
    v_add_f64 v[36:37], v[36:37], s[36:37]
    v_cmp_lt_f64 vcc, |v[36:37]|, s[34:35]
    s_and_b64 s[26:27], s[26:27], vcc
    v_add_f64 v[38:39], v[38:39], s[36:37]
    v_cmp_lt_f64 vcc, |v[38:39]|, s[34:35]
    s_and_b64 s[26:27], s[26:27], vcc
    v_add_f64 v[40:41], v[40:41], s[36:37]
    v_cmp_lt_f64 vcc, |v[40:41]|, s[34:35]
    s_and_b64 s[26:27], s[26:27], vcc
    v_add_f64 v[42:43], v[42:43], s[36:37]
    v_cmp_lt_f64 vcc, |v[42:43]|, s[34:35]
    s_and_b64 s[26:27], s[26:27], vcc
    s_cmp_eq_u64 s[26:27], exec
    s_cbranch_scc1 rec_got
    s_add_u32 s21, s21, 1
    s_cmp_lt_u32 s21, 5000
    s_cbranch_scc0 rec_got
    s_sleep 1
    s_branch rec_poll
rec_got:
    v_add_f64 v[44:45], v[44:45], v[8:9]
    v_add_f64 v[46:47], v[46:47], v[10:11]
    v_add_f64 v[48:49], v[48:49], v[12:13]
    v_add_f64 v[50:51], v[50:51], v[14:15]
    v_add_f64 v[52:53], v[52:53], v[16:17]
    v_add_f64 v[54:55], v[54:55], v[18:19]
    v_add_f64 v[56:57], v[56:57], v[20:21]
    v_add_f64 v[58:59], v[58:59], v[22:23]
    v_add_f64 v[60:61], v[60:61], v[24:25]
    v_add_f64 v[62:63], v[62:63], v[26:27]
    v_add_f64 v[64:65], v[64:65], v[28:29]
    v_add_f64 v[66:67], v[66:67], v[30:31]
    v_add_f64 v[68:69], v[68:69], v[32:33]
    v_add_f64 v[70:71], v[70:71], v[34:35]
    v_add_f64 v[72:73], v[72:73], v[36:37]
    v_add_f64 v[74:75], v[74:75], v[38:39]
    v_add_f64 v[76:77], v[76:77], v[40:41]
    v_add_f64 v[78:79], v[78:79], v[42:43]
    s_add_u32 s56, s56, 36864
    s_addc_u32 s57, s57, 0
    s_add_u32 s58, s58, 1
    s_cmp_lt_u32 s58, 1
    s_cbranch_scc1 rec_rep
    s_sub_u32 s20, s20, 1
    s_add_u32 s20, s20, 1
    v_and_b32 v4, 3, v0
    s_mov_b32 s18, 2304
    v_mul_lo_u32 v4, v4, s18
    v_bfe_u32 v5, v0, 2, 2
    v_lshl_add_u32 v4, v5, 3, v4
    v_lshrrev_b32 v5, 4, v0
    v_lshrrev_b32 v6, 2, v5
    v_and_b32 v5, 3, v5
    v_lshl_add_u32 v4, v6, 5, v4
    v_lshl_add_u32 v4, v5, 1, v4
    v_cvt_f32_f64 v44, v[44:45]
    v_cvt_pk_bf16_f32 v44, v44, v44
    ds_write_b16 v4, v44 offset:0
    v_cvt_f32_f64 v46, v[46:47]
    v_cvt_pk_bf16_f32 v46, v46, v46
    ds_write_b16 v4, v46 offset:1152
    v_cvt_f32_f64 v48, v[48:49]
    v_cvt_pk_bf16_f32 v48, v48, v48
    ds_write_b16 v4, v48 offset:128
    v_cvt_f32_f64 v50, v[50:51]
    v_cvt_pk_bf16_f32 v50, v50, v50
    ds_write_b16 v4, v50 offset:1280
    v_cvt_f32_f64 v52, v[52:53]
    v_cvt_pk_bf16_f32 v52, v52, v52
    ds_write_b16 v4, v52 offset:256
    v_cvt_f32_f64 v54, v[54:55]
    v_cvt_pk_bf16_f32 v54, v54, v54
    ds_write_b16 v4, v54 offset:1408
    v_cvt_f32_f64 v56, v[56:57]
    v_cvt_pk_bf16_f32 v56, v56, v56
    ds_write_b16 v4, v56 offset:384
    v_cvt_f32_f64 v58, v[58:59]
    v_cvt_pk_bf16_f32 v58, v58, v58
    ds_write_b16 v4, v58 offset:1536
    v_cvt_f32_f64 v60, v[60:61]
    v_cvt_pk_bf16_f32 v60, v60, v60
    ds_write_b16 v4, v60 offset:512
    v_cvt_f32_f64 v62, v[62:63]
    v_cvt_pk_bf16_f32 v62, v62, v62
    ds_write_b16 v4, v62 offset:1664
    v_cvt_f32_f64 v64, v[64:65]
    v_cvt_pk_bf16_f32 v64, v64, v64
    ds_write_b16 v4, v64 offset:640
    v_cvt_f32_f64 v66, v[66:67]
    v_cvt_pk_bf16_f32 v66, v66, v66
    ds_write_b16 v4, v66 offset:1792
    v_cvt_f32_f64 v68, v[68:69]
    v_cvt_pk_bf16_f32 v68, v68, v68
    ds_write_b16 v4, v68 offset:768
    v_cvt_f32_f64 v70, v[70:71]
    v_cvt_pk_bf16_f32 v70, v70, v70
    ds_write_b16 v4, v70 offset:1920
    v_cvt_f32_f64 v72, v[72:73]
    v_cvt_pk_bf16_f32 v72, v72, v72
    ds_write_b16 v4, v72 offset:896
    v_cvt_f32_f64 v74, v[74:75]
    v_cvt_pk_bf16_f32 v74, v74, v74
    ds_write_b16 v4, v74 offset:2048
    v_cvt_f32_f64 v76, v[76:77]
    v_cvt_pk_bf16_f32 v76, v76, v76
    ds_write_b16 v4, v76 offset:1024
    v_cvt_f32_f64 v78, v[78:79]
    v_cvt_pk_bf16_f32 v78, v78, v78
    ds_write_b16 v4, v78 offset:2176
    s_waitcnt lgkmcnt(0)
    s_barrier
    s_add_u32 s40, s40, 36864
    s_addc_u32 s41, s41, 0
rec_compute:
    v_and_b32 v3, 15, v2
    v_lshrrev_b32 v4, 4, v2
    v_lshlrev_b32 v5, 13, v3
    v_lshl_add_u32 v5, v4, 4, v5
    global_load_dwordx4 v[40:43], v5, s[42:43] offset:0
    global_load_dwordx4 v[44:47], v5, s[42:43] offset:64
    global_load_dwordx4 v[48:51], v5, s[42:43] offset:128
    global_load_dwordx4 v[52:55], v5, s[42:43] offset:192
    v_add_u32 v6, 131072, v5
    global_load_dwordx4 v[56:59], v6, s[42:43] offset:0
    global_load_dwordx4 v[60:63], v6, s[42:43] offset:64
    global_load_dwordx4 v[64:67], v6, s[42:43] offset:128
    global_load_dwordx4 v[68:71], v6, s[42:43] offset:192
    v_lshl_add_u32 v6, v1, 5, v3
    v_lshlrev_b32 v6, 12, v6
    v_lshl_add_u32 v6, v4, 3, v6
    global_load_dwordx2 v[72:73], v6, s[44:45]
    global_load_dwordx2 v[74:75], v6, s[44:45] offset:32
    v_add_u32 v6, 65536, v6
    global_load_dwordx2 v[76:77], v6, s[44:45]
    global_load_dwordx2 v[78:79], v6, s[44:45] offset:32
    v_and_b32 v5, 7, v2
    s_mov_b32 s18, 1152
    v_mul_lo_u32 v5, v5, s18
    v_lshl_add_u32 v5, v4, 4, v5
    v_mov_b32 v8, 0
    v_mov_b32 v9, 0
    v_mov_b32 v10, 0
    v_mov_b32 v11, 0
    v_mov_b32 v12, 0
    v_mov_b32 v13, 0
    v_mov_b32 v14, 0
    v_mov_b32 v15, 0
    v_mov_b32 v16, 0
    v_mov_b32 v17, 0
    v_mov_b32 v18, 0
    v_mov_b32 v19, 0
    v_mov_b32 v20, 0
    v_mov_b32 v21, 0
    v_mov_b32 v22, 0
    v_mov_b32 v23, 0
    v_mov_b32 v24, 0
    v_mov_b32 v25, 0
    v_mov_b32 v26, 0
    v_mov_b32 v27, 0
    v_mov_b32 v28, 0
    v_mov_b32 v29, 0
    v_mov_b32 v30, 0
    v_mov_b32 v31, 0
    ds_read_b128 v[32:35], v5 offset:0
    ds_read_b128 v[36:39], v5 offset:64
    s_waitcnt lgkmcnt(1)
    v_mfma_f32_16x16x32_bf16 v[8:11], a[0:3], v[32:35], v[8:11]
    v_mfma_f32_16x16x32_bf16 v[12:15], a[72:75], v[32:35], v[12:15]
    v_mfma_f32_16x16x32_bf16 v[16:19], a[144:147], v[32:35], v[16:19]
    v_mfma_f32_16x16x32_bf16 v[20:23], a[216:219], v[32:35], v[20:23]
    v_mfma_f32_16x16x32_bf16 v[24:27], v[112:115], v[32:35], v[24:27]
    v_mfma_f32_16x16x32_bf16 v[28:31], v[184:187], v[32:35], v[28:31]
    ds_read_b128 v[32:35], v5 offset:128
    s_waitcnt lgkmcnt(1)
    v_mfma_f32_16x16x32_bf16 v[8:11], a[4:7], v[36:39], v[8:11]
    v_mfma_f32_16x16x32_bf16 v[12:15], a[76:79], v[36:39], v[12:15]
    v_mfma_f32_16x16x32_bf16 v[16:19], a[148:151], v[36:39], v[16:19]
    v_mfma_f32_16x16x32_bf16 v[20:23], a[220:223], v[36:39], v[20:23]
    v_mfma_f32_16x16x32_bf16 v[24:27], v[116:119], v[36:39], v[24:27]
    v_mfma_f32_16x16x32_bf16 v[28:31], v[188:191], v[36:39], v[28:31]
    ds_read_b128 v[36:39], v5 offset:192
    s_waitcnt lgkmcnt(1)
    v_mfma_f32_16x16x32_bf16 v[8:11], a[8:11], v[32:35], v[8:11]
    v_mfma_f32_16x16x32_bf16 v[12:15], a[80:83], v[32:35], v[12:15]
    v_mfma_f32_16x16x32_bf16 v[16:19], a[152:155], v[32:35], v[16:19]
    v_mfma_f32_16x16x32_bf16 v[20:23], a[224:227], v[32:35], v[20:23]
    v_mfma_f32_16x16x32_bf16 v[24:27], v[120:123], v[32:35], v[24:27]
    v_mfma_f32_16x16x32_bf16 v[28:31], v[192:195], v[32:35], v[28:31]
    ds_read_b128 v[32:35], v5 offset:256
    s_waitcnt lgkmcnt(1)
    v_mfma_f32_16x16x32_bf16 v[8:11], a[12:15], v[36:39], v[8:11]
    v_mfma_f32_16x16x32_bf16 v[12:15], a[84:87], v[36:39], v[12:15]
    v_mfma_f32_16x16x32_bf16 v[16:19], a[156:159], v[36:39], v[16:19]
    v_mfma_f32_16x16x32_bf16 v[20:23], a[228:231], v[36:39], v[20:23]
    v_mfma_f32_16x16x32_bf16 v[24:27], v[124:127], v[36:39], v[24:27]
    v_mfma_f32_16x16x32_bf16 v[28:31], v[196:199], v[36:39], v[28:31]
    ds_read_b128 v[36:39], v5 offset:320
    s_waitcnt lgkmcnt(1)
    v_mfma_f32_16x16x32_bf16 v[8:11], a[16:19], v[32:35], v[8:11]
    v_mfma_f32_16x16x32_bf16 v[12:15], a[88:91], v[32:35], v[12:15]
    v_mfma_f32_16x16x32_bf16 v[16:19], a[160:163], v[32:35], v[16:19]
    v_mfma_f32_16x16x32_bf16 v[20:23], a[232:235], v[32:35], v[20:23]
    v_mfma_f32_16x16x32_bf16 v[24:27], v[128:131], v[32:35], v[24:27]
    v_mfma_f32_16x16x32_bf16 v[28:31], v[200:203], v[32:35], v[28:31]
    ds_read_b128 v[32:35], v5 offset:384
    s_waitcnt lgkmcnt(1)
    v_mfma_f32_16x16x32_bf16 v[8:11], a[20:23], v[36:39], v[8:11]
    v_mfma_f32_16x16x32_bf16 v[12:15], a[92:95], v[36:39], v[12:15]
    v_mfma_f32_16x16x32_bf16 v[16:19], a[164:167], v[36:39], v[16:19]
    v_mfma_f32_16x16x32_bf16 v[20:23], a[236:239], v[36:39], v[20:23]
    v_mfma_f32_16x16x32_bf16 v[24:27], v[132:135], v[36:39], v[24:27]
    v_mfma_f32_16x16x32_bf16 v[28:31], v[204:207], v[36:39], v[28:31]
    ds_read_b128 v[36:39], v5 offset:448
    s_waitcnt lgkmcnt(1)
    v_mfma_f32_16x16x32_bf16 v[8:11], a[24:27], v[32:35], v[8:11]
    v_mfma_f32_16x16x32_bf16 v[12:15], a[96:99], v[32:35], v[12:15]
    v_mfma_f32_16x16x32_bf16 v[16:19], a[168:171], v[32:35], v[16:19]
    v_mfma_f32_16x16x32_bf16 v[20:23], a[240:243], v[32:35], v[20:23]
    v_mfma_f32_16x16x32_bf16 v[24:27], v[136:139], v[32:35], v[24:27]
    v_mfma_f32_16x16x32_bf16 v[28:31], v[208:211], v[32:35], v[28:31]
    ds_read_b128 v[32:35], v5 offset:512
    s_waitcnt lgkmcnt(1)
    v_mfma_f32_16x16x32_bf16 v[8:11], a[28:31], v[36:39], v[8:11]
    v_mfma_f32_16x16x32_bf16 v[12:15], a[100:103], v[36:39], v[12:15]
    v_mfma_f32_16x16x32_bf16 v[16:19], a[172:175], v[36:39], v[16:19]
    v_mfma_f32_16x16x32_bf16 v[20:23], a[244:247], v[36:39], v[20:23]
    v_mfma_f32_16x16x32_bf16 v[24:27], v[140:143], v[36:39], v[24:27]
    v_mfma_f32_16x16x32_bf16 v[28:31], v[212:215], v[36:39], v[28:31]
    ds_read_b128 v[36:39], v5 offset:576
    s_waitcnt lgkmcnt(1)
    v_mfma_f32_16x16x32_bf16 v[8:11], a[32:35], v[32:35], v[8:11]
    v_mfma_f32_16x16x32_bf16 v[12:15], a[104:107], v[32:35], v[12:15]
    v_mfma_f32_16x16x32_bf16 v[16:19], a[176:179], v[32:35], v[16:19]
    v_mfma_f32_16x16x32_bf16 v[20:23], a[248:251], v[32:35], v[20:23]
    v_mfma_f32_16x16x32_bf16 v[24:27], v[144:147], v[32:35], v[24:27]
    v_mfma_f32_16x16x32_bf16 v[28:31], v[216:219], v[32:35], v[28:31]
    ds_read_b128 v[32:35], v5 offset:640
    s_waitcnt lgkmcnt(1)
    v_mfma_f32_16x16x32_bf16 v[8:11], a[36:39], v[36:39], v[8:11]
    v_mfma_f32_16x16x32_bf16 v[12:15], a[108:111], v[36:39], v[12:15]
    v_mfma_f32_16x16x32_bf16 v[16:19], a[180:183], v[36:39], v[16:19]
    v_mfma_f32_16x16x32_bf16 v[20:23], a[252:255], v[36:39], v[20:23]
    v_mfma_f32_16x16x32_bf16 v[24:27], v[148:151], v[36:39], v[24:27]
    v_mfma_f32_16x16x32_bf16 v[28:31], v[220:223], v[36:39], v[28:31]
    ds_read_b128 v[36:39], v5 offset:704
    s_waitcnt lgkmcnt(1)
    v_mfma_f32_16x16x32_bf16 v[8:11], a[40:43], v[32:35], v[8:11]
    v_mfma_f32_16x16x32_bf16 v[12:15], a[112:115], v[32:35], v[12:15]
    v_mfma_f32_16x16x32_bf16 v[16:19], a[184:187], v[32:35], v[16:19]
    v_mfma_f32_16x16x32_bf16 v[20:23], v[80:83], v[32:35], v[20:23]
    v_mfma_f32_16x16x32_bf16 v[24:27], v[152:155], v[32:35], v[24:27]
    v_mfma_f32_16x16x32_bf16 v[28:31], v[224:227], v[32:35], v[28:31]
    ds_read_b128 v[32:35], v5 offset:768
    s_waitcnt lgkmcnt(1)
    v_mfma_f32_16x16x32_bf16 v[8:11], a[44:47], v[36:39], v[8:11]
    v_mfma_f32_16x16x32_bf16 v[12:15], a[116:119], v[36:39], v[12:15]
    v_mfma_f32_16x16x32_bf16 v[16:19], a[188:191], v[36:39], v[16:19]
    v_mfma_f32_16x16x32_bf16 v[20:23], v[84:87], v[36:39], v[20:23]
    v_mfma_f32_16x16x32_bf16 v[24:27], v[156:159], v[36:39], v[24:27]
    v_mfma_f32_16x16x32_bf16 v[28:31], v[228:231], v[36:39], v[28:31]
    ds_read_b128 v[36:39], v5 offset:832
    s_waitcnt lgkmcnt(1)
    v_mfma_f32_16x16x32_bf16 v[8:11], a[48:51], v[32:35], v[8:11]
    v_mfma_f32_16x16x32_bf16 v[12:15], a[120:123], v[32:35], v[12:15]
    v_mfma_f32_16x16x32_bf16 v[16:19], a[192:195], v[32:35], v[16:19]
    v_mfma_f32_16x16x32_bf16 v[20:23], v[88:91], v[32:35], v[20:23]
    v_mfma_f32_16x16x32_bf16 v[24:27], v[160:163], v[32:35], v[24:27]
    v_mfma_f32_16x16x32_bf16 v[28:31], v[232:235], v[32:35], v[28:31]
    ds_read_b128 v[32:35], v5 offset:896
    s_waitcnt lgkmcnt(1)
    v_mfma_f32_16x16x32_bf16 v[8:11], a[52:55], v[36:39], v[8:11]
    v_mfma_f32_16x16x32_bf16 v[12:15], a[124:127], v[36:39], v[12:15]
    v_mfma_f32_16x16x32_bf16 v[16:19], a[196:199], v[36:39], v[16:19]
    v_mfma_f32_16x16x32_bf16 v[20:23], v[92:95], v[36:39], v[20:23]
    v_mfma_f32_16x16x32_bf16 v[24:27], v[164:167], v[36:39], v[24:27]
    v_mfma_f32_16x16x32_bf16 v[28:31], v[236:239], v[36:39], v[28:31]
    ds_read_b128 v[36:39], v5 offset:960
    s_waitcnt lgkmcnt(1)
    v_mfma_f32_16x16x32_bf16 v[8:11], a[56:59], v[32:35], v[8:11]
    v_mfma_f32_16x16x32_bf16 v[12:15], a[128:131], v[32:35], v[12:15]
    v_mfma_f32_16x16x32_bf16 v[16:19], a[200:203], v[32:35], v[16:19]
    v_mfma_f32_16x16x32_bf16 v[20:23], v[96:99], v[32:35], v[20:23]
    v_mfma_f32_16x16x32_bf16 v[24:27], v[168:171], v[32:35], v[24:27]
    v_mfma_f32_16x16x32_bf16 v[28:31], v[240:243], v[32:35], v[28:31]
    ds_read_b128 v[32:35], v5 offset:1024
    s_waitcnt lgkmcnt(1)
    v_mfma_f32_16x16x32_bf16 v[8:11], a[60:63], v[36:39], v[8:11]
    v_mfma_f32_16x16x32_bf16 v[12:15], a[132:135], v[36:39], v[12:15]
    v_mfma_f32_16x16x32_bf16 v[16:19], a[204:207], v[36:39], v[16:19]
    v_mfma_f32_16x16x32_bf16 v[20:23], v[100:103], v[36:39], v[20:23]
    v_mfma_f32_16x16x32_bf16 v[24:27], v[172:175], v[36:39], v[24:27]
    v_mfma_f32_16x16x32_bf16 v[28:31], v[244:247], v[36:39], v[28:31]
    ds_read_b128 v[36:39], v5 offset:1088
    s_waitcnt lgkmcnt(1)
    v_mfma_f32_16x16x32_bf16 v[8:11], a[64:67], v[32:35], v[8:11]
    v_mfma_f32_16x16x32_bf16 v[12:15], a[136:139], v[32:35], v[12:15]
    v_mfma_f32_16x16x32_bf16 v[16:19], a[208:211], v[32:35], v[16:19]
    v_mfma_f32_16x16x32_bf16 v[20:23], v[104:107], v[32:35], v[20:23]
    v_mfma_f32_16x16x32_bf16 v[24:27], v[176:179], v[32:35], v[24:27]
    v_mfma_f32_16x16x32_bf16 v[28:31], v[248:251], v[32:35], v[28:31]
    s_waitcnt lgkmcnt(0)
    v_mfma_f32_16x16x32_bf16 v[8:11], a[68:71], v[36:39], v[8:11]
    v_mfma_f32_16x16x32_bf16 v[12:15], a[140:143], v[36:39], v[12:15]
    v_mfma_f32_16x16x32_bf16 v[16:19], a[212:215], v[36:39], v[16:19]
    v_mfma_f32_16x16x32_bf16 v[20:23], v[108:111], v[36:39], v[20:23]
    v_mfma_f32_16x16x32_bf16 v[24:27], v[180:183], v[36:39], v[24:27]
    v_mfma_f32_16x16x32_bf16 v[28:31], v[252:255], v[36:39], v[28:31]
    s_nop 7
    s_nop 1
    v_cmp_gt_u32 vcc, 8, v3
    s_and_saveexec_b64 s[24:25], vcc
    v_lshlrev_b32 v5, 8, v3
    v_lshl_add_u32 v5, v1, 6, v5
    v_lshl_add_u32 v5, v4, 3, v5
    v_cvt_pk_bf16_f32 v8, v8, v9
    v_cvt_pk_bf16_f32 v9, v10, v11
    ds_write_b64 v5, v[8:9] offset:9216
    v_cvt_pk_bf16_f32 v12, v12, v13
    v_cvt_pk_bf16_f32 v13, v14, v15
    ds_write_b64 v5, v[12:13] offset:9248
    v_cvt_pk_bf16_f32 v16, v16, v17
    v_cvt_pk_bf16_f32 v17, v18, v19
    ds_write_b64 v5, v[16:17] offset:11264
    global_store_dwordx2 v5, v[16:17], s[46:47] offset:0
    v_cvt_pk_bf16_f32 v20, v20, v21
    v_cvt_pk_bf16_f32 v21, v22, v23
    ds_write_b64 v5, v[20:21] offset:11296
    global_store_dwordx2 v5, v[20:21], s[46:47] offset:32
    v_lshlrev_b32 v6, 1, v3
    v_lshl_add_u32 v6, v1, 9, v6
    v_lshl_add_u32 v6, v4, 6, v6
    v_cvt_pk_bf16_f32 v24, v24, v25
    v_cvt_pk_bf16_f32 v25, v26, v27
    ds_write_b16 v6, v24 offset:13312
    global_store_short v6, v24, s[48:49] offset:0
    ds_write_b16_d16_hi v6, v24 offset:13328
    global_store_short_d16_hi v6, v24, s[48:49] offset:16
    ds_write_b16 v6, v25 offset:13344
    global_store_short v6, v25, s[48:49] offset:32
    ds_write_b16_d16_hi v6, v25 offset:13360
    global_store_short_d16_hi v6, v25, s[48:49] offset:48
    v_cvt_pk_bf16_f32 v28, v28, v29
    v_cvt_pk_bf16_f32 v29, v30, v31
    ds_write_b16 v6, v28 offset:13568
    global_store_short v6, v28, s[48:49] offset:256
    ds_write_b16_d16_hi v6, v28 offset:13584
    global_store_short_d16_hi v6, v28, s[48:49] offset:272
    ds_write_b16 v6, v29 offset:13600
    global_store_short v6, v29, s[48:49] offset:288
    ds_write_b16_d16_hi v6, v29 offset:13616
    global_store_short_d16_hi v6, v29, s[48:49] offset:304
    s_mov_b64 exec, s[24:25]
    s_waitcnt lgkmcnt(0)
    s_barrier
    v_and_b32 v5, 7, v2
    v_lshlrev_b32 v5, 8, v5
    v_lshl_add_u32 v5, v4, 4, v5
    v_mov_b32 v8, 0
    v_mov_b32 v9, 0
    v_mov_b32 v10, 0
    v_mov_b32 v11, 0
    v_mov_b32 v12, 0
    v_mov_b32 v13, 0
    v_mov_b32 v14, 0
    v_mov_b32 v15, 0
    v_mov_b32 v16, 0
    v_mov_b32 v17, 0
    v_mov_b32 v18, 0
    v_mov_b32 v19, 0
    ds_read_b128 v[20:23], v5 offset:9216
    ds_read_b128 v[24:27], v5 offset:11264
    s_waitcnt vmcnt(0) lgkmcnt(0)
    v_mfma_f32_16x16x32_bf16 v[8:11], v[24:27], v[20:23], v[8:11]
    v_mfma_f32_16x16x32_bf16 v[12:15], v[40:43], v[20:23], v[12:15]
    v_mfma_f32_16x16x32_bf16 v[16:19], v[56:59], v[20:23], v[16:19]
    ds_read_b128 v[28:31], v5 offset:9280
    ds_read_b128 v[32:35], v5 offset:11328
    s_waitcnt vmcnt(0) lgkmcnt(0)
    v_mfma_f32_16x16x32_bf16 v[8:11], v[32:35], v[28:31], v[8:11]
    v_mfma_f32_16x16x32_bf16 v[12:15], v[44:47], v[28:31], v[12:15]
    v_mfma_f32_16x16x32_bf16 v[16:19], v[60:63], v[28:31], v[16:19]
    ds_read_b128 v[20:23], v5 offset:9344
    ds_read_b128 v[24:27], v5 offset:11392
    s_waitcnt vmcnt(0) lgkmcnt(0)
    v_mfma_f32_16x16x32_bf16 v[8:11], v[24:27], v[20:23], v[8:11]
    v_mfma_f32_16x16x32_bf16 v[12:15], v[48:51], v[20:23], v[12:15]
    v_mfma_f32_16x16x32_bf16 v[16:19], v[64:67], v[20:23], v[16:19]
    ds_read_b128 v[28:31], v5 offset:9408
    ds_read_b128 v[32:35], v5 offset:11456
    s_waitcnt vmcnt(0) lgkmcnt(0)
    v_mfma_f32_16x16x32_bf16 v[8:11], v[32:35], v[28:31], v[8:11]
    v_mfma_f32_16x16x32_bf16 v[12:15], v[52:55], v[28:31], v[12:15]
    v_mfma_f32_16x16x32_bf16 v[16:19], v[68:71], v[28:31], v[16:19]
    s_nop 7
    s_nop 1
    v_cmp_gt_u32 vcc, 2, v4
    v_mov_b32 v7, 0xce6e6b28
    v_cvt_pk_bf16_f32 v8, v8, v8
    v_lshlrev_b32 v8, 16, v8
    v_mul_f32 v8, 0x3db504f3, v8
    v_cvt_pk_bf16_f32 v8, v8, v8
    v_lshlrev_b32 v8, 16, v8
    v_cndmask_b32 v8, v7, v8, vcc
    v_cvt_pk_bf16_f32 v9, v9, v9
    v_lshlrev_b32 v9, 16, v9
    v_mul_f32 v9, 0x3db504f3, v9
    v_cvt_pk_bf16_f32 v9, v9, v9
    v_lshlrev_b32 v9, 16, v9
    v_cndmask_b32 v9, v7, v9, vcc
    v_cvt_pk_bf16_f32 v10, v10, v10
    v_lshlrev_b32 v10, 16, v10
    v_mul_f32 v10, 0x3db504f3, v10
    v_cvt_pk_bf16_f32 v10, v10, v10
    v_lshlrev_b32 v10, 16, v10
    v_cndmask_b32 v10, v7, v10, vcc
    v_cvt_pk_bf16_f32 v11, v11, v11
    v_lshlrev_b32 v11, 16, v11
    v_mul_f32 v11, 0x3db504f3, v11
    v_cvt_pk_bf16_f32 v11, v11, v11
    v_lshlrev_b32 v11, 16, v11
    v_cndmask_b32 v11, v7, v11, vcc
    v_cvt_pk_bf16_f32 v12, v12, v12
    v_lshlrev_b32 v12, 16, v12
    v_mul_f32 v12, 0x3db504f3, v12
    v_cvt_pk_bf16_f32 v12, v12, v12
    v_lshlrev_b32 v12, 16, v12
    v_cvt_pk_bf16_f32 v13, v13, v13
    v_lshlrev_b32 v13, 16, v13
    v_mul_f32 v13, 0x3db504f3, v13
    v_cvt_pk_bf16_f32 v13, v13, v13
    v_lshlrev_b32 v13, 16, v13
    v_cvt_pk_bf16_f32 v14, v14, v14
    v_lshlrev_b32 v14, 16, v14
    v_mul_f32 v14, 0x3db504f3, v14
    v_cvt_pk_bf16_f32 v14, v14, v14
    v_lshlrev_b32 v14, 16, v14
    v_cvt_pk_bf16_f32 v15, v15, v15
    v_lshlrev_b32 v15, 16, v15
    v_mul_f32 v15, 0x3db504f3, v15
    v_cvt_pk_bf16_f32 v15, v15, v15
    v_lshlrev_b32 v15, 16, v15
    v_cvt_pk_bf16_f32 v16, v16, v16
    v_lshlrev_b32 v16, 16, v16
    v_mul_f32 v16, 0x3db504f3, v16
    v_cvt_pk_bf16_f32 v16, v16, v16
    v_lshlrev_b32 v16, 16, v16
    v_cvt_pk_bf16_f32 v17, v17, v17
    v_lshlrev_b32 v17, 16, v17
    v_mul_f32 v17, 0x3db504f3, v17
    v_cvt_pk_bf16_f32 v17, v17, v17
    v_lshlrev_b32 v17, 16, v17
    v_cvt_pk_bf16_f32 v18, v18, v18
    v_lshlrev_b32 v18, 16, v18
    v_mul_f32 v18, 0x3db504f3, v18
    v_cvt_pk_bf16_f32 v18, v18, v18
    v_lshlrev_b32 v18, 16, v18
    v_cvt_pk_bf16_f32 v19, v19, v19
    v_lshlrev_b32 v19, 16, v19
    v_mul_f32 v19, 0x3db504f3, v19
    v_cvt_pk_bf16_f32 v19, v19, v19
    v_lshlrev_b32 v19, 16, v19
    v_max_f32 v5, v8, v9
    v_max_f32 v5, v5, v10
    v_max_f32 v5, v5, v11
    v_max_f32 v5, v5, v12
    v_max_f32 v5, v5, v13
    v_max_f32 v5, v5, v14
    v_max_f32 v5, v5, v15
    v_max_f32 v5, v5, v16
    v_max_f32 v5, v5, v17
    v_max_f32 v5, v5, v18
    v_max_f32 v5, v5, v19
    v_xor_b32 v6, 32, v2
    v_lshlrev_b32 v6, 2, v6
    ds_swizzle_b32 v7, v5 offset:0x401F
    s_waitcnt lgkmcnt(0)
    v_max_f32 v5, v5, v7
    ds_bpermute_b32 v7, v6, v5
    s_waitcnt lgkmcnt(0)
    v_max_f32 v5, v5, v7
    v_mov_b32 v20, 0
    v_sub_f32 v8, v8, v5
    v_mul_f32 v8, 0x3fb8aa3b, v8
    v_exp_f32 v8, v8
    s_nop 0
    v_add_f32 v20, v20, v8
    v_sub_f32 v9, v9, v5
    v_mul_f32 v9, 0x3fb8aa3b, v9
    v_exp_f32 v9, v9
    s_nop 0
    v_add_f32 v20, v20, v9
    v_sub_f32 v10, v10, v5
    v_mul_f32 v10, 0x3fb8aa3b, v10
    v_exp_f32 v10, v10
    s_nop 0
    v_add_f32 v20, v20, v10
    v_sub_f32 v11, v11, v5
    v_mul_f32 v11, 0x3fb8aa3b, v11
    v_exp_f32 v11, v11
    s_nop 0
    v_add_f32 v20, v20, v11
    v_sub_f32 v12, v12, v5
    v_mul_f32 v12, 0x3fb8aa3b, v12
    v_exp_f32 v12, v12
    s_nop 0
    v_add_f32 v20, v20, v12
    v_sub_f32 v13, v13, v5
    v_mul_f32 v13, 0x3fb8aa3b, v13
    v_exp_f32 v13, v13
    s_nop 0
    v_add_f32 v20, v20, v13
    v_sub_f32 v14, v14, v5
    v_mul_f32 v14, 0x3fb8aa3b, v14
    v_exp_f32 v14, v14
    s_nop 0
    v_add_f32 v20, v20, v14
    v_sub_f32 v15, v15, v5
    v_mul_f32 v15, 0x3fb8aa3b, v15
    v_exp_f32 v15, v15
    s_nop 0
    v_add_f32 v20, v20, v15
    v_sub_f32 v16, v16, v5
    v_mul_f32 v16, 0x3fb8aa3b, v16
    v_exp_f32 v16, v16
    s_nop 0
    v_add_f32 v20, v20, v16
    v_sub_f32 v17, v17, v5
    v_mul_f32 v17, 0x3fb8aa3b, v17
    v_exp_f32 v17, v17
    s_nop 0
    v_add_f32 v20, v20, v17
    v_sub_f32 v18, v18, v5
    v_mul_f32 v18, 0x3fb8aa3b, v18
    v_exp_f32 v18, v18
    s_nop 0
    v_add_f32 v20, v20, v18
    v_sub_f32 v19, v19, v5
    v_mul_f32 v19, 0x3fb8aa3b, v19
    v_exp_f32 v19, v19
    s_nop 0
    v_add_f32 v20, v20, v19
    ds_swizzle_b32 v7, v20 offset:0x401F
    s_waitcnt lgkmcnt(0)
    v_add_f32 v20, v20, v7
    ds_bpermute_b32 v7, v6, v20
    s_waitcnt lgkmcnt(0)
    v_add_f32 v20, v20, v7
    v_rcp_f32 v20, v20
    s_nop 0
    v_mul_f32 v8, v8, v20
    v_mul_f32 v9, v9, v20
    v_mul_f32 v10, v10, v20
    v_mul_f32 v11, v11, v20
    v_mul_f32 v12, v12, v20
    v_mul_f32 v13, v13, v20
    v_mul_f32 v14, v14, v20
    v_mul_f32 v15, v15, v20
    v_mul_f32 v16, v16, v20
    v_mul_f32 v17, v17, v20
    v_mul_f32 v18, v18, v20
    v_mul_f32 v19, v19, v20
    v_cvt_pk_bf16_f32 v20, v8, v9
    v_cvt_pk_bf16_f32 v21, v10, v11
    v_cvt_pk_bf16_f32 v22, v12, v13
    v_cvt_pk_bf16_f32 v23, v14, v15
    v_cvt_pk_bf16_f32 v24, v16, v17
    v_cvt_pk_bf16_f32 v25, v18, v19
    v_mov_b32 v26, 0
    v_mov_b32 v27, 0
    v_lshl_add_u32 v5, v1, 5, v3
    v_lshlrev_b32 v5, 4, v5
    v_lshl_add_u32 v5, v4, 3, v5
    ds_read_b64 v[28:29], v5 offset:13312
    v_mov_b32 v30, v72
    v_mov_b32 v31, v73
    v_mov_b32 v32, v74
    v_mov_b32 v33, v75
    v_mov_b32 v34, 0
    v_mov_b32 v35, 0
    v_mov_b32 v8, 0
    v_mov_b32 v9, 0
    v_mov_b32 v10, 0
    v_mov_b32 v11, 0
    s_waitcnt lgkmcnt(0)
    s_nop 1
    v_mfma_f32_16x16x32_bf16 v[8:11], v[28:31], v[20:23], v[8:11]
    v_mfma_f32_16x16x32_bf16 v[8:11], v[32:35], v[24:27], v[8:11]
    s_nop 7
    ds_read_b64 v[28:29], v5 offset:13568
    v_mov_b32 v30, v76
    v_mov_b32 v31, v77
    v_mov_b32 v32, v78
    v_mov_b32 v33, v79
    v_mov_b32 v34, 0
    v_mov_b32 v35, 0
    v_mov_b32 v12, 0
    v_mov_b32 v13, 0
    v_mov_b32 v14, 0
    v_mov_b32 v15, 0
    s_waitcnt lgkmcnt(0)
    s_nop 1
    v_mfma_f32_16x16x32_bf16 v[12:15], v[28:31], v[20:23], v[12:15]
    v_mfma_f32_16x16x32_bf16 v[12:15], v[32:35], v[24:27], v[12:15]
    s_nop 7
    s_nop 1
    v_cmp_gt_u32 vcc, 8, v3
    s_and_saveexec_b64 s[24:25], vcc
    v_lshlrev_b32 v5, 8, v3
    v_lshl_add_u32 v5, v1, 6, v5
    v_lshl_add_u32 v5, v4, 3, v5
    v_cvt_pk_bf16_f32 v8, v8, v9
    v_cvt_pk_bf16_f32 v9, v10, v11
    ds_write_b64 v5, v[8:9] offset:0
    v_cvt_pk_bf16_f32 v12, v12, v13
    v_cvt_pk_bf16_f32 v13, v14, v15
    ds_write_b64 v5, v[12:13] offset:32
    s_mov_b64 exec, s[24:25]
    s_waitcnt lgkmcnt(0)
    s_barrier
    s_add_u32 s20, s20, 1
    s_cmp_ge_u32 s20, 64
    s_cbranch_scc1 rec_end
    s_add_u32 s42, s42, 262144
    s_addc_u32 s43, s43, 0
    s_add_u32 s44, s44, 64
    s_addc_u32 s45, s45, 0
    s_add_u32 s46, s46, 65536
    s_addc_u32 s47, s47, 0
    s_add_u32 s48, s48, 65536
    s_addc_u32 s49, s49, 0
    v_and_b32 v5, 7, v2
    v_lshlrev_b32 v5, 8, v5
    v_lshl_add_u32 v5, v4, 4, v5
    ds_read_b128 v[8:11], v5 offset:0
    ds_read_b128 v[12:15], v5 offset:64
    ds_read_b128 v[16:19], v5 offset:128
    ds_read_b128 v[20:23], v5 offset:192
    v_lshrrev_b32 v6, 2, v3
    v_lshl_add_u32 v6, v4, 3, v6
    s_mov_b32 s18, 1152
    v_mul_lo_u32 v6, v6, s18
    v_and_b32 v7, 3, v2
    v_lshl_add_u32 v6, v7, 3, v6
    s_mov_b32 s18, 288
    v_mul_lo_u32 v7, v1, s18
    v_add_u32 v6, v6, v7
    v_lshl_add_u32 v7, v4, 3, v3
    v_lshlrev_b32 v7, 3, v7
    s_mov_b32 s18, 9216
    v_mul_lo_u32 v36, v1, s18
    v_add_u32 v7, v7, v36
    v_add_u32 v46, 16384, v6
    v_add_u32 v47, 53248, v6
    v_add_u32 v48, 90112, v6
    v_add_u32 v49, 126976, v6
    v_cmp_gt_u32 vcc, 8, v3
    s_waitcnt lgkmcnt(0)
    v_and_b32 v36, 7, v2
    v_lshl_add_u32 v7, v4, 3, v36
    v_lshlrev_b32 v7, 3, v7
    v_lshrrev_b32 v36, 3, v3
    v_lshl_add_u32 v7, v36, 8, v7
    s_mov_b32 s18, 9216
    v_mul_lo_u32 v36, v1, s18
    v_add_u32 v7, v7, v36
    s_mov_b32 s18, 0
    s_mul_i32 s18, s18, 36864
    s_add_u32 s54, s40, s18
    s_addc_u32 s55, s41, 0
    ds_read_b64_tr_b16 v[24:25], v46 offset:0
    ds_read_b64_tr_b16 v[26:27], v46 offset:4608
    ds_read_b64_tr_b16 v[28:29], v47 offset:0
    ds_read_b64_tr_b16 v[30:31], v47 offset:4608
    ds_read_b64_tr_b16 v[32:33], v48 offset:0
    ds_read_b64_tr_b16 v[34:35], v48 offset:4608
    ds_read_b64_tr_b16 v[36:37], v49 offset:0
    ds_read_b64_tr_b16 v[38:39], v49 offset:4608
    ds_read_b64_tr_b16 v[52:53], v46 offset:32
    ds_read_b64_tr_b16 v[54:55], v46 offset:4640
    ds_read_b64_tr_b16 v[56:57], v47 offset:32
    ds_read_b64_tr_b16 v[58:59], v47 offset:4640
    ds_read_b64_tr_b16 v[60:61], v48 offset:32
    ds_read_b64_tr_b16 v[62:63], v48 offset:4640
    ds_read_b64_tr_b16 v[64:65], v49 offset:32
    ds_read_b64_tr_b16 v[66:67], v49 offset:4640
    v_mov_b32 v40, 0
    v_mov_b32 v41, 0
    v_mov_b32 v42, 0
    v_mov_b32 v43, 0
    s_waitcnt lgkmcnt(8)
    s_nop 0
    v_mfma_f32_16x16x32_bf16 v[40:43], v[24:27], v[8:11], v[40:43]
    v_mfma_f32_16x16x32_bf16 v[40:43], v[28:31], v[12:15], v[40:43]
    v_mfma_f32_16x16x32_bf16 v[40:43], v[32:35], v[16:19], v[40:43]
    v_mfma_f32_16x16x32_bf16 v[40:43], v[36:39], v[20:23], v[40:43]
    ds_read_b64_tr_b16 v[24:25], v46 offset:64
    ds_read_b64_tr_b16 v[26:27], v46 offset:4672
    ds_read_b64_tr_b16 v[28:29], v47 offset:64
    ds_read_b64_tr_b16 v[30:31], v47 offset:4672
    ds_read_b64_tr_b16 v[32:33], v48 offset:64
    ds_read_b64_tr_b16 v[34:35], v48 offset:4672
    ds_read_b64_tr_b16 v[36:37], v49 offset:64
    ds_read_b64_tr_b16 v[38:39], v49 offset:4672
    v_mov_b32 v68, 0
    v_mov_b32 v69, 0
    v_mov_b32 v70, 0
    v_mov_b32 v71, 0
    s_waitcnt lgkmcnt(8)
    s_nop 0
    v_mfma_f32_16x16x32_bf16 v[68:71], v[52:55], v[8:11], v[68:71]
    v_mfma_f32_16x16x32_bf16 v[68:71], v[56:59], v[12:15], v[68:71]
    v_mfma_f32_16x16x32_bf16 v[68:71], v[60:63], v[16:19], v[68:71]
    v_mfma_f32_16x16x32_bf16 v[68:71], v[64:67], v[20:23], v[68:71]
    v_mov_b32 v74, v40
    s_nop 1
    v_mov_b32_dpp v74, v41 row_shr:8 row_mask:0xf bank_mask:0xf
    v_cvt_f64_f32 v[72:73], v74
    v_add_f64 v[72:73], v[72:73], s[32:33]
    global_atomic_add_f64 v7, v[72:73], s[54:55] offset:0 sc1
    v_mov_b32 v78, v42
    s_nop 1
    v_mov_b32_dpp v78, v43 row_shr:8 row_mask:0xf bank_mask:0xf
    v_cvt_f64_f32 v[76:77], v78
    v_add_f64 v[76:77], v[76:77], s[32:33]
    global_atomic_add_f64 v7, v[76:77], s[54:55] offset:512 sc1
    v_add_u32 v7, 1024, v7
    ds_read_b64_tr_b16 v[52:53], v46 offset:96
    ds_read_b64_tr_b16 v[54:55], v46 offset:4704
    ds_read_b64_tr_b16 v[56:57], v47 offset:96
    ds_read_b64_tr_b16 v[58:59], v47 offset:4704
    ds_read_b64_tr_b16 v[60:61], v48 offset:96
    ds_read_b64_tr_b16 v[62:63], v48 offset:4704
    ds_read_b64_tr_b16 v[64:65], v49 offset:96
    ds_read_b64_tr_b16 v[66:67], v49 offset:4704
    v_mov_b32 v40, 0
    v_mov_b32 v41, 0
    v_mov_b32 v42, 0
    v_mov_b32 v43, 0
    s_waitcnt lgkmcnt(8)
    s_nop 0
    v_mfma_f32_16x16x32_bf16 v[40:43], v[24:27], v[8:11], v[40:43]
    v_mfma_f32_16x16x32_bf16 v[40:43], v[28:31], v[12:15], v[40:43]
    v_mfma_f32_16x16x32_bf16 v[40:43], v[32:35], v[16:19], v[40:43]
    v_mfma_f32_16x16x32_bf16 v[40:43], v[36:39], v[20:23], v[40:43]
    v_mov_b32 v74, v68
    s_nop 1
    v_mov_b32_dpp v74, v69 row_shr:8 row_mask:0xf bank_mask:0xf
    v_cvt_f64_f32 v[72:73], v74
    v_add_f64 v[72:73], v[72:73], s[32:33]
    global_atomic_add_f64 v7, v[72:73], s[54:55] offset:0 sc1
    v_mov_b32 v78, v70
    s_nop 1
    v_mov_b32_dpp v78, v71 row_shr:8 row_mask:0xf bank_mask:0xf
    v_cvt_f64_f32 v[76:77], v78
    v_add_f64 v[76:77], v[76:77], s[32:33]
    global_atomic_add_f64 v7, v[76:77], s[54:55] offset:512 sc1
    v_add_u32 v7, 1024, v7
    ds_read_b64_tr_b16 v[24:25], v46 offset:128
    ds_read_b64_tr_b16 v[26:27], v46 offset:4736
    ds_read_b64_tr_b16 v[28:29], v47 offset:128
    ds_read_b64_tr_b16 v[30:31], v47 offset:4736
    ds_read_b64_tr_b16 v[32:33], v48 offset:128
    ds_read_b64_tr_b16 v[34:35], v48 offset:4736
    ds_read_b64_tr_b16 v[36:37], v49 offset:128
    ds_read_b64_tr_b16 v[38:39], v49 offset:4736
    v_mov_b32 v68, 0
    v_mov_b32 v69, 0
    v_mov_b32 v70, 0
    v_mov_b32 v71, 0
    s_waitcnt lgkmcnt(8)
    s_nop 0
    v_mfma_f32_16x16x32_bf16 v[68:71], v[52:55], v[8:11], v[68:71]
    v_mfma_f32_16x16x32_bf16 v[68:71], v[56:59], v[12:15], v[68:71]
    v_mfma_f32_16x16x32_bf16 v[68:71], v[60:63], v[16:19], v[68:71]
    v_mfma_f32_16x16x32_bf16 v[68:71], v[64:67], v[20:23], v[68:71]
    v_mov_b32 v74, v40
    s_nop 1
    v_mov_b32_dpp v74, v41 row_shr:8 row_mask:0xf bank_mask:0xf
    v_cvt_f64_f32 v[72:73], v74
    v_add_f64 v[72:73], v[72:73], s[32:33]
    global_atomic_add_f64 v7, v[72:73], s[54:55] offset:0 sc1
    v_mov_b32 v78, v42
    s_nop 1
    v_mov_b32_dpp v78, v43 row_shr:8 row_mask:0xf bank_mask:0xf
    v_cvt_f64_f32 v[76:77], v78
    v_add_f64 v[76:77], v[76:77], s[32:33]
    global_atomic_add_f64 v7, v[76:77], s[54:55] offset:512 sc1
    v_add_u32 v7, 1024, v7
    ds_read_b64_tr_b16 v[52:53], v46 offset:160
    ds_read_b64_tr_b16 v[54:55], v46 offset:4768
    ds_read_b64_tr_b16 v[56:57], v47 offset:160
    ds_read_b64_tr_b16 v[58:59], v47 offset:4768
    ds_read_b64_tr_b16 v[60:61], v48 offset:160
    ds_read_b64_tr_b16 v[62:63], v48 offset:4768
    ds_read_b64_tr_b16 v[64:65], v49 offset:160
    ds_read_b64_tr_b16 v[66:67], v49 offset:4768
    v_mov_b32 v40, 0
    v_mov_b32 v41, 0
    v_mov_b32 v42, 0
    v_mov_b32 v43, 0
    s_waitcnt lgkmcnt(8)
    s_nop 0
    v_mfma_f32_16x16x32_bf16 v[40:43], v[24:27], v[8:11], v[40:43]
    v_mfma_f32_16x16x32_bf16 v[40:43], v[28:31], v[12:15], v[40:43]
    v_mfma_f32_16x16x32_bf16 v[40:43], v[32:35], v[16:19], v[40:43]
    v_mfma_f32_16x16x32_bf16 v[40:43], v[36:39], v[20:23], v[40:43]
    v_mov_b32 v74, v68
    s_nop 1
    v_mov_b32_dpp v74, v69 row_shr:8 row_mask:0xf bank_mask:0xf
    v_cvt_f64_f32 v[72:73], v74
    v_add_f64 v[72:73], v[72:73], s[32:33]
    global_atomic_add_f64 v7, v[72:73], s[54:55] offset:0 sc1
    v_mov_b32 v78, v70
    s_nop 1
    v_mov_b32_dpp v78, v71 row_shr:8 row_mask:0xf bank_mask:0xf
    v_cvt_f64_f32 v[76:77], v78
    v_add_f64 v[76:77], v[76:77], s[32:33]
    global_atomic_add_f64 v7, v[76:77], s[54:55] offset:512 sc1
    v_add_u32 v7, 1024, v7
    ds_read_b64_tr_b16 v[24:25], v46 offset:192
    ds_read_b64_tr_b16 v[26:27], v46 offset:4800
    ds_read_b64_tr_b16 v[28:29], v47 offset:192
    ds_read_b64_tr_b16 v[30:31], v47 offset:4800
    ds_read_b64_tr_b16 v[32:33], v48 offset:192
    ds_read_b64_tr_b16 v[34:35], v48 offset:4800
    ds_read_b64_tr_b16 v[36:37], v49 offset:192
    ds_read_b64_tr_b16 v[38:39], v49 offset:4800
    v_mov_b32 v68, 0
    v_mov_b32 v69, 0
    v_mov_b32 v70, 0
    v_mov_b32 v71, 0
    s_waitcnt lgkmcnt(8)
    s_nop 0
    v_mfma_f32_16x16x32_bf16 v[68:71], v[52:55], v[8:11], v[68:71]
    v_mfma_f32_16x16x32_bf16 v[68:71], v[56:59], v[12:15], v[68:71]
    v_mfma_f32_16x16x32_bf16 v[68:71], v[60:63], v[16:19], v[68:71]
    v_mfma_f32_16x16x32_bf16 v[68:71], v[64:67], v[20:23], v[68:71]
    v_mov_b32 v74, v40
    s_nop 1
    v_mov_b32_dpp v74, v41 row_shr:8 row_mask:0xf bank_mask:0xf
    v_cvt_f64_f32 v[72:73], v74
    v_add_f64 v[72:73], v[72:73], s[32:33]
    global_atomic_add_f64 v7, v[72:73], s[54:55] offset:0 sc1
    v_mov_b32 v78, v42
    s_nop 1
    v_mov_b32_dpp v78, v43 row_shr:8 row_mask:0xf bank_mask:0xf
    v_cvt_f64_f32 v[76:77], v78
    v_add_f64 v[76:77], v[76:77], s[32:33]
    global_atomic_add_f64 v7, v[76:77], s[54:55] offset:512 sc1
    v_add_u32 v7, 1024, v7
    ds_read_b64_tr_b16 v[52:53], v46 offset:224
    ds_read_b64_tr_b16 v[54:55], v46 offset:4832
    ds_read_b64_tr_b16 v[56:57], v47 offset:224
    ds_read_b64_tr_b16 v[58:59], v47 offset:4832
    ds_read_b64_tr_b16 v[60:61], v48 offset:224
    ds_read_b64_tr_b16 v[62:63], v48 offset:4832
    ds_read_b64_tr_b16 v[64:65], v49 offset:224
    ds_read_b64_tr_b16 v[66:67], v49 offset:4832
    v_mov_b32 v40, 0
    v_mov_b32 v41, 0
    v_mov_b32 v42, 0
    v_mov_b32 v43, 0
    s_waitcnt lgkmcnt(8)
    s_nop 0
    v_mfma_f32_16x16x32_bf16 v[40:43], v[24:27], v[8:11], v[40:43]
    v_mfma_f32_16x16x32_bf16 v[40:43], v[28:31], v[12:15], v[40:43]
    v_mfma_f32_16x16x32_bf16 v[40:43], v[32:35], v[16:19], v[40:43]
    v_mfma_f32_16x16x32_bf16 v[40:43], v[36:39], v[20:23], v[40:43]
    v_mov_b32 v74, v68
    s_nop 1
    v_mov_b32_dpp v74, v69 row_shr:8 row_mask:0xf bank_mask:0xf
    v_cvt_f64_f32 v[72:73], v74
    v_add_f64 v[72:73], v[72:73], s[32:33]
    global_atomic_add_f64 v7, v[72:73], s[54:55] offset:0 sc1
    v_mov_b32 v78, v70
    s_nop 1
    v_mov_b32_dpp v78, v71 row_shr:8 row_mask:0xf bank_mask:0xf
    v_cvt_f64_f32 v[76:77], v78
    v_add_f64 v[76:77], v[76:77], s[32:33]
    global_atomic_add_f64 v7, v[76:77], s[54:55] offset:512 sc1
    v_add_u32 v7, 1024, v7
    ds_read_b64_tr_b16 v[24:25], v46 offset:256
    ds_read_b64_tr_b16 v[26:27], v46 offset:4864
    ds_read_b64_tr_b16 v[28:29], v47 offset:256
    ds_read_b64_tr_b16 v[30:31], v47 offset:4864
    ds_read_b64_tr_b16 v[32:33], v48 offset:256
    ds_read_b64_tr_b16 v[34:35], v48 offset:4864
    ds_read_b64_tr_b16 v[36:37], v49 offset:256
    ds_read_b64_tr_b16 v[38:39], v49 offset:4864
    v_mov_b32 v68, 0
    v_mov_b32 v69, 0
    v_mov_b32 v70, 0
    v_mov_b32 v71, 0
    s_waitcnt lgkmcnt(8)
    s_nop 0
    v_mfma_f32_16x16x32_bf16 v[68:71], v[52:55], v[8:11], v[68:71]
    v_mfma_f32_16x16x32_bf16 v[68:71], v[56:59], v[12:15], v[68:71]
    v_mfma_f32_16x16x32_bf16 v[68:71], v[60:63], v[16:19], v[68:71]
    v_mfma_f32_16x16x32_bf16 v[68:71], v[64:67], v[20:23], v[68:71]
    v_mov_b32 v74, v40
    s_nop 1
    v_mov_b32_dpp v74, v41 row_shr:8 row_mask:0xf bank_mask:0xf
    v_cvt_f64_f32 v[72:73], v74
    v_add_f64 v[72:73], v[72:73], s[32:33]
    global_atomic_add_f64 v7, v[72:73], s[54:55] offset:0 sc1
    v_mov_b32 v78, v42
    s_nop 1
    v_mov_b32_dpp v78, v43 row_shr:8 row_mask:0xf bank_mask:0xf
    v_cvt_f64_f32 v[76:77], v78
    v_add_f64 v[76:77], v[76:77], s[32:33]
    global_atomic_add_f64 v7, v[76:77], s[54:55] offset:512 sc1
    v_add_u32 v7, 1024, v7
    v_mov_b32 v40, 0
    v_mov_b32 v41, 0
    v_mov_b32 v42, 0
    v_mov_b32 v43, 0
    s_waitcnt lgkmcnt(0)
    s_nop 0
    v_mfma_f32_16x16x32_bf16 v[40:43], v[24:27], v[8:11], v[40:43]
    v_mfma_f32_16x16x32_bf16 v[40:43], v[28:31], v[12:15], v[40:43]
    v_mfma_f32_16x16x32_bf16 v[40:43], v[32:35], v[16:19], v[40:43]
    v_mfma_f32_16x16x32_bf16 v[40:43], v[36:39], v[20:23], v[40:43]
    v_mov_b32 v74, v68
    s_nop 1
    v_mov_b32_dpp v74, v69 row_shr:8 row_mask:0xf bank_mask:0xf
    v_cvt_f64_f32 v[72:73], v74
    v_add_f64 v[72:73], v[72:73], s[32:33]
    global_atomic_add_f64 v7, v[72:73], s[54:55] offset:0 sc1
    v_mov_b32 v78, v70
    s_nop 1
    v_mov_b32_dpp v78, v71 row_shr:8 row_mask:0xf bank_mask:0xf
    v_cvt_f64_f32 v[76:77], v78
    v_add_f64 v[76:77], v[76:77], s[32:33]
    global_atomic_add_f64 v7, v[76:77], s[54:55] offset:512 sc1
    v_add_u32 v7, 1024, v7
    s_nop 7
    s_nop 1
    v_mov_b32 v74, v40
    s_nop 1
    v_mov_b32_dpp v74, v41 row_shr:8 row_mask:0xf bank_mask:0xf
    v_cvt_f64_f32 v[72:73], v74
    v_add_f64 v[72:73], v[72:73], s[32:33]
    global_atomic_add_f64 v7, v[72:73], s[54:55] offset:0 sc1
    v_mov_b32 v78, v42
    s_nop 1
    v_mov_b32_dpp v78, v43 row_shr:8 row_mask:0xf bank_mask:0xf
    v_cvt_f64_f32 v[76:77], v78
    v_add_f64 v[76:77], v[76:77], s[32:33]
    global_atomic_add_f64 v7, v[76:77], s[54:55] offset:512 sc1
    v_add_u32 v7, 1024, v7
    s_sub_u32 s20, s20, 1
    s_add_u32 s20, s20, 1
    s_branch rec_loop
rec_end:
    s_endpgm
.globl attn_kernel
.p2align 8
.type attn_kernel,@function
attn_kernel:
    s_cmp_ge_u32 s2, 512
    s_cbranch_scc1 attn_end
    s_load_dwordx2 s[4:5], s[0:1], 120
    v_lshrrev_b32 v1, 6, v0
    v_and_b32 v2, 63, v0
    s_nop 0
    v_readfirstlane_b32 s16, v1
    s_nop 3
    s_lshl_b32 s17, s2, 2
    s_add_u32 s17, s17, s16
    s_lshr_b32 s18, s17, 5
    s_and_b32 s19, s17, 31
    s_waitcnt lgkmcnt(0)
    s_lshl_b32 s20, s18, 18
    s_lshl_b32 s21, s19, 8
    s_add_u32 s20, s20, s21
    s_add_u32 s21, s20, 4734976
    s_add_u32 s6, s4, s21
    s_addc_u32 s7, s5, 0
    s_add_u32 s21, s20, 21512192
    s_add_u32 s8, s4, s21
    s_addc_u32 s9, s5, 0
    s_add_u32 s21, s20, 63455232
    s_add_u32 s10, s4, s21
    s_addc_u32 s11, s5, 0
    s_lshl_b32 s21, s19, 19
    s_lshl_b32 s22, s18, 6
    s_add_u32 s21, s21, s22
    s_add_u32 s21, s21, 38289408
    s_add_u32 s12, s4, s21
    s_addc_u32 s13, s5, 0
    s_lshl_b32 s21, s17, 11
    s_add_u32 s22, s21, 55066624
    s_add_u32 s14, s4, s22
    s_addc_u32 s15, s5, 0
    s_add_u32 s22, s21, 59260928
    s_add_u32 s24, s4, s22
    s_addc_u32 s25, s5, 0
    v_and_b32 v3, 31, v2
    v_lshrrev_b32 v4, 5, v2
    v_lshlrev_b32 v5, 13, v3
    v_lshl_add_u32 v5, v4, 4, v5
    v_and_b32 v6, 7, v2
    v_lshlrev_b32 v6, 8, v6
    v_lshl_add_u32 v6, v4, 4, v6
    global_load_dwordx4 v[16:19], v5, s[6:7] offset:0
    global_load_dwordx4 v[48:51], v5, s[8:9] offset:0
    global_load_dwordx4 v[80:83], v6, s[14:15] offset:0
    global_load_dwordx4 v[20:23], v5, s[6:7] offset:32
    global_load_dwordx4 v[52:55], v5, s[8:9] offset:32
    global_load_dwordx4 v[84:87], v6, s[14:15] offset:32
    global_load_dwordx4 v[24:27], v5, s[6:7] offset:64
    global_load_dwordx4 v[56:59], v5, s[8:9] offset:64
    global_load_dwordx4 v[88:91], v6, s[14:15] offset:64
    global_load_dwordx4 v[28:31], v5, s[6:7] offset:96
    global_load_dwordx4 v[60:63], v5, s[8:9] offset:96
    global_load_dwordx4 v[92:95], v6, s[14:15] offset:96
    global_load_dwordx4 v[32:35], v5, s[6:7] offset:128
    global_load_dwordx4 v[64:67], v5, s[8:9] offset:128
    global_load_dwordx4 v[96:99], v6, s[14:15] offset:128
    global_load_dwordx4 v[36:39], v5, s[6:7] offset:160
    global_load_dwordx4 v[68:71], v5, s[8:9] offset:160
    global_load_dwordx4 v[100:103], v6, s[14:15] offset:160
    global_load_dwordx4 v[40:43], v5, s[6:7] offset:192
    global_load_dwordx4 v[72:75], v5, s[8:9] offset:192
    global_load_dwordx4 v[104:107], v6, s[14:15] offset:192
    global_load_dwordx4 v[44:47], v5, s[6:7] offset:224
    global_load_dwordx4 v[76:79], v5, s[8:9] offset:224
    global_load_dwordx4 v[108:111], v6, s[14:15] offset:224
    v_lshlrev_b32 v7, 12, v3
    v_lshl_add_u32 v7, v4, 3, v7
    v_lshlrev_b32 v8, 4, v3
    v_lshl_add_u32 v8, v4, 3, v8
    global_load_dwordx2 v[112:113], v8, s[24:25] offset:0
    v_mov_b32 v114, 0
    v_mov_b32 v115, 0
    global_load_dwordx2 v[116:117], v7, s[12:13] offset:0
    global_load_dwordx2 v[118:119], v7, s[12:13] offset:16
    global_load_dwordx2 v[120:121], v7, s[12:13] offset:32
    global_load_dwordx2 v[122:123], v7, s[12:13] offset:48
    v_add_u32 v7, 131072, v7
    global_load_dwordx2 v[128:129], v8, s[24:25] offset:512
    v_mov_b32 v130, 0
    v_mov_b32 v131, 0
    global_load_dwordx2 v[132:133], v7, s[12:13] offset:0
    global_load_dwordx2 v[134:135], v7, s[12:13] offset:16
    global_load_dwordx2 v[136:137], v7, s[12:13] offset:32
    global_load_dwordx2 v[138:139], v7, s[12:13] offset:48
    v_add_u32 v7, 131072, v7
    global_load_dwordx2 v[144:145], v8, s[24:25] offset:1024
    v_mov_b32 v146, 0
    v_mov_b32 v147, 0
    global_load_dwordx2 v[148:149], v7, s[12:13] offset:0
    global_load_dwordx2 v[150:151], v7, s[12:13] offset:16
    global_load_dwordx2 v[152:153], v7, s[12:13] offset:32
    global_load_dwordx2 v[154:155], v7, s[12:13] offset:48
    v_add_u32 v7, 131072, v7
    global_load_dwordx2 v[160:161], v8, s[24:25] offset:1536
    v_mov_b32 v162, 0
    v_mov_b32 v163, 0
    global_load_dwordx2 v[164:165], v7, s[12:13] offset:0
    global_load_dwordx2 v[166:167], v7, s[12:13] offset:16
    global_load_dwordx2 v[168:169], v7, s[12:13] offset:32
    global_load_dwordx2 v[170:171], v7, s[12:13] offset:48
    v_mov_b32 v176, 0
    v_mov_b32 v177, 0
    v_mov_b32 v178, 0
    v_mov_b32 v179, 0
    v_mov_b32 v180, 0
    v_mov_b32 v181, 0
    v_mov_b32 v182, 0
    v_mov_b32 v183, 0
    v_mov_b32 v184, 0
    v_mov_b32 v185, 0
    v_mov_b32 v186, 0
    v_mov_b32 v187, 0
    v_mov_b32 v188, 0
    v_mov_b32 v189, 0
    v_mov_b32 v190, 0
    v_mov_b32 v191, 0
    v_mov_b32 v192, 0
    v_mov_b32 v193, 0
    v_mov_b32 v194, 0
    v_mov_b32 v195, 0
    v_mov_b32 v196, 0
    v_mov_b32 v197, 0
    v_mov_b32 v198, 0
    v_mov_b32 v199, 0
    v_mov_b32 v200, 0
    v_mov_b32 v201, 0
    v_mov_b32 v202, 0
    v_mov_b32 v203, 0
    v_mov_b32 v204, 0
    v_mov_b32 v205, 0
    v_mov_b32 v206, 0
    v_mov_b32 v207, 0
    s_waitcnt vmcnt(24)
    v_mfma_f32_32x32x16_bf16 v[176:191], v[80:83], v[16:19], v[176:191]
    v_mfma_f32_32x32x16_bf16 v[192:207], v[48:51], v[16:19], v[192:207]
    v_mfma_f32_32x32x16_bf16 v[176:191], v[84:87], v[20:23], v[176:191]
    v_mfma_f32_32x32x16_bf16 v[192:207], v[52:55], v[20:23], v[192:207]
    v_mfma_f32_32x32x16_bf16 v[176:191], v[88:91], v[24:27], v[176:191]
    v_mfma_f32_32x32x16_bf16 v[192:207], v[56:59], v[24:27], v[192:207]
    v_mfma_f32_32x32x16_bf16 v[176:191], v[92:95], v[28:31], v[176:191]
    v_mfma_f32_32x32x16_bf16 v[192:207], v[60:63], v[28:31], v[192:207]
    v_mfma_f32_32x32x16_bf16 v[176:191], v[96:99], v[32:35], v[176:191]
    v_mfma_f32_32x32x16_bf16 v[192:207], v[64:67], v[32:35], v[192:207]
    v_mfma_f32_32x32x16_bf16 v[176:191], v[100:103], v[36:39], v[176:191]
    v_mfma_f32_32x32x16_bf16 v[192:207], v[68:71], v[36:39], v[192:207]
    v_mfma_f32_32x32x16_bf16 v[176:191], v[104:107], v[40:43], v[176:191]
    v_mfma_f32_32x32x16_bf16 v[192:207], v[72:75], v[40:43], v[192:207]
    v_mfma_f32_32x32x16_bf16 v[176:191], v[108:111], v[44:47], v[176:191]
    v_mfma_f32_32x32x16_bf16 v[192:207], v[76:79], v[44:47], v[192:207]
    s_nop 7
    s_nop 7
    v_mov_b32 v9, 0xce6e6b28
    v_lshlrev_b32 v10, 2, v4
    v_cvt_pk_bf16_f32 v176, v176, v176
    v_lshlrev_b32 v176, 16, v176
    v_mul_f32 v176, 0x3db504f3, v176
    v_cvt_pk_bf16_f32 v176, v176, v176
    v_lshlrev_b32 v176, 16, v176
    v_cvt_pk_bf16_f32 v177, v177, v177
    v_lshlrev_b32 v177, 16, v177
    v_mul_f32 v177, 0x3db504f3, v177
    v_cvt_pk_bf16_f32 v177, v177, v177
    v_lshlrev_b32 v177, 16, v177
    v_cvt_pk_bf16_f32 v178, v178, v178
    v_lshlrev_b32 v178, 16, v178
    v_mul_f32 v178, 0x3db504f3, v178
    v_cvt_pk_bf16_f32 v178, v178, v178
    v_lshlrev_b32 v178, 16, v178
    v_cvt_pk_bf16_f32 v179, v179, v179
    v_lshlrev_b32 v179, 16, v179
    v_mul_f32 v179, 0x3db504f3, v179
    v_cvt_pk_bf16_f32 v179, v179, v179
    v_lshlrev_b32 v179, 16, v179
    v_cvt_pk_bf16_f32 v192, v192, v192
    v_lshlrev_b32 v192, 16, v192
    v_mul_f32 v192, 0x3db504f3, v192
    v_cvt_pk_bf16_f32 v192, v192, v192
    v_lshlrev_b32 v192, 16, v192
    v_add_u32 v11, 0, v10
    v_cmp_le_u32 vcc, v11, v3
    v_cndmask_b32 v192, v9, v192, vcc
    v_cvt_pk_bf16_f32 v193, v193, v193
    v_lshlrev_b32 v193, 16, v193
    v_mul_f32 v193, 0x3db504f3, v193
    v_cvt_pk_bf16_f32 v193, v193, v193
    v_lshlrev_b32 v193, 16, v193
    v_add_u32 v11, 1, v10
    v_cmp_le_u32 vcc, v11, v3
    v_cndmask_b32 v193, v9, v193, vcc
    v_cvt_pk_bf16_f32 v194, v194, v194
    v_lshlrev_b32 v194, 16, v194
    v_mul_f32 v194, 0x3db504f3, v194
    v_cvt_pk_bf16_f32 v194, v194, v194
    v_lshlrev_b32 v194, 16, v194
    v_add_u32 v11, 2, v10
    v_cmp_le_u32 vcc, v11, v3
    v_cndmask_b32 v194, v9, v194, vcc
    v_cvt_pk_bf16_f32 v195, v195, v195
    v_lshlrev_b32 v195, 16, v195
    v_mul_f32 v195, 0x3db504f3, v195
    v_cvt_pk_bf16_f32 v195, v195, v195
    v_lshlrev_b32 v195, 16, v195
    v_add_u32 v11, 3, v10
    v_cmp_le_u32 vcc, v11, v3
    v_cndmask_b32 v195, v9, v195, vcc
    v_cvt_pk_bf16_f32 v196, v196, v196
    v_lshlrev_b32 v196, 16, v196
    v_mul_f32 v196, 0x3db504f3, v196
    v_cvt_pk_bf16_f32 v196, v196, v196
    v_lshlrev_b32 v196, 16, v196
    v_add_u32 v11, 8, v10
    v_cmp_le_u32 vcc, v11, v3
    v_cndmask_b32 v196, v9, v196, vcc
    v_cvt_pk_bf16_f32 v197, v197, v197
    v_lshlrev_b32 v197, 16, v197
    v_mul_f32 v197, 0x3db504f3, v197
    v_cvt_pk_bf16_f32 v197, v197, v197
    v_lshlrev_b32 v197, 16, v197
    v_add_u32 v11, 9, v10
    v_cmp_le_u32 vcc, v11, v3
    v_cndmask_b32 v197, v9, v197, vcc
    v_cvt_pk_bf16_f32 v198, v198, v198
    v_lshlrev_b32 v198, 16, v198
    v_mul_f32 v198, 0x3db504f3, v198
    v_cvt_pk_bf16_f32 v198, v198, v198
    v_lshlrev_b32 v198, 16, v198
    v_add_u32 v11, 10, v10
    v_cmp_le_u32 vcc, v11, v3
    v_cndmask_b32 v198, v9, v198, vcc
    v_cvt_pk_bf16_f32 v199, v199, v199
    v_lshlrev_b32 v199, 16, v199
    v_mul_f32 v199, 0x3db504f3, v199
    v_cvt_pk_bf16_f32 v199, v199, v199
    v_lshlrev_b32 v199, 16, v199
    v_add_u32 v11, 11, v10
    v_cmp_le_u32 vcc, v11, v3
    v_cndmask_b32 v199, v9, v199, vcc
    v_cvt_pk_bf16_f32 v200, v200, v200
    v_lshlrev_b32 v200, 16, v200
    v_mul_f32 v200, 0x3db504f3, v200
    v_cvt_pk_bf16_f32 v200, v200, v200
    v_lshlrev_b32 v200, 16, v200
    v_add_u32 v11, 16, v10
    v_cmp_le_u32 vcc, v11, v3
    v_cndmask_b32 v200, v9, v200, vcc
    v_cvt_pk_bf16_f32 v201, v201, v201
    v_lshlrev_b32 v201, 16, v201
    v_mul_f32 v201, 0x3db504f3, v201
    v_cvt_pk_bf16_f32 v201, v201, v201
    v_lshlrev_b32 v201, 16, v201
    v_add_u32 v11, 17, v10
    v_cmp_le_u32 vcc, v11, v3
    v_cndmask_b32 v201, v9, v201, vcc
    v_cvt_pk_bf16_f32 v202, v202, v202
    v_lshlrev_b32 v202, 16, v202
    v_mul_f32 v202, 0x3db504f3, v202
    v_cvt_pk_bf16_f32 v202, v202, v202
    v_lshlrev_b32 v202, 16, v202
    v_add_u32 v11, 18, v10
    v_cmp_le_u32 vcc, v11, v3
    v_cndmask_b32 v202, v9, v202, vcc
    v_cvt_pk_bf16_f32 v203, v203, v203
    v_lshlrev_b32 v203, 16, v203
    v_mul_f32 v203, 0x3db504f3, v203
    v_cvt_pk_bf16_f32 v203, v203, v203
    v_lshlrev_b32 v203, 16, v203
    v_add_u32 v11, 19, v10
    v_cmp_le_u32 vcc, v11, v3
    v_cndmask_b32 v203, v9, v203, vcc
    v_cvt_pk_bf16_f32 v204, v204, v204
    v_lshlrev_b32 v204, 16, v204
    v_mul_f32 v204, 0x3db504f3, v204
    v_cvt_pk_bf16_f32 v204, v204, v204
    v_lshlrev_b32 v204, 16, v204
    v_add_u32 v11, 24, v10
    v_cmp_le_u32 vcc, v11, v3
    v_cndmask_b32 v204, v9, v204, vcc
    v_cvt_pk_bf16_f32 v205, v205, v205
    v_lshlrev_b32 v205, 16, v205
    v_mul_f32 v205, 0x3db504f3, v205
    v_cvt_pk_bf16_f32 v205, v205, v205
    v_lshlrev_b32 v205, 16, v205
    v_add_u32 v11, 25, v10
    v_cmp_le_u32 vcc, v11, v3
    v_cndmask_b32 v205, v9, v205, vcc
    v_cvt_pk_bf16_f32 v206, v206, v206
    v_lshlrev_b32 v206, 16, v206
    v_mul_f32 v206, 0x3db504f3, v206
    v_cvt_pk_bf16_f32 v206, v206, v206
    v_lshlrev_b32 v206, 16, v206
    v_add_u32 v11, 26, v10
    v_cmp_le_u32 vcc, v11, v3
    v_cndmask_b32 v206, v9, v206, vcc
    v_cvt_pk_bf16_f32 v207, v207, v207
    v_lshlrev_b32 v207, 16, v207
    v_mul_f32 v207, 0x3db504f3, v207
    v_cvt_pk_bf16_f32 v207, v207, v207
    v_lshlrev_b32 v207, 16, v207
    v_add_u32 v11, 27, v10
    v_cmp_le_u32 vcc, v11, v3
    v_cndmask_b32 v207, v9, v207, vcc
    v_max_f32 v12, v176, v177
    v_max_f32 v12, v12, v178
    v_max_f32 v12, v12, v179
    v_max_f32 v12, v12, v192
    v_max_f32 v12, v12, v193
    v_max_f32 v12, v12, v194
    v_max_f32 v12, v12, v195
    v_max_f32 v12, v12, v196
    v_max_f32 v12, v12, v197
    v_max_f32 v12, v12, v198
    v_max_f32 v12, v12, v199
    v_max_f32 v12, v12, v200
    v_max_f32 v12, v12, v201
    v_max_f32 v12, v12, v202
    v_max_f32 v12, v12, v203
    v_max_f32 v12, v12, v204
    v_max_f32 v12, v12, v205
    v_max_f32 v12, v12, v206
    v_max_f32 v12, v12, v207
    v_xor_b32 v13, 32, v2
    v_lshlrev_b32 v13, 2, v13
    ds_bpermute_b32 v14, v13, v12
    s_waitcnt lgkmcnt(0)
    v_max_f32 v12, v12, v14
    v_mov_b32 v15, 0
    v_sub_f32 v176, v176, v12
    v_mul_f32 v176, 0x3fb8aa3b, v176
    v_exp_f32 v176, v176
    s_nop 0
    v_add_f32 v15, v15, v176
    v_sub_f32 v177, v177, v12
    v_mul_f32 v177, 0x3fb8aa3b, v177
    v_exp_f32 v177, v177
    s_nop 0
    v_add_f32 v15, v15, v177
    v_sub_f32 v178, v178, v12
    v_mul_f32 v178, 0x3fb8aa3b, v178
    v_exp_f32 v178, v178
    s_nop 0
    v_add_f32 v15, v15, v178
    v_sub_f32 v179, v179, v12
    v_mul_f32 v179, 0x3fb8aa3b, v179
    v_exp_f32 v179, v179
    s_nop 0
    v_add_f32 v15, v15, v179
    v_sub_f32 v192, v192, v12
    v_mul_f32 v192, 0x3fb8aa3b, v192
    v_exp_f32 v192, v192
    s_nop 0
    v_add_f32 v15, v15, v192
    v_sub_f32 v193, v193, v12
    v_mul_f32 v193, 0x3fb8aa3b, v193
    v_exp_f32 v193, v193
    s_nop 0
    v_add_f32 v15, v15, v193
    v_sub_f32 v194, v194, v12
    v_mul_f32 v194, 0x3fb8aa3b, v194
    v_exp_f32 v194, v194
    s_nop 0
    v_add_f32 v15, v15, v194
    v_sub_f32 v195, v195, v12
    v_mul_f32 v195, 0x3fb8aa3b, v195
    v_exp_f32 v195, v195
    s_nop 0
    v_add_f32 v15, v15, v195
    v_sub_f32 v196, v196, v12
    v_mul_f32 v196, 0x3fb8aa3b, v196
    v_exp_f32 v196, v196
    s_nop 0
    v_add_f32 v15, v15, v196
    v_sub_f32 v197, v197, v12
    v_mul_f32 v197, 0x3fb8aa3b, v197
    v_exp_f32 v197, v197
    s_nop 0
    v_add_f32 v15, v15, v197
    v_sub_f32 v198, v198, v12
    v_mul_f32 v198, 0x3fb8aa3b, v198
    v_exp_f32 v198, v198
    s_nop 0
    v_add_f32 v15, v15, v198
    v_sub_f32 v199, v199, v12
    v_mul_f32 v199, 0x3fb8aa3b, v199
    v_exp_f32 v199, v199
    s_nop 0
    v_add_f32 v15, v15, v199
    v_sub_f32 v200, v200, v12
    v_mul_f32 v200, 0x3fb8aa3b, v200
    v_exp_f32 v200, v200
    s_nop 0
    v_add_f32 v15, v15, v200
    v_sub_f32 v201, v201, v12
    v_mul_f32 v201, 0x3fb8aa3b, v201
    v_exp_f32 v201, v201
    s_nop 0
    v_add_f32 v15, v15, v201
    v_sub_f32 v202, v202, v12
    v_mul_f32 v202, 0x3fb8aa3b, v202
    v_exp_f32 v202, v202
    s_nop 0
    v_add_f32 v15, v15, v202
    v_sub_f32 v203, v203, v12
    v_mul_f32 v203, 0x3fb8aa3b, v203
    v_exp_f32 v203, v203
    s_nop 0
    v_add_f32 v15, v15, v203
    v_sub_f32 v204, v204, v12
    v_mul_f32 v204, 0x3fb8aa3b, v204
    v_exp_f32 v204, v204
    s_nop 0
    v_add_f32 v15, v15, v204
    v_sub_f32 v205, v205, v12
    v_mul_f32 v205, 0x3fb8aa3b, v205
    v_exp_f32 v205, v205
    s_nop 0
    v_add_f32 v15, v15, v205
    v_sub_f32 v206, v206, v12
    v_mul_f32 v206, 0x3fb8aa3b, v206
    v_exp_f32 v206, v206
    s_nop 0
    v_add_f32 v15, v15, v206
    v_sub_f32 v207, v207, v12
    v_mul_f32 v207, 0x3fb8aa3b, v207
    v_exp_f32 v207, v207
    s_nop 0
    v_add_f32 v15, v15, v207
    ds_bpermute_b32 v14, v13, v15
    s_waitcnt lgkmcnt(0)
    v_add_f32 v15, v15, v14
    v_rcp_f32 v15, v15
    s_nop 0
    v_mul_f32 v176, v176, v15
    v_mul_f32 v177, v177, v15
    v_mul_f32 v178, v178, v15
    v_mul_f32 v179, v179, v15
    v_mul_f32 v192, v192, v15
    v_mul_f32 v193, v193, v15
    v_mul_f32 v194, v194, v15
    v_mul_f32 v195, v195, v15
    v_mul_f32 v196, v196, v15
    v_mul_f32 v197, v197, v15
    v_mul_f32 v198, v198, v15
    v_mul_f32 v199, v199, v15
    v_mul_f32 v200, v200, v15
    v_mul_f32 v201, v201, v15
    v_mul_f32 v202, v202, v15
    v_mul_f32 v203, v203, v15
    v_mul_f32 v204, v204, v15
    v_mul_f32 v205, v205, v15
    v_mul_f32 v206, v206, v15
    v_mul_f32 v207, v207, v15
    v_cvt_pk_bf16_f32 v16, v176, v177
    v_cvt_pk_bf16_f32 v17, v178, v179
    v_mov_b32 v18, 0
    v_mov_b32 v19, 0
    v_cvt_pk_bf16_f32 v20, v192, v193
    v_cvt_pk_bf16_f32 v21, v194, v195
    v_cvt_pk_bf16_f32 v22, v196, v197
    v_cvt_pk_bf16_f32 v23, v198, v199
    v_cvt_pk_bf16_f32 v24, v200, v201
    v_cvt_pk_bf16_f32 v25, v202, v203
    v_cvt_pk_bf16_f32 v26, v204, v205
    v_cvt_pk_bf16_f32 v27, v206, v207
    s_waitcnt vmcnt(0)
    v_lshlrev_b32 v5, 13, v3
    v_lshl_add_u32 v5, v4, 3, v5
    v_mov_b32 v48, 0
    v_mov_b32 v49, 0
    v_mov_b32 v50, 0
    v_mov_b32 v51, 0
    v_mov_b32 v52, 0
    v_mov_b32 v53, 0
    v_mov_b32 v54, 0
    v_mov_b32 v55, 0
    v_mov_b32 v56, 0
    v_mov_b32 v57, 0
    v_mov_b32 v58, 0
    v_mov_b32 v59, 0
    v_mov_b32 v60, 0
    v_mov_b32 v61, 0
    v_mov_b32 v62, 0
    v_mov_b32 v63, 0
    s_nop 1
    v_mfma_f32_32x32x16_bf16 v[48:63], v[112:115], v[16:19], v[48:63]
    v_mfma_f32_32x32x16_bf16 v[48:63], v[116:119], v[20:23], v[48:63]
    v_mfma_f32_32x32x16_bf16 v[48:63], v[120:123], v[24:27], v[48:63]
    v_mov_b32 v64, 0
    v_mov_b32 v65, 0
    v_mov_b32 v66, 0
    v_mov_b32 v67, 0
    v_mov_b32 v68, 0
    v_mov_b32 v69, 0
    v_mov_b32 v70, 0
    v_mov_b32 v71, 0
    v_mov_b32 v72, 0
    v_mov_b32 v73, 0
    v_mov_b32 v74, 0
    v_mov_b32 v75, 0
    v_mov_b32 v76, 0
    v_mov_b32 v77, 0
    v_mov_b32 v78, 0
    v_mov_b32 v79, 0
    s_nop 1
    v_mfma_f32_32x32x16_bf16 v[64:79], v[128:131], v[16:19], v[64:79]
    v_mfma_f32_32x32x16_bf16 v[64:79], v[132:135], v[20:23], v[64:79]
    v_mfma_f32_32x32x16_bf16 v[64:79], v[136:139], v[24:27], v[64:79]
    v_mov_b32 v80, 0
    v_mov_b32 v81, 0
    v_mov_b32 v82, 0
    v_mov_b32 v83, 0
    v_mov_b32 v84, 0
    v_mov_b32 v85, 0
    v_mov_b32 v86, 0
    v_mov_b32 v87, 0
    v_mov_b32 v88, 0
    v_mov_b32 v89, 0
    v_mov_b32 v90, 0
    v_mov_b32 v91, 0
    v_mov_b32 v92, 0
    v_mov_b32 v93, 0
    v_mov_b32 v94, 0
    v_mov_b32 v95, 0
    s_nop 1
    v_mfma_f32_32x32x16_bf16 v[80:95], v[144:147], v[16:19], v[80:95]
    v_mfma_f32_32x32x16_bf16 v[80:95], v[148:151], v[20:23], v[80:95]
    v_mfma_f32_32x32x16_bf16 v[80:95], v[152:155], v[24:27], v[80:95]
    v_mov_b32 v96, 0
    v_mov_b32 v97, 0
    v_mov_b32 v98, 0
    v_mov_b32 v99, 0
    v_mov_b32 v100, 0
    v_mov_b32 v101, 0
    v_mov_b32 v102, 0
    v_mov_b32 v103, 0
    v_mov_b32 v104, 0
    v_mov_b32 v105, 0
    v_mov_b32 v106, 0
    v_mov_b32 v107, 0
    v_mov_b32 v108, 0
    v_mov_b32 v109, 0
    v_mov_b32 v110, 0
    v_mov_b32 v111, 0
    s_nop 1
    v_mfma_f32_32x32x16_bf16 v[96:111], v[160:163], v[16:19], v[96:111]
    v_mfma_f32_32x32x16_bf16 v[96:111], v[164:167], v[20:23], v[96:111]
    v_mfma_f32_32x32x16_bf16 v[96:111], v[168:171], v[24:27], v[96:111]
    s_nop 7
    s_nop 7
    v_cvt_pk_bf16_f32 v28, v48, v49
    v_cvt_pk_bf16_f32 v29, v50, v51
    global_store_dwordx2 v5, v[28:29], s[10:11] offset:0
    v_cvt_pk_bf16_f32 v28, v52, v53
    v_cvt_pk_bf16_f32 v29, v54, v55
    global_store_dwordx2 v5, v[28:29], s[10:11] offset:16
    v_cvt_pk_bf16_f32 v28, v56, v57
    v_cvt_pk_bf16_f32 v29, v58, v59
    global_store_dwordx2 v5, v[28:29], s[10:11] offset:32
    v_cvt_pk_bf16_f32 v28, v60, v61
    v_cvt_pk_bf16_f32 v29, v62, v63
    global_store_dwordx2 v5, v[28:29], s[10:11] offset:48
    v_cvt_pk_bf16_f32 v28, v64, v65
    v_cvt_pk_bf16_f32 v29, v66, v67
    global_store_dwordx2 v5, v[28:29], s[10:11] offset:64
    v_cvt_pk_bf16_f32 v28, v68, v69
    v_cvt_pk_bf16_f32 v29, v70, v71
    global_store_dwordx2 v5, v[28:29], s[10:11] offset:80
    v_cvt_pk_bf16_f32 v28, v72, v73
    v_cvt_pk_bf16_f32 v29, v74, v75
    global_store_dwordx2 v5, v[28:29], s[10:11] offset:96
    v_cvt_pk_bf16_f32 v28, v76, v77
    v_cvt_pk_bf16_f32 v29, v78, v79
    global_store_dwordx2 v5, v[28:29], s[10:11] offset:112
    v_cvt_pk_bf16_f32 v28, v80, v81
    v_cvt_pk_bf16_f32 v29, v82, v83
    global_store_dwordx2 v5, v[28:29], s[10:11] offset:128
    v_cvt_pk_bf16_f32 v28, v84, v85
    v_cvt_pk_bf16_f32 v29, v86, v87
    global_store_dwordx2 v5, v[28:29], s[10:11] offset:144
    v_cvt_pk_bf16_f32 v28, v88, v89
    v_cvt_pk_bf16_f32 v29, v90, v91
    global_store_dwordx2 v5, v[28:29], s[10:11] offset:160
    v_cvt_pk_bf16_f32 v28, v92, v93
    v_cvt_pk_bf16_f32 v29, v94, v95
    global_store_dwordx2 v5, v[28:29], s[10:11] offset:176
    v_cvt_pk_bf16_f32 v28, v96, v97
    v_cvt_pk_bf16_f32 v29, v98, v99
    global_store_dwordx2 v5, v[28:29], s[10:11] offset:192
    v_cvt_pk_bf16_f32 v28, v100, v101
    v_cvt_pk_bf16_f32 v29, v102, v103
    global_store_dwordx2 v5, v[28:29], s[10:11] offset:208
    v_cvt_pk_bf16_f32 v28, v104, v105
    v_cvt_pk_bf16_f32 v29, v106, v107
    global_store_dwordx2 v5, v[28:29], s[10:11] offset:224
    v_cvt_pk_bf16_f32 v28, v108, v109
    v_cvt_pk_bf16_f32 v29, v110, v111
    global_store_dwordx2 v5, v[28:29], s[10:11] offset:240
attn_end:
    s_endpgm
.globl oproj_kernel
.p2align 8
.type oproj_kernel,@function
oproj_kernel:
    s_cmp_ge_u32 s2, 80
    s_cbranch_scc1 oproj_kernel_end
    s_load_dwordx2 s[4:5], s[0:1], 120
    s_load_dwordx2 s[6:7], s[0:1], 120
    s_load_dwordx2 s[8:9], s[0:1], 40
    s_load_dwordx2 s[40:41], s[0:1], 0
    s_load_dwordx2 s[42:43], s[0:1], 104
    s_and_b32 s16, s2, 15
    s_lshr_b32 s17, s2, 4
    s_waitcnt lgkmcnt(0)
    s_add_u32 s6, s6, 63455232
    s_addc_u32 s7, s7, 0
    s_mul_i32 s18, s16, 1048576
    s_add_u32 s6, s6, s18
    s_addc_u32 s7, s7, 0
    s_lshl_b32 s19, s17, 8
    s_add_u32 s8, s8, s19
    s_addc_u32 s9, s9, 0
    v_lshrrev_b32 v1, 6, v0
    v_and_b32 v2, 63, v0
    s_nop 0
    v_readfirstlane_b32 s12, v1
    s_nop 3
    s_lshl_b32 s13, s12, 12
    v_lshrrev_b32 v3, 3, v2
    v_lshrrev_b32 v4, 4, v2
    v_and_b32 v5, 7, v2
    v_lshlrev_b32 v6, 5, v1
    s_mov_b32 s20, 8192
    v_add_u32 v7, 0, v4
    v_and_b32 v7, 7, v7
    v_xor_b32 v7, v5, v7
    v_add_u32 v8, 0, v3
    v_add_u32 v8, v8, v6
    v_mul_lo_u32 v8, v8, s20
    v_lshl_add_u32 v8, v7, 4, v8
    v_add_u32 v7, 4, v4
    v_and_b32 v7, 7, v7
    v_xor_b32 v7, v5, v7
    v_add_u32 v9, 8, v3
    v_add_u32 v9, v9, v6
    v_mul_lo_u32 v9, v9, s20
    v_lshl_add_u32 v9, v7, 4, v9
    v_add_u32 v7, 8, v4
    v_and_b32 v7, 7, v7
    v_xor_b32 v7, v5, v7
    v_add_u32 v10, 16, v3
    v_add_u32 v10, v10, v6
    v_mul_lo_u32 v10, v10, s20
    v_lshl_add_u32 v10, v7, 4, v10
    v_add_u32 v7, 12, v4
    v_and_b32 v7, 7, v7
    v_xor_b32 v7, v5, v7
    v_add_u32 v11, 24, v3
    v_add_u32 v11, v11, v6
    v_mul_lo_u32 v11, v11, s20
    v_lshl_add_u32 v11, v7, 4, v11
    v_and_b32 v5, 15, v2
    v_lshrrev_b32 v7, 2, v5
    v_xor_b32 v7, v7, v4
    v_and_b32 v5, 3, v5
    v_lshl_add_u32 v7, v7, 2, v5
    v_lshlrev_b32 v6, 4, v1
    s_mov_b32 s20, 1152
    v_add_u32 v3, 0, v4
    v_add_u32 v3, v3, v6
    v_mul_lo_u32 v3, v3, s20
    s_lshl_b32 s19, s17, 4
    v_add_u32 v5, s19, v7
    v_cmp_le_u32 vcc, 72, v5
    v_subrev_u32 v5, 8, v7
    v_cndmask_b32 v5, v7, v5, vcc
    v_lshl_add_u32 v3, v5, 4, v3
    v_mov_b32 v21, s9
    v_add_co_u32 v12, vcc, s8, v3
    v_addc_co_u32 v13, vcc, 0, v21, vcc
    v_add_u32 v3, 4, v4
    v_add_u32 v3, v3, v6
    v_mul_lo_u32 v3, v3, s20
    s_lshl_b32 s19, s17, 4
    v_add_u32 v5, s19, v7
    v_cmp_le_u32 vcc, 72, v5
    v_subrev_u32 v5, 8, v7
    v_cndmask_b32 v5, v7, v5, vcc
    v_lshl_add_u32 v3, v5, 4, v3
    v_mov_b32 v21, s9
    v_add_co_u32 v14, vcc, s8, v3
    v_addc_co_u32 v15, vcc, 0, v21, vcc
    v_add_u32 v3, 8, v4
    v_add_u32 v3, v3, v6
    v_mul_lo_u32 v3, v3, s20
    s_lshl_b32 s19, s17, 4
    v_add_u32 v5, s19, v7
    v_cmp_le_u32 vcc, 72, v5
    v_subrev_u32 v5, 8, v7
    v_cndmask_b32 v5, v7, v5, vcc
    v_lshl_add_u32 v3, v5, 4, v3
    v_mov_b32 v21, s9
    v_add_co_u32 v16, vcc, s8, v3
    v_addc_co_u32 v17, vcc, 0, v21, vcc
    v_add_u32 v3, 12, v4
    v_add_u32 v3, v3, v6
    v_mul_lo_u32 v3, v3, s20
    s_lshl_b32 s19, s17, 4
    v_add_u32 v5, s19, v7
    v_cmp_le_u32 vcc, 72, v5
    v_subrev_u32 v5, 8, v7
    v_cndmask_b32 v5, v7, v5, vcc
    v_lshl_add_u32 v3, v5, 4, v3
    v_mov_b32 v21, s9
    v_add_co_u32 v18, vcc, s8, v3
    v_addc_co_u32 v19, vcc, 0, v21, vcc
    v_and_b32 v3, 31, v2
    v_lshrrev_b32 v4, 5, v2
    v_and_b32 v5, 1, v1
    v_lshl_add_u32 v6, v5, 6, v3
    v_lshrrev_b32 v7, 1, v3
    v_and_b32 v7, 7, v7
    v_add_u32 v26, 0, v4
    v_xor_b32 v26, v26, v7
    v_lshlrev_b32 v26, 4, v26
    v_lshl_add_u32 v20, v6, 7, v26
    v_add_u32 v26, 2, v4
    v_xor_b32 v26, v26, v7
    v_lshlrev_b32 v26, 4, v26
    v_lshl_add_u32 v21, v6, 7, v26
    v_add_u32 v26, 4, v4
    v_xor_b32 v26, v26, v7
    v_lshlrev_b32 v26, 4, v26
    v_lshl_add_u32 v22, v6, 7, v26
    v_add_u32 v26, 6, v4
    v_xor_b32 v26, v26, v7
    v_lshlrev_b32 v26, 4, v26
    v_lshl_add_u32 v23, v6, 7, v26
    v_lshrrev_b32 v5, 1, v1
    v_and_b32 v6, 15, v2
    v_lshrrev_b32 v7, 2, v6
    v_lshl_add_u32 v26, v4, 3, v7
    v_lshrrev_b32 v27, 4, v2
    v_and_b32 v27, 1, v27
    v_and_b32 v28, 3, v2
    v_lshlrev_b32 v28, 3, v28
    v_lshl_add_u32 v28, v27, 5, v28
    v_lshl_add_u32 v29, v5, 1, 0
    v_xor_b32 v29, v29, v7
    v_lshl_add_u32 v29, v29, 6, v28
    v_lshl_add_u32 v24, v26, 8, v29
    v_add_u32 v24, 16384, v24
    v_lshl_add_u32 v29, v5, 1, 1
    v_xor_b32 v29, v29, v7
    v_lshl_add_u32 v29, v29, 6, v28
    v_lshl_add_u32 v25, v26, 8, v29
    v_add_u32 v25, 16384, v25
    v_mov_b32 v64, 0
    v_mov_b32 v65, 0
    v_mov_b32 v66, 0
    v_mov_b32 v67, 0
    v_mov_b32 v68, 0
    v_mov_b32 v69, 0
    v_mov_b32 v70, 0
    v_mov_b32 v71, 0
    v_mov_b32 v72, 0
    v_mov_b32 v73, 0
    v_mov_b32 v74, 0
    v_mov_b32 v75, 0
    v_mov_b32 v76, 0
    v_mov_b32 v77, 0
    v_mov_b32 v78, 0
    v_mov_b32 v79, 0
    v_mov_b32 v80, 0
    v_mov_b32 v81, 0
    v_mov_b32 v82, 0
    v_mov_b32 v83, 0
    v_mov_b32 v84, 0
    v_mov_b32 v85, 0
    v_mov_b32 v86, 0
    v_mov_b32 v87, 0
    v_mov_b32 v88, 0
    v_mov_b32 v89, 0
    v_mov_b32 v90, 0
    v_mov_b32 v91, 0
    v_mov_b32 v92, 0
    v_mov_b32 v93, 0
    v_mov_b32 v94, 0
    v_mov_b32 v95, 0
    v_mov_b32 v96, 0
    v_mov_b32 v97, 0
    v_mov_b32 v98, 0
    v_mov_b32 v99, 0
    v_mov_b32 v100, 0
    v_mov_b32 v101, 0
    v_mov_b32 v102, 0
    v_mov_b32 v103, 0
    v_mov_b32 v104, 0
    v_mov_b32 v105, 0
    v_mov_b32 v106, 0
    v_mov_b32 v107, 0
    v_mov_b32 v108, 0
    v_mov_b32 v109, 0
    v_mov_b32 v110, 0
    v_mov_b32 v111, 0
    v_mov_b32 v112, 0
    v_mov_b32 v113, 0
    v_mov_b32 v114, 0
    v_mov_b32 v115, 0
    v_mov_b32 v116, 0
    v_mov_b32 v117, 0
    v_mov_b32 v118, 0
    v_mov_b32 v119, 0
    v_mov_b32 v120, 0
    v_mov_b32 v121, 0
    v_mov_b32 v122, 0
    v_mov_b32 v123, 0
    v_mov_b32 v124, 0
    v_mov_b32 v125, 0
    v_mov_b32 v126, 0
    v_mov_b32 v127, 0
    s_add_u32 m0, s13, 0
    s_nop 0
    global_load_lds_dwordx4 v8, s[6:7]
    s_add_u32 m0, s13, 1024
    s_nop 0
    global_load_lds_dwordx4 v9, s[6:7]
    s_add_u32 m0, s13, 2048
    s_nop 0
    global_load_lds_dwordx4 v10, s[6:7]
    s_add_u32 m0, s13, 3072
    s_nop 0
    global_load_lds_dwordx4 v11, s[6:7]
    s_add_u32 m0, s13, 16384
    s_nop 0
    global_load_lds_dwordx4 v[12:13], off
    s_add_u32 m0, s13, 17408
    s_nop 0
    global_load_lds_dwordx4 v[14:15], off
    s_add_u32 m0, s13, 18432
    s_nop 0
    global_load_lds_dwordx4 v[16:17], off
    s_add_u32 m0, s13, 19456
    s_nop 0
    global_load_lds_dwordx4 v[18:19], off
    s_add_u32 s6, s6, 128
    s_addc_u32 s7, s7, 0
    v_add_co_u32 v12, vcc, 73728, v12
    v_addc_co_u32 v13, vcc, 0, v13, vcc
    v_add_co_u32 v14, vcc, 73728, v14
    v_addc_co_u32 v15, vcc, 0, v15, vcc
    v_add_co_u32 v16, vcc, 73728, v16
    v_addc_co_u32 v17, vcc, 0, v17, vcc
    v_add_co_u32 v18, vcc, 73728, v18
    v_addc_co_u32 v19, vcc, 0, v19, vcc
    s_mov_b32 s21, 31
oproj_kernel_loop:
    s_add_u32 m0, s13, 32768
    s_nop 0
    global_load_lds_dwordx4 v8, s[6:7]
    s_add_u32 m0, s13, 33792
    s_nop 0
    global_load_lds_dwordx4 v9, s[6:7]
    s_add_u32 m0, s13, 34816
    s_nop 0
    global_load_lds_dwordx4 v10, s[6:7]
    s_add_u32 m0, s13, 35840
    s_nop 0
    global_load_lds_dwordx4 v11, s[6:7]
    s_add_u32 m0, s13, 49152
    s_nop 0
    global_load_lds_dwordx4 v[12:13], off
    s_add_u32 m0, s13, 50176
    s_nop 0
    global_load_lds_dwordx4 v[14:15], off
    s_add_u32 m0, s13, 51200
    s_nop 0
    global_load_lds_dwordx4 v[16:17], off
    s_add_u32 m0, s13, 52224
    s_nop 0
    global_load_lds_dwordx4 v[18:19], off
    s_add_u32 s6, s6, 128
    s_addc_u32 s7, s7, 0
    v_add_co_u32 v12, vcc, 73728, v12
    v_addc_co_u32 v13, vcc, 0, v13, vcc
    v_add_co_u32 v14, vcc, 73728, v14
    v_addc_co_u32 v15, vcc, 0, v15, vcc
    v_add_co_u32 v16, vcc, 73728, v16
    v_addc_co_u32 v17, vcc, 0, v17, vcc
    v_add_co_u32 v18, vcc, 73728, v18
    v_addc_co_u32 v19, vcc, 0, v19, vcc
    s_waitcnt vmcnt(8)
    s_barrier
    ds_read_b128 v[32:35], v20 offset:0
    ds_read_b128 v[36:39], v20 offset:4096
    ds_read_b64_tr_b16 v[40:41], v24 offset:0
    ds_read_b64_tr_b16 v[42:43], v24 offset:1024
    ds_read_b64_tr_b16 v[44:45], v25 offset:0
    ds_read_b64_tr_b16 v[46:47], v25 offset:1024
    ds_read_b128 v[48:51], v21 offset:0
    ds_read_b128 v[52:55], v21 offset:4096
    ds_read_b64_tr_b16 v[56:57], v24 offset:4096
    ds_read_b64_tr_b16 v[58:59], v24 offset:5120
    ds_read_b64_tr_b16 v[60:61], v25 offset:4096
    ds_read_b64_tr_b16 v[62:63], v25 offset:5120
    s_waitcnt lgkmcnt(6)
    v_mfma_f32_32x32x16_bf16 v[64:79], v[40:43], v[32:35], v[64:79]
    v_mfma_f32_32x32x16_bf16 v[80:95], v[44:47], v[32:35], v[80:95]
    v_mfma_f32_32x32x16_bf16 v[96:111], v[40:43], v[36:39], v[96:111]
    v_mfma_f32_32x32x16_bf16 v[112:127], v[44:47], v[36:39], v[112:127]
    ds_read_b128 v[32:35], v22 offset:0
    ds_read_b128 v[36:39], v22 offset:4096
    ds_read_b64_tr_b16 v[40:41], v24 offset:8192
    ds_read_b64_tr_b16 v[42:43], v24 offset:9216
    ds_read_b64_tr_b16 v[44:45], v25 offset:8192
    ds_read_b64_tr_b16 v[46:47], v25 offset:9216
    s_waitcnt lgkmcnt(6)
    v_mfma_f32_32x32x16_bf16 v[64:79], v[56:59], v[48:51], v[64:79]
    v_mfma_f32_32x32x16_bf16 v[80:95], v[60:63], v[48:51], v[80:95]
    v_mfma_f32_32x32x16_bf16 v[96:111], v[56:59], v[52:55], v[96:111]
    v_mfma_f32_32x32x16_bf16 v[112:127], v[60:63], v[52:55], v[112:127]
    ds_read_b128 v[48:51], v23 offset:0
    ds_read_b128 v[52:55], v23 offset:4096
    ds_read_b64_tr_b16 v[56:57], v24 offset:12288
    ds_read_b64_tr_b16 v[58:59], v24 offset:13312
    ds_read_b64_tr_b16 v[60:61], v25 offset:12288
    ds_read_b64_tr_b16 v[62:63], v25 offset:13312
    s_waitcnt lgkmcnt(6)
    v_mfma_f32_32x32x16_bf16 v[64:79], v[40:43], v[32:35], v[64:79]
    v_mfma_f32_32x32x16_bf16 v[80:95], v[44:47], v[32:35], v[80:95]
    v_mfma_f32_32x32x16_bf16 v[96:111], v[40:43], v[36:39], v[96:111]
    v_mfma_f32_32x32x16_bf16 v[112:127], v[44:47], v[36:39], v[112:127]
    s_waitcnt lgkmcnt(0)
    v_mfma_f32_32x32x16_bf16 v[64:79], v[56:59], v[48:51], v[64:79]
    v_mfma_f32_32x32x16_bf16 v[80:95], v[60:63], v[48:51], v[80:95]
    v_mfma_f32_32x32x16_bf16 v[96:111], v[56:59], v[52:55], v[96:111]
    v_mfma_f32_32x32x16_bf16 v[112:127], v[60:63], v[52:55], v[112:127]
    s_barrier
    s_add_u32 m0, s13, 0
    s_nop 0
    global_load_lds_dwordx4 v8, s[6:7]
    s_add_u32 m0, s13, 1024
    s_nop 0
    global_load_lds_dwordx4 v9, s[6:7]
    s_add_u32 m0, s13, 2048
    s_nop 0
    global_load_lds_dwordx4 v10, s[6:7]
    s_add_u32 m0, s13, 3072
    s_nop 0
    global_load_lds_dwordx4 v11, s[6:7]
    s_add_u32 m0, s13, 16384
    s_nop 0
    global_load_lds_dwordx4 v[12:13], off
    s_add_u32 m0, s13, 17408
    s_nop 0
    global_load_lds_dwordx4 v[14:15], off
    s_add_u32 m0, s13, 18432
    s_nop 0
    global_load_lds_dwordx4 v[16:17], off
    s_add_u32 m0, s13, 19456
    s_nop 0
    global_load_lds_dwordx4 v[18:19], off
    s_add_u32 s6, s6, 128
    s_addc_u32 s7, s7, 0
    v_add_co_u32 v12, vcc, 73728, v12
    v_addc_co_u32 v13, vcc, 0, v13, vcc
    v_add_co_u32 v14, vcc, 73728, v14
    v_addc_co_u32 v15, vcc, 0, v15, vcc
    v_add_co_u32 v16, vcc, 73728, v16
    v_addc_co_u32 v17, vcc, 0, v17, vcc
    v_add_co_u32 v18, vcc, 73728, v18
    v_addc_co_u32 v19, vcc, 0, v19, vcc
    s_waitcnt vmcnt(8)
    s_barrier
    ds_read_b128 v[32:35], v20 offset:32768
    ds_read_b128 v[36:39], v20 offset:36864
    ds_read_b64_tr_b16 v[40:41], v24 offset:32768
    ds_read_b64_tr_b16 v[42:43], v24 offset:33792
    ds_read_b64_tr_b16 v[44:45], v25 offset:32768
    ds_read_b64_tr_b16 v[46:47], v25 offset:33792
    ds_read_b128 v[48:51], v21 offset:32768
    ds_read_b128 v[52:55], v21 offset:36864
    ds_read_b64_tr_b16 v[56:57], v24 offset:36864
    ds_read_b64_tr_b16 v[58:59], v24 offset:37888
    ds_read_b64_tr_b16 v[60:61], v25 offset:36864
    ds_read_b64_tr_b16 v[62:63], v25 offset:37888
    s_waitcnt lgkmcnt(6)
    v_mfma_f32_32x32x16_bf16 v[64:79], v[40:43], v[32:35], v[64:79]
    v_mfma_f32_32x32x16_bf16 v[80:95], v[44:47], v[32:35], v[80:95]
    v_mfma_f32_32x32x16_bf16 v[96:111], v[40:43], v[36:39], v[96:111]
    v_mfma_f32_32x32x16_bf16 v[112:127], v[44:47], v[36:39], v[112:127]
    ds_read_b128 v[32:35], v22 offset:32768
    ds_read_b128 v[36:39], v22 offset:36864
    ds_read_b64_tr_b16 v[40:41], v24 offset:40960
    ds_read_b64_tr_b16 v[42:43], v24 offset:41984
    ds_read_b64_tr_b16 v[44:45], v25 offset:40960
    ds_read_b64_tr_b16 v[46:47], v25 offset:41984
    s_waitcnt lgkmcnt(6)
    v_mfma_f32_32x32x16_bf16 v[64:79], v[56:59], v[48:51], v[64:79]
    v_mfma_f32_32x32x16_bf16 v[80:95], v[60:63], v[48:51], v[80:95]
    v_mfma_f32_32x32x16_bf16 v[96:111], v[56:59], v[52:55], v[96:111]
    v_mfma_f32_32x32x16_bf16 v[112:127], v[60:63], v[52:55], v[112:127]
    ds_read_b128 v[48:51], v23 offset:32768
    ds_read_b128 v[52:55], v23 offset:36864
    ds_read_b64_tr_b16 v[56:57], v24 offset:45056
    ds_read_b64_tr_b16 v[58:59], v24 offset:46080
    ds_read_b64_tr_b16 v[60:61], v25 offset:45056
    ds_read_b64_tr_b16 v[62:63], v25 offset:46080
    s_waitcnt lgkmcnt(6)
    v_mfma_f32_32x32x16_bf16 v[64:79], v[40:43], v[32:35], v[64:79]
    v_mfma_f32_32x32x16_bf16 v[80:95], v[44:47], v[32:35], v[80:95]
    v_mfma_f32_32x32x16_bf16 v[96:111], v[40:43], v[36:39], v[96:111]
    v_mfma_f32_32x32x16_bf16 v[112:127], v[44:47], v[36:39], v[112:127]
    s_waitcnt lgkmcnt(0)
    v_mfma_f32_32x32x16_bf16 v[64:79], v[56:59], v[48:51], v[64:79]
    v_mfma_f32_32x32x16_bf16 v[80:95], v[60:63], v[48:51], v[80:95]
    v_mfma_f32_32x32x16_bf16 v[96:111], v[56:59], v[52:55], v[96:111]
    v_mfma_f32_32x32x16_bf16 v[112:127], v[60:63], v[52:55], v[112:127]
    s_barrier
    s_sub_u32 s21, s21, 1
    s_cmp_lg_u32 s21, 0
    s_cbranch_scc1 oproj_kernel_loop
    s_add_u32 m0, s13, 32768
    s_nop 0
    global_load_lds_dwordx4 v8, s[6:7]
    s_add_u32 m0, s13, 33792
    s_nop 0
    global_load_lds_dwordx4 v9, s[6:7]
    s_add_u32 m0, s13, 34816
    s_nop 0
    global_load_lds_dwordx4 v10, s[6:7]
    s_add_u32 m0, s13, 35840
    s_nop 0
    global_load_lds_dwordx4 v11, s[6:7]
    s_add_u32 m0, s13, 49152
    s_nop 0
    global_load_lds_dwordx4 v[12:13], off
    s_add_u32 m0, s13, 50176
    s_nop 0
    global_load_lds_dwordx4 v[14:15], off
    s_add_u32 m0, s13, 51200
    s_nop 0
    global_load_lds_dwordx4 v[16:17], off
    s_add_u32 m0, s13, 52224
    s_nop 0
    global_load_lds_dwordx4 v[18:19], off
    s_add_u32 s6, s6, 128
    s_addc_u32 s7, s7, 0
    v_add_co_u32 v12, vcc, 73728, v12
    v_addc_co_u32 v13, vcc, 0, v13, vcc
    v_add_co_u32 v14, vcc, 73728, v14
    v_addc_co_u32 v15, vcc, 0, v15, vcc
    v_add_co_u32 v16, vcc, 73728, v16
    v_addc_co_u32 v17, vcc, 0, v17, vcc
    v_add_co_u32 v18, vcc, 73728, v18
    v_addc_co_u32 v19, vcc, 0, v19, vcc
    s_waitcnt vmcnt(8)
    s_barrier
    ds_read_b128 v[32:35], v20 offset:0
    ds_read_b128 v[36:39], v20 offset:4096
    ds_read_b64_tr_b16 v[40:41], v24 offset:0
    ds_read_b64_tr_b16 v[42:43], v24 offset:1024
    ds_read_b64_tr_b16 v[44:45], v25 offset:0
    ds_read_b64_tr_b16 v[46:47], v25 offset:1024
    ds_read_b128 v[48:51], v21 offset:0
    ds_read_b128 v[52:55], v21 offset:4096
    ds_read_b64_tr_b16 v[56:57], v24 offset:4096
    ds_read_b64_tr_b16 v[58:59], v24 offset:5120
    ds_read_b64_tr_b16 v[60:61], v25 offset:4096
    ds_read_b64_tr_b16 v[62:63], v25 offset:5120
    s_waitcnt lgkmcnt(6)
    v_mfma_f32_32x32x16_bf16 v[64:79], v[40:43], v[32:35], v[64:79]
    v_mfma_f32_32x32x16_bf16 v[80:95], v[44:47], v[32:35], v[80:95]
    v_mfma_f32_32x32x16_bf16 v[96:111], v[40:43], v[36:39], v[96:111]
    v_mfma_f32_32x32x16_bf16 v[112:127], v[44:47], v[36:39], v[112:127]
    ds_read_b128 v[32:35], v22 offset:0
    ds_read_b128 v[36:39], v22 offset:4096
    ds_read_b64_tr_b16 v[40:41], v24 offset:8192
    ds_read_b64_tr_b16 v[42:43], v24 offset:9216
    ds_read_b64_tr_b16 v[44:45], v25 offset:8192
    ds_read_b64_tr_b16 v[46:47], v25 offset:9216
    s_waitcnt lgkmcnt(6)
    v_mfma_f32_32x32x16_bf16 v[64:79], v[56:59], v[48:51], v[64:79]
    v_mfma_f32_32x32x16_bf16 v[80:95], v[60:63], v[48:51], v[80:95]
    v_mfma_f32_32x32x16_bf16 v[96:111], v[56:59], v[52:55], v[96:111]
    v_mfma_f32_32x32x16_bf16 v[112:127], v[60:63], v[52:55], v[112:127]
    ds_read_b128 v[48:51], v23 offset:0
    ds_read_b128 v[52:55], v23 offset:4096
    ds_read_b64_tr_b16 v[56:57], v24 offset:12288
    ds_read_b64_tr_b16 v[58:59], v24 offset:13312
    ds_read_b64_tr_b16 v[60:61], v25 offset:12288
    ds_read_b64_tr_b16 v[62:63], v25 offset:13312
    s_waitcnt lgkmcnt(6)
    v_mfma_f32_32x32x16_bf16 v[64:79], v[40:43], v[32:35], v[64:79]
    v_mfma_f32_32x32x16_bf16 v[80:95], v[44:47], v[32:35], v[80:95]
    v_mfma_f32_32x32x16_bf16 v[96:111], v[40:43], v[36:39], v[96:111]
    v_mfma_f32_32x32x16_bf16 v[112:127], v[44:47], v[36:39], v[112:127]
    s_waitcnt lgkmcnt(0)
    v_mfma_f32_32x32x16_bf16 v[64:79], v[56:59], v[48:51], v[64:79]
    v_mfma_f32_32x32x16_bf16 v[80:95], v[60:63], v[48:51], v[80:95]
    v_mfma_f32_32x32x16_bf16 v[96:111], v[56:59], v[52:55], v[96:111]
    v_mfma_f32_32x32x16_bf16 v[112:127], v[60:63], v[52:55], v[112:127]
    s_barrier
    s_waitcnt vmcnt(0)
    s_barrier
    ds_read_b128 v[32:35], v20 offset:32768
    ds_read_b128 v[36:39], v20 offset:36864
    ds_read_b64_tr_b16 v[40:41], v24 offset:32768
    ds_read_b64_tr_b16 v[42:43], v24 offset:33792
    ds_read_b64_tr_b16 v[44:45], v25 offset:32768
    ds_read_b64_tr_b16 v[46:47], v25 offset:33792
    ds_read_b128 v[48:51], v21 offset:32768
    ds_read_b128 v[52:55], v21 offset:36864
    ds_read_b64_tr_b16 v[56:57], v24 offset:36864
    ds_read_b64_tr_b16 v[58:59], v24 offset:37888
    ds_read_b64_tr_b16 v[60:61], v25 offset:36864
    ds_read_b64_tr_b16 v[62:63], v25 offset:37888
    s_waitcnt lgkmcnt(6)
    v_mfma_f32_32x32x16_bf16 v[64:79], v[40:43], v[32:35], v[64:79]
    v_mfma_f32_32x32x16_bf16 v[80:95], v[44:47], v[32:35], v[80:95]
    v_mfma_f32_32x32x16_bf16 v[96:111], v[40:43], v[36:39], v[96:111]
    v_mfma_f32_32x32x16_bf16 v[112:127], v[44:47], v[36:39], v[112:127]
    ds_read_b128 v[32:35], v22 offset:32768
    ds_read_b128 v[36:39], v22 offset:36864
    ds_read_b64_tr_b16 v[40:41], v24 offset:40960
    ds_read_b64_tr_b16 v[42:43], v24 offset:41984
    ds_read_b64_tr_b16 v[44:45], v25 offset:40960
    ds_read_b64_tr_b16 v[46:47], v25 offset:41984
    s_waitcnt lgkmcnt(6)
    v_mfma_f32_32x32x16_bf16 v[64:79], v[56:59], v[48:51], v[64:79]
    v_mfma_f32_32x32x16_bf16 v[80:95], v[60:63], v[48:51], v[80:95]
    v_mfma_f32_32x32x16_bf16 v[96:111], v[56:59], v[52:55], v[96:111]
    v_mfma_f32_32x32x16_bf16 v[112:127], v[60:63], v[52:55], v[112:127]
    ds_read_b128 v[48:51], v23 offset:32768
    ds_read_b128 v[52:55], v23 offset:36864
    ds_read_b64_tr_b16 v[56:57], v24 offset:45056
    ds_read_b64_tr_b16 v[58:59], v24 offset:46080
    ds_read_b64_tr_b16 v[60:61], v25 offset:45056
    ds_read_b64_tr_b16 v[62:63], v25 offset:46080
    s_waitcnt lgkmcnt(6)
    v_mfma_f32_32x32x16_bf16 v[64:79], v[40:43], v[32:35], v[64:79]
    v_mfma_f32_32x32x16_bf16 v[80:95], v[44:47], v[32:35], v[80:95]
    v_mfma_f32_32x32x16_bf16 v[96:111], v[40:43], v[36:39], v[96:111]
    v_mfma_f32_32x32x16_bf16 v[112:127], v[44:47], v[36:39], v[112:127]
    s_waitcnt lgkmcnt(0)
    v_mfma_f32_32x32x16_bf16 v[64:79], v[56:59], v[48:51], v[64:79]
    v_mfma_f32_32x32x16_bf16 v[80:95], v[60:63], v[48:51], v[80:95]
    v_mfma_f32_32x32x16_bf16 v[96:111], v[56:59], v[52:55], v[96:111]
    v_mfma_f32_32x32x16_bf16 v[112:127], v[60:63], v[52:55], v[112:127]
    s_barrier
    s_nop 15
    v_and_b32 v3, 31, v2
    v_lshrrev_b32 v4, 5, v2
    v_and_b32 v5, 1, v1
    v_lshrrev_b32 v6, 1, v1
    v_lshl_add_u32 v7, v5, 6, v3
    s_lshl_b32 s18, s16, 7
    v_add_u32 v7, s18, v7
    s_mov_b32 s22, s40
    s_mov_b32 s23, s41
    s_add_u32 s26, s4, 80232448
    s_addc_u32 s27, s5, 0
    s_lshl_b32 s19, s17, 8
    s_add_u32 s22, s22, s19
    s_addc_u32 s23, s23, 0
    s_add_u32 s26, s26, s19
    s_addc_u32 s27, s27, 0
    s_lshl_b32 s19, s17, 9
    s_add_u32 s19, s19, 4608
    s_add_u32 s28, s4, s19
    s_addc_u32 s29, s5, 0
    s_mov_b32 s20, 1152
    v_mul_lo_u32 v9, v7, s20
    v_lshl_add_u32 v9, v6, 7, v9
    v_lshl_add_u32 v9, v4, 3, v9
    v_lshlrev_b32 v19, 8, v6
    v_lshl_add_u32 v19, v4, 4, v19
    s_lshl_b32 s19, s17, 7
    v_lshl_add_u32 v20, v6, 6, s19
    v_cmp_gt_u32 vcc, 576, v20
    s_and_saveexec_b64 s[24:25], vcc
    s_cbranch_execz oproj_kernel_end
    global_load_dwordx2 v[10:11], v9, s[22:23] offset:0
    global_load_dwordx4 v[12:15], v19, s[28:29] offset:0
    s_waitcnt vmcnt(0)
    v_cvt_pk_bf16_f32 v16, v64, v64
    v_lshlrev_b32 v16, 16, v16
    v_mul_f32 v16, v16, v12
    v_cvt_pk_bf16_f32 v16, v16, v16
    v_lshlrev_b32 v16, 16, v16
    v_lshlrev_b32 v17, 16, v10
    v_add_f32 v12, v16, v17
    v_cvt_pk_bf16_f32 v16, v65, v65
    v_lshlrev_b32 v16, 16, v16
    v_mul_f32 v16, v16, v13
    v_cvt_pk_bf16_f32 v16, v16, v16
    v_lshlrev_b32 v16, 16, v16
    v_and_b32 v17, 0xffff0000, v10
    v_add_f32 v13, v16, v17
    v_cvt_pk_bf16_f32 v16, v66, v66
    v_lshlrev_b32 v16, 16, v16
    v_mul_f32 v16, v16, v14
    v_cvt_pk_bf16_f32 v16, v16, v16
    v_lshlrev_b32 v16, 16, v16
    v_lshlrev_b32 v17, 16, v11
    v_add_f32 v14, v16, v17
    v_cvt_pk_bf16_f32 v16, v67, v67
    v_lshlrev_b32 v16, 16, v16
    v_mul_f32 v16, v16, v15
    v_cvt_pk_bf16_f32 v16, v16, v16
    v_lshlrev_b32 v16, 16, v16
    v_and_b32 v17, 0xffff0000, v11
    v_add_f32 v15, v16, v17
    v_cvt_pk_bf16_f32 v10, v12, v13
    v_cvt_pk_bf16_f32 v11, v14, v15
    global_store_dwordx2 v9, v[10:11], s[26:27] offset:0
    global_load_dwordx2 v[10:11], v9, s[22:23] offset:16
    global_load_dwordx4 v[12:15], v19, s[28:29] offset:32
    s_waitcnt vmcnt(0)
    v_cvt_pk_bf16_f32 v16, v68, v68
    v_lshlrev_b32 v16, 16, v16
    v_mul_f32 v16, v16, v12
    v_cvt_pk_bf16_f32 v16, v16, v16
    v_lshlrev_b32 v16, 16, v16
    v_lshlrev_b32 v17, 16, v10
    v_add_f32 v12, v16, v17
    v_cvt_pk_bf16_f32 v16, v69, v69
    v_lshlrev_b32 v16, 16, v16
    v_mul_f32 v16, v16, v13
    v_cvt_pk_bf16_f32 v16, v16, v16
    v_lshlrev_b32 v16, 16, v16
    v_and_b32 v17, 0xffff0000, v10
    v_add_f32 v13, v16, v17
    v_cvt_pk_bf16_f32 v16, v70, v70
    v_lshlrev_b32 v16, 16, v16
    v_mul_f32 v16, v16, v14
    v_cvt_pk_bf16_f32 v16, v16, v16
    v_lshlrev_b32 v16, 16, v16
    v_lshlrev_b32 v17, 16, v11
    v_add_f32 v14, v16, v17
    v_cvt_pk_bf16_f32 v16, v71, v71
    v_lshlrev_b32 v16, 16, v16
    v_mul_f32 v16, v16, v15
    v_cvt_pk_bf16_f32 v16, v16, v16
    v_lshlrev_b32 v16, 16, v16
    v_and_b32 v17, 0xffff0000, v11
    v_add_f32 v15, v16, v17
    v_cvt_pk_bf16_f32 v10, v12, v13
    v_cvt_pk_bf16_f32 v11, v14, v15
    global_store_dwordx2 v9, v[10:11], s[26:27] offset:16
    global_load_dwordx2 v[10:11], v9, s[22:23] offset:32
    global_load_dwordx4 v[12:15], v19, s[28:29] offset:64
    s_waitcnt vmcnt(0)
    v_cvt_pk_bf16_f32 v16, v72, v72
    v_lshlrev_b32 v16, 16, v16
    v_mul_f32 v16, v16, v12
    v_cvt_pk_bf16_f32 v16, v16, v16
    v_lshlrev_b32 v16, 16, v16
    v_lshlrev_b32 v17, 16, v10
    v_add_f32 v12, v16, v17
    v_cvt_pk_bf16_f32 v16, v73, v73
    v_lshlrev_b32 v16, 16, v16
    v_mul_f32 v16, v16, v13
    v_cvt_pk_bf16_f32 v16, v16, v16
    v_lshlrev_b32 v16, 16, v16
    v_and_b32 v17, 0xffff0000, v10
    v_add_f32 v13, v16, v17
    v_cvt_pk_bf16_f32 v16, v74, v74
    v_lshlrev_b32 v16, 16, v16
    v_mul_f32 v16, v16, v14
    v_cvt_pk_bf16_f32 v16, v16, v16
    v_lshlrev_b32 v16, 16, v16
    v_lshlrev_b32 v17, 16, v11
    v_add_f32 v14, v16, v17
    v_cvt_pk_bf16_f32 v16, v75, v75
    v_lshlrev_b32 v16, 16, v16
    v_mul_f32 v16, v16, v15
    v_cvt_pk_bf16_f32 v16, v16, v16
    v_lshlrev_b32 v16, 16, v16
    v_and_b32 v17, 0xffff0000, v11
    v_add_f32 v15, v16, v17
    v_cvt_pk_bf16_f32 v10, v12, v13
    v_cvt_pk_bf16_f32 v11, v14, v15
    global_store_dwordx2 v9, v[10:11], s[26:27] offset:32
    global_load_dwordx2 v[10:11], v9, s[22:23] offset:48
    global_load_dwordx4 v[12:15], v19, s[28:29] offset:96
    s_waitcnt vmcnt(0)
    v_cvt_pk_bf16_f32 v16, v76, v76
    v_lshlrev_b32 v16, 16, v16
    v_mul_f32 v16, v16, v12
    v_cvt_pk_bf16_f32 v16, v16, v16
    v_lshlrev_b32 v16, 16, v16
    v_lshlrev_b32 v17, 16, v10
    v_add_f32 v12, v16, v17
    v_cvt_pk_bf16_f32 v16, v77, v77
    v_lshlrev_b32 v16, 16, v16
    v_mul_f32 v16, v16, v13
    v_cvt_pk_bf16_f32 v16, v16, v16
    v_lshlrev_b32 v16, 16, v16
    v_and_b32 v17, 0xffff0000, v10
    v_add_f32 v13, v16, v17
    v_cvt_pk_bf16_f32 v16, v78, v78
    v_lshlrev_b32 v16, 16, v16
    v_mul_f32 v16, v16, v14
    v_cvt_pk_bf16_f32 v16, v16, v16
    v_lshlrev_b32 v16, 16, v16
    v_lshlrev_b32 v17, 16, v11
    v_add_f32 v14, v16, v17
    v_cvt_pk_bf16_f32 v16, v79, v79
    v_lshlrev_b32 v16, 16, v16
    v_mul_f32 v16, v16, v15
    v_cvt_pk_bf16_f32 v16, v16, v16
    v_lshlrev_b32 v16, 16, v16
    v_and_b32 v17, 0xffff0000, v11
    v_add_f32 v15, v16, v17
    v_cvt_pk_bf16_f32 v10, v12, v13
    v_cvt_pk_bf16_f32 v11, v14, v15
    global_store_dwordx2 v9, v[10:11], s[26:27] offset:48
    global_load_dwordx2 v[10:11], v9, s[22:23] offset:64
    global_load_dwordx4 v[12:15], v19, s[28:29] offset:128
    s_waitcnt vmcnt(0)
    v_cvt_pk_bf16_f32 v16, v80, v80
    v_lshlrev_b32 v16, 16, v16
    v_mul_f32 v16, v16, v12
    v_cvt_pk_bf16_f32 v16, v16, v16
    v_lshlrev_b32 v16, 16, v16
    v_lshlrev_b32 v17, 16, v10
    v_add_f32 v12, v16, v17
    v_cvt_pk_bf16_f32 v16, v81, v81
    v_lshlrev_b32 v16, 16, v16
    v_mul_f32 v16, v16, v13
    v_cvt_pk_bf16_f32 v16, v16, v16
    v_lshlrev_b32 v16, 16, v16
    v_and_b32 v17, 0xffff0000, v10
    v_add_f32 v13, v16, v17
    v_cvt_pk_bf16_f32 v16, v82, v82
    v_lshlrev_b32 v16, 16, v16
    v_mul_f32 v16, v16, v14
    v_cvt_pk_bf16_f32 v16, v16, v16
    v_lshlrev_b32 v16, 16, v16
    v_lshlrev_b32 v17, 16, v11
    v_add_f32 v14, v16, v17
    v_cvt_pk_bf16_f32 v16, v83, v83
    v_lshlrev_b32 v16, 16, v16
    v_mul_f32 v16, v16, v15
    v_cvt_pk_bf16_f32 v16, v16, v16
    v_lshlrev_b32 v16, 16, v16
    v_and_b32 v17, 0xffff0000, v11
    v_add_f32 v15, v16, v17
    v_cvt_pk_bf16_f32 v10, v12, v13
    v_cvt_pk_bf16_f32 v11, v14, v15
    global_store_dwordx2 v9, v[10:11], s[26:27] offset:64
    global_load_dwordx2 v[10:11], v9, s[22:23] offset:80
    global_load_dwordx4 v[12:15], v19, s[28:29] offset:160
    s_waitcnt vmcnt(0)
    v_cvt_pk_bf16_f32 v16, v84, v84
    v_lshlrev_b32 v16, 16, v16
    v_mul_f32 v16, v16, v12
    v_cvt_pk_bf16_f32 v16, v16, v16
    v_lshlrev_b32 v16, 16, v16
    v_lshlrev_b32 v17, 16, v10
    v_add_f32 v12, v16, v17
    v_cvt_pk_bf16_f32 v16, v85, v85
    v_lshlrev_b32 v16, 16, v16
    v_mul_f32 v16, v16, v13
    v_cvt_pk_bf16_f32 v16, v16, v16
    v_lshlrev_b32 v16, 16, v16
    v_and_b32 v17, 0xffff0000, v10
    v_add_f32 v13, v16, v17
    v_cvt_pk_bf16_f32 v16, v86, v86
    v_lshlrev_b32 v16, 16, v16
    v_mul_f32 v16, v16, v14
    v_cvt_pk_bf16_f32 v16, v16, v16
    v_lshlrev_b32 v16, 16, v16
    v_lshlrev_b32 v17, 16, v11
    v_add_f32 v14, v16, v17
    v_cvt_pk_bf16_f32 v16, v87, v87
    v_lshlrev_b32 v16, 16, v16
    v_mul_f32 v16, v16, v15
    v_cvt_pk_bf16_f32 v16, v16, v16
    v_lshlrev_b32 v16, 16, v16
    v_and_b32 v17, 0xffff0000, v11
    v_add_f32 v15, v16, v17
    v_cvt_pk_bf16_f32 v10, v12, v13
    v_cvt_pk_bf16_f32 v11, v14, v15
    global_store_dwordx2 v9, v[10:11], s[26:27] offset:80
    global_load_dwordx2 v[10:11], v9, s[22:23] offset:96
    global_load_dwordx4 v[12:15], v19, s[28:29] offset:192
    s_waitcnt vmcnt(0)
    v_cvt_pk_bf16_f32 v16, v88, v88
    v_lshlrev_b32 v16, 16, v16
    v_mul_f32 v16, v16, v12
    v_cvt_pk_bf16_f32 v16, v16, v16
    v_lshlrev_b32 v16, 16, v16
    v_lshlrev_b32 v17, 16, v10
    v_add_f32 v12, v16, v17
    v_cvt_pk_bf16_f32 v16, v89, v89
    v_lshlrev_b32 v16, 16, v16
    v_mul_f32 v16, v16, v13
    v_cvt_pk_bf16_f32 v16, v16, v16
    v_lshlrev_b32 v16, 16, v16
    v_and_b32 v17, 0xffff0000, v10
    v_add_f32 v13, v16, v17
    v_cvt_pk_bf16_f32 v16, v90, v90
    v_lshlrev_b32 v16, 16, v16
    v_mul_f32 v16, v16, v14
    v_cvt_pk_bf16_f32 v16, v16, v16
    v_lshlrev_b32 v16, 16, v16
    v_lshlrev_b32 v17, 16, v11
    v_add_f32 v14, v16, v17
    v_cvt_pk_bf16_f32 v16, v91, v91
    v_lshlrev_b32 v16, 16, v16
    v_mul_f32 v16, v16, v15
    v_cvt_pk_bf16_f32 v16, v16, v16
    v_lshlrev_b32 v16, 16, v16
    v_and_b32 v17, 0xffff0000, v11
    v_add_f32 v15, v16, v17
    v_cvt_pk_bf16_f32 v10, v12, v13
    v_cvt_pk_bf16_f32 v11, v14, v15
    global_store_dwordx2 v9, v[10:11], s[26:27] offset:96
    global_load_dwordx2 v[10:11], v9, s[22:23] offset:112
    global_load_dwordx4 v[12:15], v19, s[28:29] offset:224
    s_waitcnt vmcnt(0)
    v_cvt_pk_bf16_f32 v16, v92, v92
    v_lshlrev_b32 v16, 16, v16
    v_mul_f32 v16, v16, v12
    v_cvt_pk_bf16_f32 v16, v16, v16
    v_lshlrev_b32 v16, 16, v16
    v_lshlrev_b32 v17, 16, v10
    v_add_f32 v12, v16, v17
    v_cvt_pk_bf16_f32 v16, v93, v93
    v_lshlrev_b32 v16, 16, v16
    v_mul_f32 v16, v16, v13
    v_cvt_pk_bf16_f32 v16, v16, v16
    v_lshlrev_b32 v16, 16, v16
    v_and_b32 v17, 0xffff0000, v10
    v_add_f32 v13, v16, v17
    v_cvt_pk_bf16_f32 v16, v94, v94
    v_lshlrev_b32 v16, 16, v16
    v_mul_f32 v16, v16, v14
    v_cvt_pk_bf16_f32 v16, v16, v16
    v_lshlrev_b32 v16, 16, v16
    v_lshlrev_b32 v17, 16, v11
    v_add_f32 v14, v16, v17
    v_cvt_pk_bf16_f32 v16, v95, v95
    v_lshlrev_b32 v16, 16, v16
    v_mul_f32 v16, v16, v15
    v_cvt_pk_bf16_f32 v16, v16, v16
    v_lshlrev_b32 v16, 16, v16
    v_and_b32 v17, 0xffff0000, v11
    v_add_f32 v15, v16, v17
    v_cvt_pk_bf16_f32 v10, v12, v13
    v_cvt_pk_bf16_f32 v11, v14, v15
    global_store_dwordx2 v9, v[10:11], s[26:27] offset:112
    v_add_u32 v9, 36864, v9
    global_load_dwordx2 v[10:11], v9, s[22:23] offset:0
    global_load_dwordx4 v[12:15], v19, s[28:29] offset:0
    s_waitcnt vmcnt(0)
    v_cvt_pk_bf16_f32 v16, v96, v96
    v_lshlrev_b32 v16, 16, v16
    v_mul_f32 v16, v16, v12
    v_cvt_pk_bf16_f32 v16, v16, v16
    v_lshlrev_b32 v16, 16, v16
    v_lshlrev_b32 v17, 16, v10
    v_add_f32 v12, v16, v17
    v_cvt_pk_bf16_f32 v16, v97, v97
    v_lshlrev_b32 v16, 16, v16
    v_mul_f32 v16, v16, v13
    v_cvt_pk_bf16_f32 v16, v16, v16
    v_lshlrev_b32 v16, 16, v16
    v_and_b32 v17, 0xffff0000, v10
    v_add_f32 v13, v16, v17
    v_cvt_pk_bf16_f32 v16, v98, v98
    v_lshlrev_b32 v16, 16, v16
    v_mul_f32 v16, v16, v14
    v_cvt_pk_bf16_f32 v16, v16, v16
    v_lshlrev_b32 v16, 16, v16
    v_lshlrev_b32 v17, 16, v11
    v_add_f32 v14, v16, v17
    v_cvt_pk_bf16_f32 v16, v99, v99
    v_lshlrev_b32 v16, 16, v16
    v_mul_f32 v16, v16, v15
    v_cvt_pk_bf16_f32 v16, v16, v16
    v_lshlrev_b32 v16, 16, v16
    v_and_b32 v17, 0xffff0000, v11
    v_add_f32 v15, v16, v17
    v_cvt_pk_bf16_f32 v10, v12, v13
    v_cvt_pk_bf16_f32 v11, v14, v15
    global_store_dwordx2 v9, v[10:11], s[26:27] offset:0
    global_load_dwordx2 v[10:11], v9, s[22:23] offset:16
    global_load_dwordx4 v[12:15], v19, s[28:29] offset:32
    s_waitcnt vmcnt(0)
    v_cvt_pk_bf16_f32 v16, v100, v100
    v_lshlrev_b32 v16, 16, v16
    v_mul_f32 v16, v16, v12
    v_cvt_pk_bf16_f32 v16, v16, v16
    v_lshlrev_b32 v16, 16, v16
    v_lshlrev_b32 v17, 16, v10
    v_add_f32 v12, v16, v17
    v_cvt_pk_bf16_f32 v16, v101, v101
    v_lshlrev_b32 v16, 16, v16
    v_mul_f32 v16, v16, v13
    v_cvt_pk_bf16_f32 v16, v16, v16
    v_lshlrev_b32 v16, 16, v16
    v_and_b32 v17, 0xffff0000, v10
    v_add_f32 v13, v16, v17
    v_cvt_pk_bf16_f32 v16, v102, v102
    v_lshlrev_b32 v16, 16, v16
    v_mul_f32 v16, v16, v14
    v_cvt_pk_bf16_f32 v16, v16, v16
    v_lshlrev_b32 v16, 16, v16
    v_lshlrev_b32 v17, 16, v11
    v_add_f32 v14, v16, v17
    v_cvt_pk_bf16_f32 v16, v103, v103
    v_lshlrev_b32 v16, 16, v16
    v_mul_f32 v16, v16, v15
    v_cvt_pk_bf16_f32 v16, v16, v16
    v_lshlrev_b32 v16, 16, v16
    v_and_b32 v17, 0xffff0000, v11
    v_add_f32 v15, v16, v17
    v_cvt_pk_bf16_f32 v10, v12, v13
    v_cvt_pk_bf16_f32 v11, v14, v15
    global_store_dwordx2 v9, v[10:11], s[26:27] offset:16
    global_load_dwordx2 v[10:11], v9, s[22:23] offset:32
    global_load_dwordx4 v[12:15], v19, s[28:29] offset:64
    s_waitcnt vmcnt(0)
    v_cvt_pk_bf16_f32 v16, v104, v104
    v_lshlrev_b32 v16, 16, v16
    v_mul_f32 v16, v16, v12
    v_cvt_pk_bf16_f32 v16, v16, v16
    v_lshlrev_b32 v16, 16, v16
    v_lshlrev_b32 v17, 16, v10
    v_add_f32 v12, v16, v17
    v_cvt_pk_bf16_f32 v16, v105, v105
    v_lshlrev_b32 v16, 16, v16
    v_mul_f32 v16, v16, v13
    v_cvt_pk_bf16_f32 v16, v16, v16
    v_lshlrev_b32 v16, 16, v16
    v_and_b32 v17, 0xffff0000, v10
    v_add_f32 v13, v16, v17
    v_cvt_pk_bf16_f32 v16, v106, v106
    v_lshlrev_b32 v16, 16, v16
    v_mul_f32 v16, v16, v14
    v_cvt_pk_bf16_f32 v16, v16, v16
    v_lshlrev_b32 v16, 16, v16
    v_lshlrev_b32 v17, 16, v11
    v_add_f32 v14, v16, v17
    v_cvt_pk_bf16_f32 v16, v107, v107
    v_lshlrev_b32 v16, 16, v16
    v_mul_f32 v16, v16, v15
    v_cvt_pk_bf16_f32 v16, v16, v16
    v_lshlrev_b32 v16, 16, v16
    v_and_b32 v17, 0xffff0000, v11
    v_add_f32 v15, v16, v17
    v_cvt_pk_bf16_f32 v10, v12, v13
    v_cvt_pk_bf16_f32 v11, v14, v15
    global_store_dwordx2 v9, v[10:11], s[26:27] offset:32
    global_load_dwordx2 v[10:11], v9, s[22:23] offset:48
    global_load_dwordx4 v[12:15], v19, s[28:29] offset:96
    s_waitcnt vmcnt(0)
    v_cvt_pk_bf16_f32 v16, v108, v108
    v_lshlrev_b32 v16, 16, v16
    v_mul_f32 v16, v16, v12
    v_cvt_pk_bf16_f32 v16, v16, v16
    v_lshlrev_b32 v16, 16, v16
    v_lshlrev_b32 v17, 16, v10
    v_add_f32 v12, v16, v17
    v_cvt_pk_bf16_f32 v16, v109, v109
    v_lshlrev_b32 v16, 16, v16
    v_mul_f32 v16, v16, v13
    v_cvt_pk_bf16_f32 v16, v16, v16
    v_lshlrev_b32 v16, 16, v16
    v_and_b32 v17, 0xffff0000, v10
    v_add_f32 v13, v16, v17
    v_cvt_pk_bf16_f32 v16, v110, v110
    v_lshlrev_b32 v16, 16, v16
    v_mul_f32 v16, v16, v14
    v_cvt_pk_bf16_f32 v16, v16, v16
    v_lshlrev_b32 v16, 16, v16
    v_lshlrev_b32 v17, 16, v11
    v_add_f32 v14, v16, v17
    v_cvt_pk_bf16_f32 v16, v111, v111
    v_lshlrev_b32 v16, 16, v16
    v_mul_f32 v16, v16, v15
    v_cvt_pk_bf16_f32 v16, v16, v16
    v_lshlrev_b32 v16, 16, v16
    v_and_b32 v17, 0xffff0000, v11
    v_add_f32 v15, v16, v17
    v_cvt_pk_bf16_f32 v10, v12, v13
    v_cvt_pk_bf16_f32 v11, v14, v15
    global_store_dwordx2 v9, v[10:11], s[26:27] offset:48
    global_load_dwordx2 v[10:11], v9, s[22:23] offset:64
    global_load_dwordx4 v[12:15], v19, s[28:29] offset:128
    s_waitcnt vmcnt(0)
    v_cvt_pk_bf16_f32 v16, v112, v112
    v_lshlrev_b32 v16, 16, v16
    v_mul_f32 v16, v16, v12
    v_cvt_pk_bf16_f32 v16, v16, v16
    v_lshlrev_b32 v16, 16, v16
    v_lshlrev_b32 v17, 16, v10
    v_add_f32 v12, v16, v17
    v_cvt_pk_bf16_f32 v16, v113, v113
    v_lshlrev_b32 v16, 16, v16
    v_mul_f32 v16, v16, v13
    v_cvt_pk_bf16_f32 v16, v16, v16
    v_lshlrev_b32 v16, 16, v16
    v_and_b32 v17, 0xffff0000, v10
    v_add_f32 v13, v16, v17
    v_cvt_pk_bf16_f32 v16, v114, v114
    v_lshlrev_b32 v16, 16, v16
    v_mul_f32 v16, v16, v14
    v_cvt_pk_bf16_f32 v16, v16, v16
    v_lshlrev_b32 v16, 16, v16
    v_lshlrev_b32 v17, 16, v11
    v_add_f32 v14, v16, v17
    v_cvt_pk_bf16_f32 v16, v115, v115
    v_lshlrev_b32 v16, 16, v16
    v_mul_f32 v16, v16, v15
    v_cvt_pk_bf16_f32 v16, v16, v16
    v_lshlrev_b32 v16, 16, v16
    v_and_b32 v17, 0xffff0000, v11
    v_add_f32 v15, v16, v17
    v_cvt_pk_bf16_f32 v10, v12, v13
    v_cvt_pk_bf16_f32 v11, v14, v15
    global_store_dwordx2 v9, v[10:11], s[26:27] offset:64
    global_load_dwordx2 v[10:11], v9, s[22:23] offset:80
    global_load_dwordx4 v[12:15], v19, s[28:29] offset:160
    s_waitcnt vmcnt(0)
    v_cvt_pk_bf16_f32 v16, v116, v116
    v_lshlrev_b32 v16, 16, v16
    v_mul_f32 v16, v16, v12
    v_cvt_pk_bf16_f32 v16, v16, v16
    v_lshlrev_b32 v16, 16, v16
    v_lshlrev_b32 v17, 16, v10
    v_add_f32 v12, v16, v17
    v_cvt_pk_bf16_f32 v16, v117, v117
    v_lshlrev_b32 v16, 16, v16
    v_mul_f32 v16, v16, v13
    v_cvt_pk_bf16_f32 v16, v16, v16
    v_lshlrev_b32 v16, 16, v16
    v_and_b32 v17, 0xffff0000, v10
    v_add_f32 v13, v16, v17
    v_cvt_pk_bf16_f32 v16, v118, v118
    v_lshlrev_b32 v16, 16, v16
    v_mul_f32 v16, v16, v14
    v_cvt_pk_bf16_f32 v16, v16, v16
    v_lshlrev_b32 v16, 16, v16
    v_lshlrev_b32 v17, 16, v11
    v_add_f32 v14, v16, v17
    v_cvt_pk_bf16_f32 v16, v119, v119
    v_lshlrev_b32 v16, 16, v16
    v_mul_f32 v16, v16, v15
    v_cvt_pk_bf16_f32 v16, v16, v16
    v_lshlrev_b32 v16, 16, v16
    v_and_b32 v17, 0xffff0000, v11
    v_add_f32 v15, v16, v17
    v_cvt_pk_bf16_f32 v10, v12, v13
    v_cvt_pk_bf16_f32 v11, v14, v15
    global_store_dwordx2 v9, v[10:11], s[26:27] offset:80
    global_load_dwordx2 v[10:11], v9, s[22:23] offset:96
    global_load_dwordx4 v[12:15], v19, s[28:29] offset:192
    s_waitcnt vmcnt(0)
    v_cvt_pk_bf16_f32 v16, v120, v120
    v_lshlrev_b32 v16, 16, v16
    v_mul_f32 v16, v16, v12
    v_cvt_pk_bf16_f32 v16, v16, v16
    v_lshlrev_b32 v16, 16, v16
    v_lshlrev_b32 v17, 16, v10
    v_add_f32 v12, v16, v17
    v_cvt_pk_bf16_f32 v16, v121, v121
    v_lshlrev_b32 v16, 16, v16
    v_mul_f32 v16, v16, v13
    v_cvt_pk_bf16_f32 v16, v16, v16
    v_lshlrev_b32 v16, 16, v16
    v_and_b32 v17, 0xffff0000, v10
    v_add_f32 v13, v16, v17
    v_cvt_pk_bf16_f32 v16, v122, v122
    v_lshlrev_b32 v16, 16, v16
    v_mul_f32 v16, v16, v14
    v_cvt_pk_bf16_f32 v16, v16, v16
    v_lshlrev_b32 v16, 16, v16
    v_lshlrev_b32 v17, 16, v11
    v_add_f32 v14, v16, v17
    v_cvt_pk_bf16_f32 v16, v123, v123
    v_lshlrev_b32 v16, 16, v16
    v_mul_f32 v16, v16, v15
    v_cvt_pk_bf16_f32 v16, v16, v16
    v_lshlrev_b32 v16, 16, v16
    v_and_b32 v17, 0xffff0000, v11
    v_add_f32 v15, v16, v17
    v_cvt_pk_bf16_f32 v10, v12, v13
    v_cvt_pk_bf16_f32 v11, v14, v15
    global_store_dwordx2 v9, v[10:11], s[26:27] offset:96
    global_load_dwordx2 v[10:11], v9, s[22:23] offset:112
    global_load_dwordx4 v[12:15], v19, s[28:29] offset:224
    s_waitcnt vmcnt(0)
    v_cvt_pk_bf16_f32 v16, v124, v124
    v_lshlrev_b32 v16, 16, v16
    v_mul_f32 v16, v16, v12
    v_cvt_pk_bf16_f32 v16, v16, v16
    v_lshlrev_b32 v16, 16, v16
    v_lshlrev_b32 v17, 16, v10
    v_add_f32 v12, v16, v17
    v_cvt_pk_bf16_f32 v16, v125, v125
    v_lshlrev_b32 v16, 16, v16
    v_mul_f32 v16, v16, v13
    v_cvt_pk_bf16_f32 v16, v16, v16
    v_lshlrev_b32 v16, 16, v16
    v_and_b32 v17, 0xffff0000, v10
    v_add_f32 v13, v16, v17
    v_cvt_pk_bf16_f32 v16, v126, v126
    v_lshlrev_b32 v16, 16, v16
    v_mul_f32 v16, v16, v14
    v_cvt_pk_bf16_f32 v16, v16, v16
    v_lshlrev_b32 v16, 16, v16
    v_lshlrev_b32 v17, 16, v11
    v_add_f32 v14, v16, v17
    v_cvt_pk_bf16_f32 v16, v127, v127
    v_lshlrev_b32 v16, 16, v16
    v_mul_f32 v16, v16, v15
    v_cvt_pk_bf16_f32 v16, v16, v16
    v_lshlrev_b32 v16, 16, v16
    v_and_b32 v17, 0xffff0000, v11
    v_add_f32 v15, v16, v17
    v_cvt_pk_bf16_f32 v10, v12, v13
    v_cvt_pk_bf16_f32 v11, v14, v15
    global_store_dwordx2 v9, v[10:11], s[26:27] offset:112
oproj_kernel_end:
    s_endpgm
.globl ln2_kernel
.p2align 8
.type ln2_kernel,@function
ln2_kernel:
    s_cmp_ge_u32 s2, 512
    s_cbranch_scc1 ln2_kernel_end
    s_load_dwordx2 s[4:5], s[0:1], 120
    s_load_dwordx2 s[6:7], s[0:1], 120
    s_waitcnt lgkmcnt(0)
    s_add_u32 s6, s6, 80232448
    s_addc_u32 s7, s7, 0
    s_add_u32 s24, s4, 82591744
    s_addc_u32 s25, s5, 0
    s_add_u32 s26, s4, 6912
    s_addc_u32 s27, s5, 0
    s_add_u32 s28, s4, 9216
    s_addc_u32 s29, s5, 0
    v_lshrrev_b32 v1, 6, v0
    s_lshl_b32 s3, s2, 2
    v_add_u32 v1, s3, v1
    v_and_b32 v2, 63, v0
    s_mov_b32 s20, 1152
    v_mul_lo_u32 v3, v1, s20
    v_lshl_add_u32 v3, v2, 1, v3
    v_lshlrev_b32 v4, 2, v2
    global_load_ushort v10, v3, s[6:7] offset:0
    global_load_ushort v11, v3, s[6:7] offset:128
    global_load_ushort v12, v3, s[6:7] offset:256
    global_load_ushort v13, v3, s[6:7] offset:384
    global_load_ushort v14, v3, s[6:7] offset:512
    global_load_ushort v15, v3, s[6:7] offset:640
    global_load_ushort v16, v3, s[6:7] offset:768
    global_load_ushort v17, v3, s[6:7] offset:896
    global_load_ushort v18, v3, s[6:7] offset:1024
    global_load_dword v20, v4, s[26:27] offset:0
    global_load_dword v30, v4, s[28:29] offset:0
    global_load_dword v21, v4, s[26:27] offset:256
    global_load_dword v31, v4, s[28:29] offset:256
    global_load_dword v22, v4, s[26:27] offset:512
    global_load_dword v32, v4, s[28:29] offset:512
    global_load_dword v23, v4, s[26:27] offset:768
    global_load_dword v33, v4, s[28:29] offset:768
    global_load_dword v24, v4, s[26:27] offset:1024
    global_load_dword v34, v4, s[28:29] offset:1024
    global_load_dword v25, v4, s[26:27] offset:1280
    global_load_dword v35, v4, s[28:29] offset:1280
    global_load_dword v26, v4, s[26:27] offset:1536
    global_load_dword v36, v4, s[28:29] offset:1536
    global_load_dword v27, v4, s[26:27] offset:1792
    global_load_dword v37, v4, s[28:29] offset:1792
    global_load_dword v28, v4, s[26:27] offset:2048
    global_load_dword v38, v4, s[28:29] offset:2048
    s_waitcnt vmcnt(18)
    v_mov_b32 v5, 0
    v_lshlrev_b32 v10, 16, v10
    v_add_f32 v5, v5, v10
    v_lshlrev_b32 v11, 16, v11
    v_add_f32 v5, v5, v11
    v_lshlrev_b32 v12, 16, v12
    v_add_f32 v5, v5, v12
    v_lshlrev_b32 v13, 16, v13
    v_add_f32 v5, v5, v13
    v_lshlrev_b32 v14, 16, v14
    v_add_f32 v5, v5, v14
    v_lshlrev_b32 v15, 16, v15
    v_add_f32 v5, v5, v15
    v_lshlrev_b32 v16, 16, v16
    v_add_f32 v5, v5, v16
    v_lshlrev_b32 v17, 16, v17
    v_add_f32 v5, v5, v17
    v_lshlrev_b32 v18, 16, v18
    v_add_f32 v5, v5, v18
    ds_swizzle_b32 v6, v5 offset:0x41f
    s_waitcnt lgkmcnt(0)
    v_add_f32 v5, v5, v6
    ds_swizzle_b32 v6, v5 offset:0x81f
    s_waitcnt lgkmcnt(0)
    v_add_f32 v5, v5, v6
    ds_swizzle_b32 v6, v5 offset:0x101f
    s_waitcnt lgkmcnt(0)
    v_add_f32 v5, v5, v6
    ds_swizzle_b32 v6, v5 offset:0x201f
    s_waitcnt lgkmcnt(0)
    v_add_f32 v5, v5, v6
    ds_swizzle_b32 v6, v5 offset:0x401f
    s_waitcnt lgkmcnt(0)
    v_add_f32 v5, v5, v6
    s_nop 1
    v_readlane_b32 s21, v5, 32
    s_nop 3
    v_add_f32 v5, s21, v5
    s_nop 1
    v_readlane_b32 s21, v5, 0
    s_nop 3
    v_mov_b32 v7, 0x3ae38e39
    v_mul_f32 v5, s21, v7
    v_mov_b32 v8, 0
    v_sub_f32 v6, v10, v5
    v_fmac_f32 v8, v6, v6
    v_sub_f32 v6, v11, v5
    v_fmac_f32 v8, v6, v6
    v_sub_f32 v6, v12, v5
    v_fmac_f32 v8, v6, v6
    v_sub_f32 v6, v13, v5
    v_fmac_f32 v8, v6, v6
    v_sub_f32 v6, v14, v5
    v_fmac_f32 v8, v6, v6
    v_sub_f32 v6, v15, v5
    v_fmac_f32 v8, v6, v6
    v_sub_f32 v6, v16, v5
    v_fmac_f32 v8, v6, v6
    v_sub_f32 v6, v17, v5
    v_fmac_f32 v8, v6, v6
    v_sub_f32 v6, v18, v5
    v_fmac_f32 v8, v6, v6
    ds_swizzle_b32 v6, v8 offset:0x41f
    s_waitcnt lgkmcnt(0)
    v_add_f32 v8, v8, v6
    ds_swizzle_b32 v6, v8 offset:0x81f
    s_waitcnt lgkmcnt(0)
    v_add_f32 v8, v8, v6
    ds_swizzle_b32 v6, v8 offset:0x101f
    s_waitcnt lgkmcnt(0)
    v_add_f32 v8, v8, v6
    ds_swizzle_b32 v6, v8 offset:0x201f
    s_waitcnt lgkmcnt(0)
    v_add_f32 v8, v8, v6
    ds_swizzle_b32 v6, v8 offset:0x401f
    s_waitcnt lgkmcnt(0)
    v_add_f32 v8, v8, v6
    s_nop 1
    v_readlane_b32 s22, v8, 32
    s_nop 3
    v_add_f32 v8, s22, v8
    s_nop 1
    v_readlane_b32 s22, v8, 0
    s_nop 3
    v_mul_f32 v8, s22, v7
    v_cvt_pk_bf16_f32 v5, v5, v5
    v_lshlrev_b32 v5, 16, v5
    v_cvt_pk_bf16_f32 v8, v8, v8
    v_lshlrev_b32 v8, 16, v8
    v_add_f32 v8, 0x3727c5ac, v8
    v_cvt_pk_bf16_f32 v8, v8, v8
    v_lshlrev_b32 v8, 16, v8
    v_sqrt_f32 v8, v8
    s_nop 0
    v_cvt_pk_bf16_f32 v8, v8, v8
    v_lshlrev_b32 v8, 16, v8
    v_rcp_f32 v8, v8
    s_waitcnt vmcnt(0)
    v_sub_f32 v6, v10, v5
    v_cvt_pk_bf16_f32 v6, v6, v6
    v_lshlrev_b32 v6, 16, v6
    v_mul_f32 v6, v6, v8
    v_cvt_pk_bf16_f32 v6, v6, v6
    v_lshlrev_b32 v6, 16, v6
    v_add_f32 v9, 1.0, v30
    v_cvt_pk_bf16_f32 v9, v9, v9
    v_lshlrev_b32 v9, 16, v9
    v_mul_f32 v6, v6, v9
    v_cvt_pk_bf16_f32 v6, v6, v6
    v_lshlrev_b32 v6, 16, v6
    v_add_f32 v6, v6, v20
    v_cvt_pk_bf16_f32 v6, v6, v6
    global_store_short v3, v6, s[24:25] offset:0
    v_sub_f32 v6, v11, v5
    v_cvt_pk_bf16_f32 v6, v6, v6
    v_lshlrev_b32 v6, 16, v6
    v_mul_f32 v6, v6, v8
    v_cvt_pk_bf16_f32 v6, v6, v6
    v_lshlrev_b32 v6, 16, v6
    v_add_f32 v9, 1.0, v31
    v_cvt_pk_bf16_f32 v9, v9, v9
    v_lshlrev_b32 v9, 16, v9
    v_mul_f32 v6, v6, v9
    v_cvt_pk_bf16_f32 v6, v6, v6
    v_lshlrev_b32 v6, 16, v6
    v_add_f32 v6, v6, v21
    v_cvt_pk_bf16_f32 v6, v6, v6
    global_store_short v3, v6, s[24:25] offset:128
    v_sub_f32 v6, v12, v5
    v_cvt_pk_bf16_f32 v6, v6, v6
    v_lshlrev_b32 v6, 16, v6
    v_mul_f32 v6, v6, v8
    v_cvt_pk_bf16_f32 v6, v6, v6
    v_lshlrev_b32 v6, 16, v6
    v_add_f32 v9, 1.0, v32
    v_cvt_pk_bf16_f32 v9, v9, v9
    v_lshlrev_b32 v9, 16, v9
    v_mul_f32 v6, v6, v9
    v_cvt_pk_bf16_f32 v6, v6, v6
    v_lshlrev_b32 v6, 16, v6
    v_add_f32 v6, v6, v22
    v_cvt_pk_bf16_f32 v6, v6, v6
    global_store_short v3, v6, s[24:25] offset:256
    v_sub_f32 v6, v13, v5
    v_cvt_pk_bf16_f32 v6, v6, v6
    v_lshlrev_b32 v6, 16, v6
    v_mul_f32 v6, v6, v8
    v_cvt_pk_bf16_f32 v6, v6, v6
    v_lshlrev_b32 v6, 16, v6
    v_add_f32 v9, 1.0, v33
    v_cvt_pk_bf16_f32 v9, v9, v9
    v_lshlrev_b32 v9, 16, v9
    v_mul_f32 v6, v6, v9
    v_cvt_pk_bf16_f32 v6, v6, v6
    v_lshlrev_b32 v6, 16, v6
    v_add_f32 v6, v6, v23
    v_cvt_pk_bf16_f32 v6, v6, v6
    global_store_short v3, v6, s[24:25] offset:384
    v_sub_f32 v6, v14, v5
    v_cvt_pk_bf16_f32 v6, v6, v6
    v_lshlrev_b32 v6, 16, v6
    v_mul_f32 v6, v6, v8
    v_cvt_pk_bf16_f32 v6, v6, v6
    v_lshlrev_b32 v6, 16, v6
    v_add_f32 v9, 1.0, v34
    v_cvt_pk_bf16_f32 v9, v9, v9
    v_lshlrev_b32 v9, 16, v9
    v_mul_f32 v6, v6, v9
    v_cvt_pk_bf16_f32 v6, v6, v6
    v_lshlrev_b32 v6, 16, v6
    v_add_f32 v6, v6, v24
    v_cvt_pk_bf16_f32 v6, v6, v6
    global_store_short v3, v6, s[24:25] offset:512
    v_sub_f32 v6, v15, v5
    v_cvt_pk_bf16_f32 v6, v6, v6
    v_lshlrev_b32 v6, 16, v6
    v_mul_f32 v6, v6, v8
    v_cvt_pk_bf16_f32 v6, v6, v6
    v_lshlrev_b32 v6, 16, v6
    v_add_f32 v9, 1.0, v35
    v_cvt_pk_bf16_f32 v9, v9, v9
    v_lshlrev_b32 v9, 16, v9
    v_mul_f32 v6, v6, v9
    v_cvt_pk_bf16_f32 v6, v6, v6
    v_lshlrev_b32 v6, 16, v6
    v_add_f32 v6, v6, v25
    v_cvt_pk_bf16_f32 v6, v6, v6
    global_store_short v3, v6, s[24:25] offset:640
    v_sub_f32 v6, v16, v5
    v_cvt_pk_bf16_f32 v6, v6, v6
    v_lshlrev_b32 v6, 16, v6
    v_mul_f32 v6, v6, v8
    v_cvt_pk_bf16_f32 v6, v6, v6
    v_lshlrev_b32 v6, 16, v6
    v_add_f32 v9, 1.0, v36
    v_cvt_pk_bf16_f32 v9, v9, v9
    v_lshlrev_b32 v9, 16, v9
    v_mul_f32 v6, v6, v9
    v_cvt_pk_bf16_f32 v6, v6, v6
    v_lshlrev_b32 v6, 16, v6
    v_add_f32 v6, v6, v26
    v_cvt_pk_bf16_f32 v6, v6, v6
    global_store_short v3, v6, s[24:25] offset:768
    v_sub_f32 v6, v17, v5
    v_cvt_pk_bf16_f32 v6, v6, v6
    v_lshlrev_b32 v6, 16, v6
    v_mul_f32 v6, v6, v8
    v_cvt_pk_bf16_f32 v6, v6, v6
    v_lshlrev_b32 v6, 16, v6
    v_add_f32 v9, 1.0, v37
    v_cvt_pk_bf16_f32 v9, v9, v9
    v_lshlrev_b32 v9, 16, v9
    v_mul_f32 v6, v6, v9
    v_cvt_pk_bf16_f32 v6, v6, v6
    v_lshlrev_b32 v6, 16, v6
    v_add_f32 v6, v6, v27
    v_cvt_pk_bf16_f32 v6, v6, v6
    global_store_short v3, v6, s[24:25] offset:896
    v_sub_f32 v6, v18, v5
    v_cvt_pk_bf16_f32 v6, v6, v6
    v_lshlrev_b32 v6, 16, v6
    v_mul_f32 v6, v6, v8
    v_cvt_pk_bf16_f32 v6, v6, v6
    v_lshlrev_b32 v6, 16, v6
    v_add_f32 v9, 1.0, v38
    v_cvt_pk_bf16_f32 v9, v9, v9
    v_lshlrev_b32 v9, 16, v9
    v_mul_f32 v6, v6, v9
    v_cvt_pk_bf16_f32 v6, v6, v6
    v_lshlrev_b32 v6, 16, v6
    v_add_f32 v6, v6, v28
    v_cvt_pk_bf16_f32 v6, v6, v6
    global_store_short v3, v6, s[24:25] offset:1024
ln2_kernel_end:
    s_endpgm
.globl ffn1_kernel
.p2align 8
.type ffn1_kernel,@function
ffn1_kernel:
    s_cmp_ge_u32 s2, 1152
    s_cbranch_scc1 ffn1_kernel_end
    s_load_dwordx2 s[4:5], s[0:1], 120
    s_load_dwordx2 s[6:7], s[0:1], 120
    s_load_dwordx2 s[8:9], s[0:1], 64
    s_load_dwordx2 s[10:11], s[0:1], 72
    s_and_b32 s16, s2, 15
    s_lshr_b32 s17, s2, 4
    s_waitcnt lgkmcnt(0)
    s_add_u32 s6, s6, 82591744
    s_addc_u32 s7, s7, 0
    s_mul_i32 s18, s16, 147456
    s_add_u32 s6, s6, s18
    s_addc_u32 s7, s7, 0
    s_lshl_b32 s19, s17, 7
    s_add_u32 s8, s8, s19
    s_addc_u32 s9, s9, 0
    s_add_u32 s10, s10, s19
    s_addc_u32 s11, s11, 0
    v_lshrrev_b32 v1, 6, v0
    v_and_b32 v2, 63, v0
    s_nop 0
    v_readfirstlane_b32 s12, v1
    s_nop 3
    s_lshl_b32 s13, s12, 12
    v_lshrrev_b32 v3, 3, v2
    v_lshrrev_b32 v4, 4, v2
    v_and_b32 v5, 7, v2
    v_lshlrev_b32 v6, 5, v1
    s_mov_b32 s20, 1152
    v_add_u32 v7, 0, v4
    v_and_b32 v7, 7, v7
    v_xor_b32 v7, v5, v7
    v_add_u32 v8, 0, v3
    v_add_u32 v8, v8, v6
    v_mul_lo_u32 v8, v8, s20
    v_lshl_add_u32 v8, v7, 4, v8
    v_add_u32 v7, 4, v4
    v_and_b32 v7, 7, v7
    v_xor_b32 v7, v5, v7
    v_add_u32 v9, 8, v3
    v_add_u32 v9, v9, v6
    v_mul_lo_u32 v9, v9, s20
    v_lshl_add_u32 v9, v7, 4, v9
    v_add_u32 v7, 8, v4
    v_and_b32 v7, 7, v7
    v_xor_b32 v7, v5, v7
    v_add_u32 v10, 16, v3
    v_add_u32 v10, v10, v6
    v_mul_lo_u32 v10, v10, s20
    v_lshl_add_u32 v10, v7, 4, v10
    v_add_u32 v7, 12, v4
    v_and_b32 v7, 7, v7
    v_xor_b32 v7, v5, v7
    v_add_u32 v11, 24, v3
    v_add_u32 v11, v11, v6
    v_mul_lo_u32 v11, v11, s20
    v_lshl_add_u32 v11, v7, 4, v11
    v_and_b32 v5, 15, v2
    v_lshrrev_b32 v7, 2, v5
    v_xor_b32 v7, v7, v4
    v_and_b32 v5, 3, v5
    v_lshl_add_u32 v7, v7, 2, v5
    v_lshlrev_b32 v6, 4, v1
    s_mov_b32 s20, 9216
    v_add_u32 v3, 0, v4
    v_add_u32 v3, v3, v6
    v_mul_lo_u32 v3, v3, s20
    v_and_b32 v5, 7, v7
    v_lshl_add_u32 v3, v5, 4, v3
    v_cmp_gt_u32 vcc, 8, v7
    v_mov_b32 v20, s10
    v_mov_b32 v21, s11
    v_mov_b32 v22, s8
    v_mov_b32 v23, s9
    v_cndmask_b32 v20, v20, v22, vcc
    v_cndmask_b32 v21, v21, v23, vcc
    v_add_co_u32 v12, vcc, v20, v3
    v_addc_co_u32 v13, vcc, 0, v21, vcc
    v_add_u32 v3, 4, v4
    v_add_u32 v3, v3, v6
    v_mul_lo_u32 v3, v3, s20
    v_and_b32 v5, 7, v7
    v_lshl_add_u32 v3, v5, 4, v3
    v_cmp_gt_u32 vcc, 8, v7
    v_mov_b32 v20, s10
    v_mov_b32 v21, s11
    v_mov_b32 v22, s8
    v_mov_b32 v23, s9
    v_cndmask_b32 v20, v20, v22, vcc
    v_cndmask_b32 v21, v21, v23, vcc
    v_add_co_u32 v14, vcc, v20, v3
    v_addc_co_u32 v15, vcc, 0, v21, vcc
    v_add_u32 v3, 8, v4
    v_add_u32 v3, v3, v6
    v_mul_lo_u32 v3, v3, s20
    v_and_b32 v5, 7, v7
    v_lshl_add_u32 v3, v5, 4, v3
    v_cmp_gt_u32 vcc, 8, v7
    v_mov_b32 v20, s10
    v_mov_b32 v21, s11
    v_mov_b32 v22, s8
    v_mov_b32 v23, s9
    v_cndmask_b32 v20, v20, v22, vcc
    v_cndmask_b32 v21, v21, v23, vcc
    v_add_co_u32 v16, vcc, v20, v3
    v_addc_co_u32 v17, vcc, 0, v21, vcc
    v_add_u32 v3, 12, v4
    v_add_u32 v3, v3, v6
    v_mul_lo_u32 v3, v3, s20
    v_and_b32 v5, 7, v7
    v_lshl_add_u32 v3, v5, 4, v3
    v_cmp_gt_u32 vcc, 8, v7
    v_mov_b32 v20, s10
    v_mov_b32 v21, s11
    v_mov_b32 v22, s8
    v_mov_b32 v23, s9
    v_cndmask_b32 v20, v20, v22, vcc
    v_cndmask_b32 v21, v21, v23, vcc
    v_add_co_u32 v18, vcc, v20, v3
    v_addc_co_u32 v19, vcc, 0, v21, vcc
    v_and_b32 v3, 31, v2
    v_lshrrev_b32 v4, 5, v2
    v_and_b32 v5, 1, v1
    v_lshl_add_u32 v6, v5, 6, v3
    v_lshrrev_b32 v7, 1, v3
    v_and_b32 v7, 7, v7
    v_add_u32 v26, 0, v4
    v_xor_b32 v26, v26, v7
    v_lshlrev_b32 v26, 4, v26
    v_lshl_add_u32 v20, v6, 7, v26
    v_add_u32 v26, 2, v4
    v_xor_b32 v26, v26, v7
    v_lshlrev_b32 v26, 4, v26
    v_lshl_add_u32 v21, v6, 7, v26
    v_add_u32 v26, 4, v4
    v_xor_b32 v26, v26, v7
    v_lshlrev_b32 v26, 4, v26
    v_lshl_add_u32 v22, v6, 7, v26
    v_add_u32 v26, 6, v4
    v_xor_b32 v26, v26, v7
    v_lshlrev_b32 v26, 4, v26
    v_lshl_add_u32 v23, v6, 7, v26
    v_lshrrev_b32 v5, 1, v1
    v_and_b32 v6, 15, v2
    v_lshrrev_b32 v7, 2, v6
    v_lshl_add_u32 v26, v4, 3, v7
    v_lshrrev_b32 v27, 4, v2
    v_and_b32 v27, 1, v27
    v_and_b32 v28, 3, v2
    v_lshlrev_b32 v28, 3, v28
    v_lshl_add_u32 v28, v27, 5, v28
    v_lshl_add_u32 v29, v5, 1, 0
    v_xor_b32 v29, v29, v7
    v_lshl_add_u32 v29, v29, 6, v28
    v_lshl_add_u32 v24, v26, 8, v29
    v_add_u32 v24, 16384, v24
    v_lshl_add_u32 v29, v5, 1, 1
    v_xor_b32 v29, v29, v7
    v_lshl_add_u32 v29, v29, 6, v28
    v_lshl_add_u32 v25, v26, 8, v29
    v_add_u32 v25, 16384, v25
    v_mov_b32 v64, 0
    v_mov_b32 v65, 0
    v_mov_b32 v66, 0
    v_mov_b32 v67, 0
    v_mov_b32 v68, 0
    v_mov_b32 v69, 0
    v_mov_b32 v70, 0
    v_mov_b32 v71, 0
    v_mov_b32 v72, 0
    v_mov_b32 v73, 0
    v_mov_b32 v74, 0
    v_mov_b32 v75, 0
    v_mov_b32 v76, 0
    v_mov_b32 v77, 0
    v_mov_b32 v78, 0
    v_mov_b32 v79, 0
    v_mov_b32 v80, 0
    v_mov_b32 v81, 0
    v_mov_b32 v82, 0
    v_mov_b32 v83, 0
    v_mov_b32 v84, 0
    v_mov_b32 v85, 0
    v_mov_b32 v86, 0
    v_mov_b32 v87, 0
    v_mov_b32 v88, 0
    v_mov_b32 v89, 0
    v_mov_b32 v90, 0
    v_mov_b32 v91, 0
    v_mov_b32 v92, 0
    v_mov_b32 v93, 0
    v_mov_b32 v94, 0
    v_mov_b32 v95, 0
    v_mov_b32 v96, 0
    v_mov_b32 v97, 0
    v_mov_b32 v98, 0
    v_mov_b32 v99, 0
    v_mov_b32 v100, 0
    v_mov_b32 v101, 0
    v_mov_b32 v102, 0
    v_mov_b32 v103, 0
    v_mov_b32 v104, 0
    v_mov_b32 v105, 0
    v_mov_b32 v106, 0
    v_mov_b32 v107, 0
    v_mov_b32 v108, 0
    v_mov_b32 v109, 0
    v_mov_b32 v110, 0
    v_mov_b32 v111, 0
    v_mov_b32 v112, 0
    v_mov_b32 v113, 0
    v_mov_b32 v114, 0
    v_mov_b32 v115, 0
    v_mov_b32 v116, 0
    v_mov_b32 v117, 0
    v_mov_b32 v118, 0
    v_mov_b32 v119, 0
    v_mov_b32 v120, 0
    v_mov_b32 v121, 0
    v_mov_b32 v122, 0
    v_mov_b32 v123, 0
    v_mov_b32 v124, 0
    v_mov_b32 v125, 0
    v_mov_b32 v126, 0
    v_mov_b32 v127, 0
    s_add_u32 m0, s13, 0
    s_nop 0
    global_load_lds_dwordx4 v8, s[6:7]
    s_add_u32 m0, s13, 1024
    s_nop 0
    global_load_lds_dwordx4 v9, s[6:7]
    s_add_u32 m0, s13, 2048
    s_nop 0
    global_load_lds_dwordx4 v10, s[6:7]
    s_add_u32 m0, s13, 3072
    s_nop 0
    global_load_lds_dwordx4 v11, s[6:7]
    s_add_u32 m0, s13, 16384
    s_nop 0
    global_load_lds_dwordx4 v[12:13], off
    s_add_u32 m0, s13, 17408
    s_nop 0
    global_load_lds_dwordx4 v[14:15], off
    s_add_u32 m0, s13, 18432
    s_nop 0
    global_load_lds_dwordx4 v[16:17], off
    s_add_u32 m0, s13, 19456
    s_nop 0
    global_load_lds_dwordx4 v[18:19], off
    s_add_u32 s6, s6, 128
    s_addc_u32 s7, s7, 0
    v_add_co_u32 v12, vcc, 589824, v12
    v_addc_co_u32 v13, vcc, 0, v13, vcc
    v_add_co_u32 v14, vcc, 589824, v14
    v_addc_co_u32 v15, vcc, 0, v15, vcc
    v_add_co_u32 v16, vcc, 589824, v16
    v_addc_co_u32 v17, vcc, 0, v17, vcc
    v_add_co_u32 v18, vcc, 589824, v18
    v_addc_co_u32 v19, vcc, 0, v19, vcc
    s_add_u32 m0, s13, 32768
    s_nop 0
    global_load_lds_dwordx4 v8, s[6:7]
    s_add_u32 m0, s13, 33792
    s_nop 0
    global_load_lds_dwordx4 v9, s[6:7]
    s_add_u32 m0, s13, 34816
    s_nop 0
    global_load_lds_dwordx4 v10, s[6:7]
    s_add_u32 m0, s13, 35840
    s_nop 0
    global_load_lds_dwordx4 v11, s[6:7]
    s_add_u32 m0, s13, 49152
    s_nop 0
    global_load_lds_dwordx4 v[12:13], off
    s_add_u32 m0, s13, 50176
    s_nop 0
    global_load_lds_dwordx4 v[14:15], off
    s_add_u32 m0, s13, 51200
    s_nop 0
    global_load_lds_dwordx4 v[16:17], off
    s_add_u32 m0, s13, 52224
    s_nop 0
    global_load_lds_dwordx4 v[18:19], off
    s_add_u32 s6, s6, 128
    s_addc_u32 s7, s7, 0
    v_add_co_u32 v12, vcc, 589824, v12
    v_addc_co_u32 v13, vcc, 0, v13, vcc
    v_add_co_u32 v14, vcc, 589824, v14
    v_addc_co_u32 v15, vcc, 0, v15, vcc
    v_add_co_u32 v16, vcc, 589824, v16
    v_addc_co_u32 v17, vcc, 0, v17, vcc
    v_add_co_u32 v18, vcc, 589824, v18
    v_addc_co_u32 v19, vcc, 0, v19, vcc
    s_waitcnt vmcnt(8)
    s_barrier
    ds_read_b128 v[32:35], v20 offset:0
    ds_read_b128 v[36:39], v20 offset:4096
    ds_read_b64_tr_b16 v[40:41], v24 offset:0
    ds_read_b64_tr_b16 v[42:43], v24 offset:1024
    ds_read_b64_tr_b16 v[44:45], v25 offset:0
    ds_read_b64_tr_b16 v[46:47], v25 offset:1024
    ds_read_b128 v[48:51], v21 offset:0
    ds_read_b128 v[52:55], v21 offset:4096
    ds_read_b64_tr_b16 v[56:57], v24 offset:4096
    ds_read_b64_tr_b16 v[58:59], v24 offset:5120
    ds_read_b64_tr_b16 v[60:61], v25 offset:4096
    ds_read_b64_tr_b16 v[62:63], v25 offset:5120
    s_waitcnt lgkmcnt(6)
    v_mfma_f32_32x32x16_bf16 v[64:79], v[40:43], v[32:35], v[64:79]
    v_mfma_f32_32x32x16_bf16 v[80:95], v[44:47], v[32:35], v[80:95]
    v_mfma_f32_32x32x16_bf16 v[96:111], v[40:43], v[36:39], v[96:111]
    v_mfma_f32_32x32x16_bf16 v[112:127], v[44:47], v[36:39], v[112:127]
    ds_read_b128 v[32:35], v22 offset:0
    ds_read_b128 v[36:39], v22 offset:4096
    ds_read_b64_tr_b16 v[40:41], v24 offset:8192
    ds_read_b64_tr_b16 v[42:43], v24 offset:9216
    ds_read_b64_tr_b16 v[44:45], v25 offset:8192
    ds_read_b64_tr_b16 v[46:47], v25 offset:9216
    s_waitcnt lgkmcnt(6)
    v_mfma_f32_32x32x16_bf16 v[64:79], v[56:59], v[48:51], v[64:79]
    v_mfma_f32_32x32x16_bf16 v[80:95], v[60:63], v[48:51], v[80:95]
    v_mfma_f32_32x32x16_bf16 v[96:111], v[56:59], v[52:55], v[96:111]
    v_mfma_f32_32x32x16_bf16 v[112:127], v[60:63], v[52:55], v[112:127]
    ds_read_b128 v[48:51], v23 offset:0
    ds_read_b128 v[52:55], v23 offset:4096
    ds_read_b64_tr_b16 v[56:57], v24 offset:12288
    ds_read_b64_tr_b16 v[58:59], v24 offset:13312
    ds_read_b64_tr_b16 v[60:61], v25 offset:12288
    ds_read_b64_tr_b16 v[62:63], v25 offset:13312
    s_waitcnt lgkmcnt(6)
    v_mfma_f32_32x32x16_bf16 v[64:79], v[40:43], v[32:35], v[64:79]
    v_mfma_f32_32x32x16_bf16 v[80:95], v[44:47], v[32:35], v[80:95]
    v_mfma_f32_32x32x16_bf16 v[96:111], v[40:43], v[36:39], v[96:111]
    v_mfma_f32_32x32x16_bf16 v[112:127], v[44:47], v[36:39], v[112:127]
    s_waitcnt lgkmcnt(0)
    v_mfma_f32_32x32x16_bf16 v[64:79], v[56:59], v[48:51], v[64:79]
    v_mfma_f32_32x32x16_bf16 v[80:95], v[60:63], v[48:51], v[80:95]
    v_mfma_f32_32x32x16_bf16 v[96:111], v[56:59], v[52:55], v[96:111]
    v_mfma_f32_32x32x16_bf16 v[112:127], v[60:63], v[52:55], v[112:127]
    s_barrier
    s_add_u32 m0, s13, 0
    s_nop 0
    global_load_lds_dwordx4 v8, s[6:7]
    s_add_u32 m0, s13, 1024
    s_nop 0
    global_load_lds_dwordx4 v9, s[6:7]
    s_add_u32 m0, s13, 2048
    s_nop 0
    global_load_lds_dwordx4 v10, s[6:7]
    s_add_u32 m0, s13, 3072
    s_nop 0
    global_load_lds_dwordx4 v11, s[6:7]
    s_add_u32 m0, s13, 16384
    s_nop 0
    global_load_lds_dwordx4 v[12:13], off
    s_add_u32 m0, s13, 17408
    s_nop 0
    global_load_lds_dwordx4 v[14:15], off
    s_add_u32 m0, s13, 18432
    s_nop 0
    global_load_lds_dwordx4 v[16:17], off
    s_add_u32 m0, s13, 19456
    s_nop 0
    global_load_lds_dwordx4 v[18:19], off
    s_add_u32 s6, s6, 128
    s_addc_u32 s7, s7, 0
    v_add_co_u32 v12, vcc, 589824, v12
    v_addc_co_u32 v13, vcc, 0, v13, vcc
    v_add_co_u32 v14, vcc, 589824, v14
    v_addc_co_u32 v15, vcc, 0, v15, vcc
    v_add_co_u32 v16, vcc, 589824, v16
    v_addc_co_u32 v17, vcc, 0, v17, vcc
    v_add_co_u32 v18, vcc, 589824, v18
    v_addc_co_u32 v19, vcc, 0, v19, vcc
    s_waitcnt vmcnt(8)
    s_barrier
    ds_read_b128 v[32:35], v20 offset:32768
    ds_read_b128 v[36:39], v20 offset:36864
    ds_read_b64_tr_b16 v[40:41], v24 offset:32768
    ds_read_b64_tr_b16 v[42:43], v24 offset:33792
    ds_read_b64_tr_b16 v[44:45], v25 offset:32768
    ds_read_b64_tr_b16 v[46:47], v25 offset:33792
    ds_read_b128 v[48:51], v21 offset:32768
    ds_read_b128 v[52:55], v21 offset:36864
    ds_read_b64_tr_b16 v[56:57], v24 offset:36864
    ds_read_b64_tr_b16 v[58:59], v24 offset:37888
    ds_read_b64_tr_b16 v[60:61], v25 offset:36864
    ds_read_b64_tr_b16 v[62:63], v25 offset:37888
    s_waitcnt lgkmcnt(6)
    v_mfma_f32_32x32x16_bf16 v[64:79], v[40:43], v[32:35], v[64:79]
    v_mfma_f32_32x32x16_bf16 v[80:95], v[44:47], v[32:35], v[80:95]
    v_mfma_f32_32x32x16_bf16 v[96:111], v[40:43], v[36:39], v[96:111]
    v_mfma_f32_32x32x16_bf16 v[112:127], v[44:47], v[36:39], v[112:127]
    ds_read_b128 v[32:35], v22 offset:32768
    ds_read_b128 v[36:39], v22 offset:36864
    ds_read_b64_tr_b16 v[40:41], v24 offset:40960
    ds_read_b64_tr_b16 v[42:43], v24 offset:41984
    ds_read_b64_tr_b16 v[44:45], v25 offset:40960
    ds_read_b64_tr_b16 v[46:47], v25 offset:41984
    s_waitcnt lgkmcnt(6)
    v_mfma_f32_32x32x16_bf16 v[64:79], v[56:59], v[48:51], v[64:79]
    v_mfma_f32_32x32x16_bf16 v[80:95], v[60:63], v[48:51], v[80:95]
    v_mfma_f32_32x32x16_bf16 v[96:111], v[56:59], v[52:55], v[96:111]
    v_mfma_f32_32x32x16_bf16 v[112:127], v[60:63], v[52:55], v[112:127]
    ds_read_b128 v[48:51], v23 offset:32768
    ds_read_b128 v[52:55], v23 offset:36864
    ds_read_b64_tr_b16 v[56:57], v24 offset:45056
    ds_read_b64_tr_b16 v[58:59], v24 offset:46080
    ds_read_b64_tr_b16 v[60:61], v25 offset:45056
    ds_read_b64_tr_b16 v[62:63], v25 offset:46080
    s_waitcnt lgkmcnt(6)
    v_mfma_f32_32x32x16_bf16 v[64:79], v[40:43], v[32:35], v[64:79]
    v_mfma_f32_32x32x16_bf16 v[80:95], v[44:47], v[32:35], v[80:95]
    v_mfma_f32_32x32x16_bf16 v[96:111], v[40:43], v[36:39], v[96:111]
    v_mfma_f32_32x32x16_bf16 v[112:127], v[44:47], v[36:39], v[112:127]
    s_waitcnt lgkmcnt(0)
    v_mfma_f32_32x32x16_bf16 v[64:79], v[56:59], v[48:51], v[64:79]
    v_mfma_f32_32x32x16_bf16 v[80:95], v[60:63], v[48:51], v[80:95]
    v_mfma_f32_32x32x16_bf16 v[96:111], v[56:59], v[52:55], v[96:111]
    v_mfma_f32_32x32x16_bf16 v[112:127], v[60:63], v[52:55], v[112:127]
    s_barrier
    s_add_u32 m0, s13, 32768
    s_nop 0
    global_load_lds_dwordx4 v8, s[6:7]
    s_add_u32 m0, s13, 33792
    s_nop 0
    global_load_lds_dwordx4 v9, s[6:7]
    s_add_u32 m0, s13, 34816
    s_nop 0
    global_load_lds_dwordx4 v10, s[6:7]
    s_add_u32 m0, s13, 35840
    s_nop 0
    global_load_lds_dwordx4 v11, s[6:7]
    s_add_u32 m0, s13, 49152
    s_nop 0
    global_load_lds_dwordx4 v[12:13], off
    s_add_u32 m0, s13, 50176
    s_nop 0
    global_load_lds_dwordx4 v[14:15], off
    s_add_u32 m0, s13, 51200
    s_nop 0
    global_load_lds_dwordx4 v[16:17], off
    s_add_u32 m0, s13, 52224
    s_nop 0
    global_load_lds_dwordx4 v[18:19], off
    s_add_u32 s6, s6, 128
    s_addc_u32 s7, s7, 0
    v_add_co_u32 v12, vcc, 589824, v12
    v_addc_co_u32 v13, vcc, 0, v13, vcc
    v_add_co_u32 v14, vcc, 589824, v14
    v_addc_co_u32 v15, vcc, 0, v15, vcc
    v_add_co_u32 v16, vcc, 589824, v16
    v_addc_co_u32 v17, vcc, 0, v17, vcc
    v_add_co_u32 v18, vcc, 589824, v18
    v_addc_co_u32 v19, vcc, 0, v19, vcc
    s_waitcnt vmcnt(8)
    s_barrier
    ds_read_b128 v[32:35], v20 offset:0
    ds_read_b128 v[36:39], v20 offset:4096
    ds_read_b64_tr_b16 v[40:41], v24 offset:0
    ds_read_b64_tr_b16 v[42:43], v24 offset:1024
    ds_read_b64_tr_b16 v[44:45], v25 offset:0
    ds_read_b64_tr_b16 v[46:47], v25 offset:1024
    ds_read_b128 v[48:51], v21 offset:0
    ds_read_b128 v[52:55], v21 offset:4096
    ds_read_b64_tr_b16 v[56:57], v24 offset:4096
    ds_read_b64_tr_b16 v[58:59], v24 offset:5120
    ds_read_b64_tr_b16 v[60:61], v25 offset:4096
    ds_read_b64_tr_b16 v[62:63], v25 offset:5120
    s_waitcnt lgkmcnt(6)
    v_mfma_f32_32x32x16_bf16 v[64:79], v[40:43], v[32:35], v[64:79]
    v_mfma_f32_32x32x16_bf16 v[80:95], v[44:47], v[32:35], v[80:95]
    v_mfma_f32_32x32x16_bf16 v[96:111], v[40:43], v[36:39], v[96:111]
    v_mfma_f32_32x32x16_bf16 v[112:127], v[44:47], v[36:39], v[112:127]
    ds_read_b128 v[32:35], v22 offset:0
    ds_read_b128 v[36:39], v22 offset:4096
    ds_read_b64_tr_b16 v[40:41], v24 offset:8192
    ds_read_b64_tr_b16 v[42:43], v24 offset:9216
    ds_read_b64_tr_b16 v[44:45], v25 offset:8192
    ds_read_b64_tr_b16 v[46:47], v25 offset:9216
    s_waitcnt lgkmcnt(6)
    v_mfma_f32_32x32x16_bf16 v[64:79], v[56:59], v[48:51], v[64:79]
    v_mfma_f32_32x32x16_bf16 v[80:95], v[60:63], v[48:51], v[80:95]
    v_mfma_f32_32x32x16_bf16 v[96:111], v[56:59], v[52:55], v[96:111]
    v_mfma_f32_32x32x16_bf16 v[112:127], v[60:63], v[52:55], v[112:127]
    ds_read_b128 v[48:51], v23 offset:0
    ds_read_b128 v[52:55], v23 offset:4096
    ds_read_b64_tr_b16 v[56:57], v24 offset:12288
    ds_read_b64_tr_b16 v[58:59], v24 offset:13312
    ds_read_b64_tr_b16 v[60:61], v25 offset:12288
    ds_read_b64_tr_b16 v[62:63], v25 offset:13312
    s_waitcnt lgkmcnt(6)
    v_mfma_f32_32x32x16_bf16 v[64:79], v[40:43], v[32:35], v[64:79]
    v_mfma_f32_32x32x16_bf16 v[80:95], v[44:47], v[32:35], v[80:95]
    v_mfma_f32_32x32x16_bf16 v[96:111], v[40:43], v[36:39], v[96:111]
    v_mfma_f32_32x32x16_bf16 v[112:127], v[44:47], v[36:39], v[112:127]
    s_waitcnt lgkmcnt(0)
    v_mfma_f32_32x32x16_bf16 v[64:79], v[56:59], v[48:51], v[64:79]
    v_mfma_f32_32x32x16_bf16 v[80:95], v[60:63], v[48:51], v[80:95]
    v_mfma_f32_32x32x16_bf16 v[96:111], v[56:59], v[52:55], v[96:111]
    v_mfma_f32_32x32x16_bf16 v[112:127], v[60:63], v[52:55], v[112:127]
    s_barrier
    s_add_u32 m0, s13, 0
    s_nop 0
    global_load_lds_dwordx4 v8, s[6:7]
    s_add_u32 m0, s13, 1024
    s_nop 0
    global_load_lds_dwordx4 v9, s[6:7]
    s_add_u32 m0, s13, 2048
    s_nop 0
    global_load_lds_dwordx4 v10, s[6:7]
    s_add_u32 m0, s13, 3072
    s_nop 0
    global_load_lds_dwordx4 v11, s[6:7]
    s_add_u32 m0, s13, 16384
    s_nop 0
    global_load_lds_dwordx4 v[12:13], off
    s_add_u32 m0, s13, 17408
    s_nop 0
    global_load_lds_dwordx4 v[14:15], off
    s_add_u32 m0, s13, 18432
    s_nop 0
    global_load_lds_dwordx4 v[16:17], off
    s_add_u32 m0, s13, 19456
    s_nop 0
    global_load_lds_dwordx4 v[18:19], off
    s_add_u32 s6, s6, 128
    s_addc_u32 s7, s7, 0
    v_add_co_u32 v12, vcc, 589824, v12
    v_addc_co_u32 v13, vcc, 0, v13, vcc
    v_add_co_u32 v14, vcc, 589824, v14
    v_addc_co_u32 v15, vcc, 0, v15, vcc
    v_add_co_u32 v16, vcc, 589824, v16
    v_addc_co_u32 v17, vcc, 0, v17, vcc
    v_add_co_u32 v18, vcc, 589824, v18
    v_addc_co_u32 v19, vcc, 0, v19, vcc
    s_waitcnt vmcnt(8)
    s_barrier
    ds_read_b128 v[32:35], v20 offset:32768
    ds_read_b128 v[36:39], v20 offset:36864
    ds_read_b64_tr_b16 v[40:41], v24 offset:32768
    ds_read_b64_tr_b16 v[42:43], v24 offset:33792
    ds_read_b64_tr_b16 v[44:45], v25 offset:32768
    ds_read_b64_tr_b16 v[46:47], v25 offset:33792
    ds_read_b128 v[48:51], v21 offset:32768
    ds_read_b128 v[52:55], v21 offset:36864
    ds_read_b64_tr_b16 v[56:57], v24 offset:36864
    ds_read_b64_tr_b16 v[58:59], v24 offset:37888
    ds_read_b64_tr_b16 v[60:61], v25 offset:36864
    ds_read_b64_tr_b16 v[62:63], v25 offset:37888
    s_waitcnt lgkmcnt(6)
    v_mfma_f32_32x32x16_bf16 v[64:79], v[40:43], v[32:35], v[64:79]
    v_mfma_f32_32x32x16_bf16 v[80:95], v[44:47], v[32:35], v[80:95]
    v_mfma_f32_32x32x16_bf16 v[96:111], v[40:43], v[36:39], v[96:111]
    v_mfma_f32_32x32x16_bf16 v[112:127], v[44:47], v[36:39], v[112:127]
    ds_read_b128 v[32:35], v22 offset:32768
    ds_read_b128 v[36:39], v22 offset:36864
    ds_read_b64_tr_b16 v[40:41], v24 offset:40960
    ds_read_b64_tr_b16 v[42:43], v24 offset:41984
    ds_read_b64_tr_b16 v[44:45], v25 offset:40960
    ds_read_b64_tr_b16 v[46:47], v25 offset:41984
    s_waitcnt lgkmcnt(6)
    v_mfma_f32_32x32x16_bf16 v[64:79], v[56:59], v[48:51], v[64:79]
    v_mfma_f32_32x32x16_bf16 v[80:95], v[60:63], v[48:51], v[80:95]
    v_mfma_f32_32x32x16_bf16 v[96:111], v[56:59], v[52:55], v[96:111]
    v_mfma_f32_32x32x16_bf16 v[112:127], v[60:63], v[52:55], v[112:127]
    ds_read_b128 v[48:51], v23 offset:32768
    ds_read_b128 v[52:55], v23 offset:36864
    ds_read_b64_tr_b16 v[56:57], v24 offset:45056
    ds_read_b64_tr_b16 v[58:59], v24 offset:46080
    ds_read_b64_tr_b16 v[60:61], v25 offset:45056
    ds_read_b64_tr_b16 v[62:63], v25 offset:46080
    s_waitcnt lgkmcnt(6)
    v_mfma_f32_32x32x16_bf16 v[64:79], v[40:43], v[32:35], v[64:79]
    v_mfma_f32_32x32x16_bf16 v[80:95], v[44:47], v[32:35], v[80:95]
    v_mfma_f32_32x32x16_bf16 v[96:111], v[40:43], v[36:39], v[96:111]
    v_mfma_f32_32x32x16_bf16 v[112:127], v[44:47], v[36:39], v[112:127]
    s_waitcnt lgkmcnt(0)
    v_mfma_f32_32x32x16_bf16 v[64:79], v[56:59], v[48:51], v[64:79]
    v_mfma_f32_32x32x16_bf16 v[80:95], v[60:63], v[48:51], v[80:95]
    v_mfma_f32_32x32x16_bf16 v[96:111], v[56:59], v[52:55], v[96:111]
    v_mfma_f32_32x32x16_bf16 v[112:127], v[60:63], v[52:55], v[112:127]
    s_barrier
    s_add_u32 m0, s13, 32768
    s_nop 0
    global_load_lds_dwordx4 v8, s[6:7]
    s_add_u32 m0, s13, 33792
    s_nop 0
    global_load_lds_dwordx4 v9, s[6:7]
    s_add_u32 m0, s13, 34816
    s_nop 0
    global_load_lds_dwordx4 v10, s[6:7]
    s_add_u32 m0, s13, 35840
    s_nop 0
    global_load_lds_dwordx4 v11, s[6:7]
    s_add_u32 m0, s13, 49152
    s_nop 0
    global_load_lds_dwordx4 v[12:13], off
    s_add_u32 m0, s13, 50176
    s_nop 0
    global_load_lds_dwordx4 v[14:15], off
    s_add_u32 m0, s13, 51200
    s_nop 0
    global_load_lds_dwordx4 v[16:17], off
    s_add_u32 m0, s13, 52224
    s_nop 0
    global_load_lds_dwordx4 v[18:19], off
    s_add_u32 s6, s6, 128
    s_addc_u32 s7, s7, 0
    v_add_co_u32 v12, vcc, 589824, v12
    v_addc_co_u32 v13, vcc, 0, v13, vcc
    v_add_co_u32 v14, vcc, 589824, v14
    v_addc_co_u32 v15, vcc, 0, v15, vcc
    v_add_co_u32 v16, vcc, 589824, v16
    v_addc_co_u32 v17, vcc, 0, v17, vcc
    v_add_co_u32 v18, vcc, 589824, v18
    v_addc_co_u32 v19, vcc, 0, v19, vcc
    s_waitcnt vmcnt(8)
    s_barrier
    ds_read_b128 v[32:35], v20 offset:0
    ds_read_b128 v[36:39], v20 offset:4096
    ds_read_b64_tr_b16 v[40:41], v24 offset:0
    ds_read_b64_tr_b16 v[42:43], v24 offset:1024
    ds_read_b64_tr_b16 v[44:45], v25 offset:0
    ds_read_b64_tr_b16 v[46:47], v25 offset:1024
    ds_read_b128 v[48:51], v21 offset:0
    ds_read_b128 v[52:55], v21 offset:4096
    ds_read_b64_tr_b16 v[56:57], v24 offset:4096
    ds_read_b64_tr_b16 v[58:59], v24 offset:5120
    ds_read_b64_tr_b16 v[60:61], v25 offset:4096
    ds_read_b64_tr_b16 v[62:63], v25 offset:5120
    s_waitcnt lgkmcnt(6)
    v_mfma_f32_32x32x16_bf16 v[64:79], v[40:43], v[32:35], v[64:79]
    v_mfma_f32_32x32x16_bf16 v[80:95], v[44:47], v[32:35], v[80:95]
    v_mfma_f32_32x32x16_bf16 v[96:111], v[40:43], v[36:39], v[96:111]
    v_mfma_f32_32x32x16_bf16 v[112:127], v[44:47], v[36:39], v[112:127]
    ds_read_b128 v[32:35], v22 offset:0
    ds_read_b128 v[36:39], v22 offset:4096
    ds_read_b64_tr_b16 v[40:41], v24 offset:8192
    ds_read_b64_tr_b16 v[42:43], v24 offset:9216
    ds_read_b64_tr_b16 v[44:45], v25 offset:8192
    ds_read_b64_tr_b16 v[46:47], v25 offset:9216
    s_waitcnt lgkmcnt(6)
    v_mfma_f32_32x32x16_bf16 v[64:79], v[56:59], v[48:51], v[64:79]
    v_mfma_f32_32x32x16_bf16 v[80:95], v[60:63], v[48:51], v[80:95]
    v_mfma_f32_32x32x16_bf16 v[96:111], v[56:59], v[52:55], v[96:111]
    v_mfma_f32_32x32x16_bf16 v[112:127], v[60:63], v[52:55], v[112:127]
    ds_read_b128 v[48:51], v23 offset:0
    ds_read_b128 v[52:55], v23 offset:4096
    ds_read_b64_tr_b16 v[56:57], v24 offset:12288
    ds_read_b64_tr_b16 v[58:59], v24 offset:13312
    ds_read_b64_tr_b16 v[60:61], v25 offset:12288
    ds_read_b64_tr_b16 v[62:63], v25 offset:13312
    s_waitcnt lgkmcnt(6)
    v_mfma_f32_32x32x16_bf16 v[64:79], v[40:43], v[32:35], v[64:79]
    v_mfma_f32_32x32x16_bf16 v[80:95], v[44:47], v[32:35], v[80:95]
    v_mfma_f32_32x32x16_bf16 v[96:111], v[40:43], v[36:39], v[96:111]
    v_mfma_f32_32x32x16_bf16 v[112:127], v[44:47], v[36:39], v[112:127]
    s_waitcnt lgkmcnt(0)
    v_mfma_f32_32x32x16_bf16 v[64:79], v[56:59], v[48:51], v[64:79]
    v_mfma_f32_32x32x16_bf16 v[80:95], v[60:63], v[48:51], v[80:95]
    v_mfma_f32_32x32x16_bf16 v[96:111], v[56:59], v[52:55], v[96:111]
    v_mfma_f32_32x32x16_bf16 v[112:127], v[60:63], v[52:55], v[112:127]
    s_barrier
    s_add_u32 m0, s13, 0
    s_nop 0
    global_load_lds_dwordx4 v8, s[6:7]
    s_add_u32 m0, s13, 1024
    s_nop 0
    global_load_lds_dwordx4 v9, s[6:7]
    s_add_u32 m0, s13, 2048
    s_nop 0
    global_load_lds_dwordx4 v10, s[6:7]
    s_add_u32 m0, s13, 3072
    s_nop 0
    global_load_lds_dwordx4 v11, s[6:7]
    s_add_u32 m0, s13, 16384
    s_nop 0
    global_load_lds_dwordx4 v[12:13], off
    s_add_u32 m0, s13, 17408
    s_nop 0
    global_load_lds_dwordx4 v[14:15], off
    s_add_u32 m0, s13, 18432
    s_nop 0
    global_load_lds_dwordx4 v[16:17], off
    s_add_u32 m0, s13, 19456
    s_nop 0
    global_load_lds_dwordx4 v[18:19], off
    s_add_u32 s6, s6, 128
    s_addc_u32 s7, s7, 0
    v_add_co_u32 v12, vcc, 589824, v12
    v_addc_co_u32 v13, vcc, 0, v13, vcc
    v_add_co_u32 v14, vcc, 589824, v14
    v_addc_co_u32 v15, vcc, 0, v15, vcc
    v_add_co_u32 v16, vcc, 589824, v16
    v_addc_co_u32 v17, vcc, 0, v17, vcc
    v_add_co_u32 v18, vcc, 589824, v18
    v_addc_co_u32 v19, vcc, 0, v19, vcc
    s_waitcnt vmcnt(8)
    s_barrier
    ds_read_b128 v[32:35], v20 offset:32768
    ds_read_b128 v[36:39], v20 offset:36864
    ds_read_b64_tr_b16 v[40:41], v24 offset:32768
    ds_read_b64_tr_b16 v[42:43], v24 offset:33792
    ds_read_b64_tr_b16 v[44:45], v25 offset:32768
    ds_read_b64_tr_b16 v[46:47], v25 offset:33792
    ds_read_b128 v[48:51], v21 offset:32768
    ds_read_b128 v[52:55], v21 offset:36864
    ds_read_b64_tr_b16 v[56:57], v24 offset:36864
    ds_read_b64_tr_b16 v[58:59], v24 offset:37888
    ds_read_b64_tr_b16 v[60:61], v25 offset:36864
    ds_read_b64_tr_b16 v[62:63], v25 offset:37888
    s_waitcnt lgkmcnt(6)
    v_mfma_f32_32x32x16_bf16 v[64:79], v[40:43], v[32:35], v[64:79]
    v_mfma_f32_32x32x16_bf16 v[80:95], v[44:47], v[32:35], v[80:95]
    v_mfma_f32_32x32x16_bf16 v[96:111], v[40:43], v[36:39], v[96:111]
    v_mfma_f32_32x32x16_bf16 v[112:127], v[44:47], v[36:39], v[112:127]
    ds_read_b128 v[32:35], v22 offset:32768
    ds_read_b128 v[36:39], v22 offset:36864
    ds_read_b64_tr_b16 v[40:41], v24 offset:40960
    ds_read_b64_tr_b16 v[42:43], v24 offset:41984
    ds_read_b64_tr_b16 v[44:45], v25 offset:40960
    ds_read_b64_tr_b16 v[46:47], v25 offset:41984
    s_waitcnt lgkmcnt(6)
    v_mfma_f32_32x32x16_bf16 v[64:79], v[56:59], v[48:51], v[64:79]
    v_mfma_f32_32x32x16_bf16 v[80:95], v[60:63], v[48:51], v[80:95]
    v_mfma_f32_32x32x16_bf16 v[96:111], v[56:59], v[52:55], v[96:111]
    v_mfma_f32_32x32x16_bf16 v[112:127], v[60:63], v[52:55], v[112:127]
    ds_read_b128 v[48:51], v23 offset:32768
    ds_read_b128 v[52:55], v23 offset:36864
    ds_read_b64_tr_b16 v[56:57], v24 offset:45056
    ds_read_b64_tr_b16 v[58:59], v24 offset:46080
    ds_read_b64_tr_b16 v[60:61], v25 offset:45056
    ds_read_b64_tr_b16 v[62:63], v25 offset:46080
    s_waitcnt lgkmcnt(6)
    v_mfma_f32_32x32x16_bf16 v[64:79], v[40:43], v[32:35], v[64:79]
    v_mfma_f32_32x32x16_bf16 v[80:95], v[44:47], v[32:35], v[80:95]
    v_mfma_f32_32x32x16_bf16 v[96:111], v[40:43], v[36:39], v[96:111]
    v_mfma_f32_32x32x16_bf16 v[112:127], v[44:47], v[36:39], v[112:127]
    s_waitcnt lgkmcnt(0)
    v_mfma_f32_32x32x16_bf16 v[64:79], v[56:59], v[48:51], v[64:79]
    v_mfma_f32_32x32x16_bf16 v[80:95], v[60:63], v[48:51], v[80:95]
    v_mfma_f32_32x32x16_bf16 v[96:111], v[56:59], v[52:55], v[96:111]
    v_mfma_f32_32x32x16_bf16 v[112:127], v[60:63], v[52:55], v[112:127]
    s_barrier
    s_add_u32 m0, s13, 32768
    s_nop 0
    global_load_lds_dwordx4 v8, s[6:7]
    s_add_u32 m0, s13, 33792
    s_nop 0
    global_load_lds_dwordx4 v9, s[6:7]
    s_add_u32 m0, s13, 34816
    s_nop 0
    global_load_lds_dwordx4 v10, s[6:7]
    s_add_u32 m0, s13, 35840
    s_nop 0
    global_load_lds_dwordx4 v11, s[6:7]
    s_add_u32 m0, s13, 49152
    s_nop 0
    global_load_lds_dwordx4 v[12:13], off
    s_add_u32 m0, s13, 50176
    s_nop 0
    global_load_lds_dwordx4 v[14:15], off
    s_add_u32 m0, s13, 51200
    s_nop 0
    global_load_lds_dwordx4 v[16:17], off
    s_add_u32 m0, s13, 52224
    s_nop 0
    global_load_lds_dwordx4 v[18:19], off
    s_add_u32 s6, s6, 128
    s_addc_u32 s7, s7, 0
    v_add_co_u32 v12, vcc, 589824, v12
    v_addc_co_u32 v13, vcc, 0, v13, vcc
    v_add_co_u32 v14, vcc, 589824, v14
    v_addc_co_u32 v15, vcc, 0, v15, vcc
    v_add_co_u32 v16, vcc, 589824, v16
    v_addc_co_u32 v17, vcc, 0, v17, vcc
    v_add_co_u32 v18, vcc, 589824, v18
    v_addc_co_u32 v19, vcc, 0, v19, vcc
    s_waitcnt vmcnt(8)
    s_barrier
    ds_read_b128 v[32:35], v20 offset:0
    ds_read_b128 v[36:39], v20 offset:4096
    ds_read_b64_tr_b16 v[40:41], v24 offset:0
    ds_read_b64_tr_b16 v[42:43], v24 offset:1024
    ds_read_b64_tr_b16 v[44:45], v25 offset:0
    ds_read_b64_tr_b16 v[46:47], v25 offset:1024
    ds_read_b128 v[48:51], v21 offset:0
    ds_read_b128 v[52:55], v21 offset:4096
    ds_read_b64_tr_b16 v[56:57], v24 offset:4096
    ds_read_b64_tr_b16 v[58:59], v24 offset:5120
    ds_read_b64_tr_b16 v[60:61], v25 offset:4096
    ds_read_b64_tr_b16 v[62:63], v25 offset:5120
    s_waitcnt lgkmcnt(6)
    v_mfma_f32_32x32x16_bf16 v[64:79], v[40:43], v[32:35], v[64:79]
    v_mfma_f32_32x32x16_bf16 v[80:95], v[44:47], v[32:35], v[80:95]
    v_mfma_f32_32x32x16_bf16 v[96:111], v[40:43], v[36:39], v[96:111]
    v_mfma_f32_32x32x16_bf16 v[112:127], v[44:47], v[36:39], v[112:127]
    ds_read_b128 v[32:35], v22 offset:0
    ds_read_b128 v[36:39], v22 offset:4096
    ds_read_b64_tr_b16 v[40:41], v24 offset:8192
    ds_read_b64_tr_b16 v[42:43], v24 offset:9216
    ds_read_b64_tr_b16 v[44:45], v25 offset:8192
    ds_read_b64_tr_b16 v[46:47], v25 offset:9216
    s_waitcnt lgkmcnt(6)
    v_mfma_f32_32x32x16_bf16 v[64:79], v[56:59], v[48:51], v[64:79]
    v_mfma_f32_32x32x16_bf16 v[80:95], v[60:63], v[48:51], v[80:95]
    v_mfma_f32_32x32x16_bf16 v[96:111], v[56:59], v[52:55], v[96:111]
    v_mfma_f32_32x32x16_bf16 v[112:127], v[60:63], v[52:55], v[112:127]
    ds_read_b128 v[48:51], v23 offset:0
    ds_read_b128 v[52:55], v23 offset:4096
    ds_read_b64_tr_b16 v[56:57], v24 offset:12288
    ds_read_b64_tr_b16 v[58:59], v24 offset:13312
    ds_read_b64_tr_b16 v[60:61], v25 offset:12288
    ds_read_b64_tr_b16 v[62:63], v25 offset:13312
    s_waitcnt lgkmcnt(6)
    v_mfma_f32_32x32x16_bf16 v[64:79], v[40:43], v[32:35], v[64:79]
    v_mfma_f32_32x32x16_bf16 v[80:95], v[44:47], v[32:35], v[80:95]
    v_mfma_f32_32x32x16_bf16 v[96:111], v[40:43], v[36:39], v[96:111]
    v_mfma_f32_32x32x16_bf16 v[112:127], v[44:47], v[36:39], v[112:127]
    s_waitcnt lgkmcnt(0)
    v_mfma_f32_32x32x16_bf16 v[64:79], v[56:59], v[48:51], v[64:79]
    v_mfma_f32_32x32x16_bf16 v[80:95], v[60:63], v[48:51], v[80:95]
    v_mfma_f32_32x32x16_bf16 v[96:111], v[56:59], v[52:55], v[96:111]
    v_mfma_f32_32x32x16_bf16 v[112:127], v[60:63], v[52:55], v[112:127]
    s_barrier
    s_add_u32 m0, s13, 0
    s_nop 0
    global_load_lds_dwordx4 v8, s[6:7]
    s_add_u32 m0, s13, 1024
    s_nop 0
    global_load_lds_dwordx4 v9, s[6:7]
    s_add_u32 m0, s13, 2048
    s_nop 0
    global_load_lds_dwordx4 v10, s[6:7]
    s_add_u32 m0, s13, 3072
    s_nop 0
    global_load_lds_dwordx4 v11, s[6:7]
    s_add_u32 m0, s13, 16384
    s_nop 0
    global_load_lds_dwordx4 v[12:13], off
    s_add_u32 m0, s13, 17408
    s_nop 0
    global_load_lds_dwordx4 v[14:15], off
    s_add_u32 m0, s13, 18432
    s_nop 0
    global_load_lds_dwordx4 v[16:17], off
    s_add_u32 m0, s13, 19456
    s_nop 0
    global_load_lds_dwordx4 v[18:19], off
    s_add_u32 s6, s6, 128
    s_addc_u32 s7, s7, 0
    v_add_co_u32 v12, vcc, 589824, v12
    v_addc_co_u32 v13, vcc, 0, v13, vcc
    v_add_co_u32 v14, vcc, 589824, v14
    v_addc_co_u32 v15, vcc, 0, v15, vcc
    v_add_co_u32 v16, vcc, 589824, v16
    v_addc_co_u32 v17, vcc, 0, v17, vcc
    v_add_co_u32 v18, vcc, 589824, v18
    v_addc_co_u32 v19, vcc, 0, v19, vcc
    s_waitcnt vmcnt(8)
    s_barrier
    ds_read_b128 v[32:35], v20 offset:32768
    ds_read_b128 v[36:39], v20 offset:36864
    ds_read_b64_tr_b16 v[40:41], v24 offset:32768
    ds_read_b64_tr_b16 v[42:43], v24 offset:33792
    ds_read_b64_tr_b16 v[44:45], v25 offset:32768
    ds_read_b64_tr_b16 v[46:47], v25 offset:33792
    ds_read_b128 v[48:51], v21 offset:32768
    ds_read_b128 v[52:55], v21 offset:36864
    ds_read_b64_tr_b16 v[56:57], v24 offset:36864
    ds_read_b64_tr_b16 v[58:59], v24 offset:37888
    ds_read_b64_tr_b16 v[60:61], v25 offset:36864
    ds_read_b64_tr_b16 v[62:63], v25 offset:37888
    s_waitcnt lgkmcnt(6)
    v_mfma_f32_32x32x16_bf16 v[64:79], v[40:43], v[32:35], v[64:79]
    v_mfma_f32_32x32x16_bf16 v[80:95], v[44:47], v[32:35], v[80:95]
    v_mfma_f32_32x32x16_bf16 v[96:111], v[40:43], v[36:39], v[96:111]
    v_mfma_f32_32x32x16_bf16 v[112:127], v[44:47], v[36:39], v[112:127]
    ds_read_b128 v[32:35], v22 offset:32768
    ds_read_b128 v[36:39], v22 offset:36864
    ds_read_b64_tr_b16 v[40:41], v24 offset:40960
    ds_read_b64_tr_b16 v[42:43], v24 offset:41984
    ds_read_b64_tr_b16 v[44:45], v25 offset:40960
    ds_read_b64_tr_b16 v[46:47], v25 offset:41984
    s_waitcnt lgkmcnt(6)
    v_mfma_f32_32x32x16_bf16 v[64:79], v[56:59], v[48:51], v[64:79]
    v_mfma_f32_32x32x16_bf16 v[80:95], v[60:63], v[48:51], v[80:95]
    v_mfma_f32_32x32x16_bf16 v[96:111], v[56:59], v[52:55], v[96:111]
    v_mfma_f32_32x32x16_bf16 v[112:127], v[60:63], v[52:55], v[112:127]
    ds_read_b128 v[48:51], v23 offset:32768
    ds_read_b128 v[52:55], v23 offset:36864
    ds_read_b64_tr_b16 v[56:57], v24 offset:45056
    ds_read_b64_tr_b16 v[58:59], v24 offset:46080
    ds_read_b64_tr_b16 v[60:61], v25 offset:45056
    ds_read_b64_tr_b16 v[62:63], v25 offset:46080
    s_waitcnt lgkmcnt(6)
    v_mfma_f32_32x32x16_bf16 v[64:79], v[40:43], v[32:35], v[64:79]
    v_mfma_f32_32x32x16_bf16 v[80:95], v[44:47], v[32:35], v[80:95]
    v_mfma_f32_32x32x16_bf16 v[96:111], v[40:43], v[36:39], v[96:111]
    v_mfma_f32_32x32x16_bf16 v[112:127], v[44:47], v[36:39], v[112:127]
    s_waitcnt lgkmcnt(0)
    v_mfma_f32_32x32x16_bf16 v[64:79], v[56:59], v[48:51], v[64:79]
    v_mfma_f32_32x32x16_bf16 v[80:95], v[60:63], v[48:51], v[80:95]
    v_mfma_f32_32x32x16_bf16 v[96:111], v[56:59], v[52:55], v[96:111]
    v_mfma_f32_32x32x16_bf16 v[112:127], v[60:63], v[52:55], v[112:127]
    s_barrier
    s_waitcnt vmcnt(0)
    s_barrier
    ds_read_b128 v[32:35], v20 offset:0
    ds_read_b128 v[36:39], v20 offset:4096
    ds_read_b64_tr_b16 v[40:41], v24 offset:0
    ds_read_b64_tr_b16 v[42:43], v24 offset:1024
    ds_read_b64_tr_b16 v[44:45], v25 offset:0
    ds_read_b64_tr_b16 v[46:47], v25 offset:1024
    ds_read_b128 v[48:51], v21 offset:0
    ds_read_b128 v[52:55], v21 offset:4096
    ds_read_b64_tr_b16 v[56:57], v24 offset:4096
    ds_read_b64_tr_b16 v[58:59], v24 offset:5120
    ds_read_b64_tr_b16 v[60:61], v25 offset:4096
    ds_read_b64_tr_b16 v[62:63], v25 offset:5120
    s_waitcnt lgkmcnt(6)
    v_mfma_f32_32x32x16_bf16 v[64:79], v[40:43], v[32:35], v[64:79]
    v_mfma_f32_32x32x16_bf16 v[80:95], v[44:47], v[32:35], v[80:95]
    v_mfma_f32_32x32x16_bf16 v[96:111], v[40:43], v[36:39], v[96:111]
    v_mfma_f32_32x32x16_bf16 v[112:127], v[44:47], v[36:39], v[112:127]
    ds_read_b128 v[32:35], v22 offset:0
    ds_read_b128 v[36:39], v22 offset:4096
    ds_read_b64_tr_b16 v[40:41], v24 offset:8192
    ds_read_b64_tr_b16 v[42:43], v24 offset:9216
    ds_read_b64_tr_b16 v[44:45], v25 offset:8192
    ds_read_b64_tr_b16 v[46:47], v25 offset:9216
    s_waitcnt lgkmcnt(6)
    v_mfma_f32_32x32x16_bf16 v[64:79], v[56:59], v[48:51], v[64:79]
    v_mfma_f32_32x32x16_bf16 v[80:95], v[60:63], v[48:51], v[80:95]
    v_mfma_f32_32x32x16_bf16 v[96:111], v[56:59], v[52:55], v[96:111]
    v_mfma_f32_32x32x16_bf16 v[112:127], v[60:63], v[52:55], v[112:127]
    ds_read_b128 v[48:51], v23 offset:0
    ds_read_b128 v[52:55], v23 offset:4096
    ds_read_b64_tr_b16 v[56:57], v24 offset:12288
    ds_read_b64_tr_b16 v[58:59], v24 offset:13312
    ds_read_b64_tr_b16 v[60:61], v25 offset:12288
    ds_read_b64_tr_b16 v[62:63], v25 offset:13312
    s_waitcnt lgkmcnt(6)
    v_mfma_f32_32x32x16_bf16 v[64:79], v[40:43], v[32:35], v[64:79]
    v_mfma_f32_32x32x16_bf16 v[80:95], v[44:47], v[32:35], v[80:95]
    v_mfma_f32_32x32x16_bf16 v[96:111], v[40:43], v[36:39], v[96:111]
    v_mfma_f32_32x32x16_bf16 v[112:127], v[44:47], v[36:39], v[112:127]
    s_waitcnt lgkmcnt(0)
    v_mfma_f32_32x32x16_bf16 v[64:79], v[56:59], v[48:51], v[64:79]
    v_mfma_f32_32x32x16_bf16 v[80:95], v[60:63], v[48:51], v[80:95]
    v_mfma_f32_32x32x16_bf16 v[96:111], v[56:59], v[52:55], v[96:111]
    v_mfma_f32_32x32x16_bf16 v[112:127], v[60:63], v[52:55], v[112:127]
    s_barrier
    s_nop 15
    v_and_b32 v3, 31, v2
    v_lshrrev_b32 v4, 5, v2
    v_and_b32 v5, 1, v1
    v_lshrrev_b32 v6, 1, v1
    v_lshl_add_u32 v7, v5, 6, v3
    s_lshl_b32 s18, s16, 7
    v_add_u32 v7, s18, v7
    v_lshlrev_b32 v8, 2, v2
    v_lshl_add_u32 v8, v5, 14, v8
    v_cmp_eq_u32 vcc, 1, v6
    s_and_saveexec_b64 s[24:25], vcc
    s_cbranch_execz ffn1_kernel_g1
    ds_write_b32 v8, v64 offset:0
    ds_write_b32 v8, v65 offset:256
    ds_write_b32 v8, v66 offset:512
    ds_write_b32 v8, v67 offset:768
    ds_write_b32 v8, v68 offset:1024
    ds_write_b32 v8, v69 offset:1280
    ds_write_b32 v8, v70 offset:1536
    ds_write_b32 v8, v71 offset:1792
    ds_write_b32 v8, v72 offset:2048
    ds_write_b32 v8, v73 offset:2304
    ds_write_b32 v8, v74 offset:2560
    ds_write_b32 v8, v75 offset:2816
    ds_write_b32 v8, v76 offset:3072
    ds_write_b32 v8, v77 offset:3328
    ds_write_b32 v8, v78 offset:3584
    ds_write_b32 v8, v79 offset:3840
    ds_write_b32 v8, v80 offset:4096
    ds_write_b32 v8, v81 offset:4352
    ds_write_b32 v8, v82 offset:4608
    ds_write_b32 v8, v83 offset:4864
    ds_write_b32 v8, v84 offset:5120
    ds_write_b32 v8, v85 offset:5376
    ds_write_b32 v8, v86 offset:5632
    ds_write_b32 v8, v87 offset:5888
    ds_write_b32 v8, v88 offset:6144
    ds_write_b32 v8, v89 offset:6400
    ds_write_b32 v8, v90 offset:6656
    ds_write_b32 v8, v91 offset:6912
    ds_write_b32 v8, v92 offset:7168
    ds_write_b32 v8, v93 offset:7424
    ds_write_b32 v8, v94 offset:7680
    ds_write_b32 v8, v95 offset:7936
    ds_write_b32 v8, v96 offset:8192
    ds_write_b32 v8, v97 offset:8448
    ds_write_b32 v8, v98 offset:8704
    ds_write_b32 v8, v99 offset:8960
    ds_write_b32 v8, v100 offset:9216
    ds_write_b32 v8, v101 offset:9472
    ds_write_b32 v8, v102 offset:9728
    ds_write_b32 v8, v103 offset:9984
    ds_write_b32 v8, v104 offset:10240
    ds_write_b32 v8, v105 offset:10496
    ds_write_b32 v8, v106 offset:10752
    ds_write_b32 v8, v107 offset:11008
    ds_write_b32 v8, v108 offset:11264
    ds_write_b32 v8, v109 offset:11520
    ds_write_b32 v8, v110 offset:11776
    ds_write_b32 v8, v111 offset:12032
    ds_write_b32 v8, v112 offset:12288
    ds_write_b32 v8, v113 offset:12544
    ds_write_b32 v8, v114 offset:12800
    ds_write_b32 v8, v115 offset:13056
    ds_write_b32 v8, v116 offset:13312
    ds_write_b32 v8, v117 offset:13568
    ds_write_b32 v8, v118 offset:13824
    ds_write_b32 v8, v119 offset:14080
    ds_write_b32 v8, v120 offset:14336
    ds_write_b32 v8, v121 offset:14592
    ds_write_b32 v8, v122 offset:14848
    ds_write_b32 v8, v123 offset:15104
    ds_write_b32 v8, v124 offset:15360
    ds_write_b32 v8, v125 offset:15616
    ds_write_b32 v8, v126 offset:15872
    ds_write_b32 v8, v127 offset:16128
ffn1_kernel_g1:
    s_mov_b64 exec, s[24:25]
    s_waitcnt lgkmcnt(0)
    s_barrier
    v_cmp_eq_u32 vcc, 0, v6
    s_and_saveexec_b64 s[24:25], vcc
    s_cbranch_execz ffn1_kernel_end
    s_add_u32 s22, s4, 84951040
    s_addc_u32 s23, s5, 0
    s_lshl_b32 s19, s17, 7
    s_add_u32 s22, s22, s19
    s_addc_u32 s23, s23, 0
    s_mov_b32 s20, 9216
    v_mul_lo_u32 v9, v7, s20
    v_lshl_add_u32 v9, v4, 3, v9
    ds_read_b32 v12, v8 offset:0
    ds_read_b32 v13, v8 offset:256
    ds_read_b32 v14, v8 offset:512
    ds_read_b32 v15, v8 offset:768
    s_waitcnt lgkmcnt(0)
    v_cvt_pk_bf16_f32 v16, v64, v64
    v_lshlrev_b32 v16, 16, v16
    v_cvt_pk_bf16_f32 v17, v12, v12
    v_lshlrev_b32 v17, 16, v17
    v_max_f32 v16, 0, v16
    v_mul_f32 v12, v16, v17
    v_cvt_pk_bf16_f32 v16, v65, v65
    v_lshlrev_b32 v16, 16, v16
    v_cvt_pk_bf16_f32 v17, v13, v13
    v_lshlrev_b32 v17, 16, v17
    v_max_f32 v16, 0, v16
    v_mul_f32 v13, v16, v17
    v_cvt_pk_bf16_f32 v16, v66, v66
    v_lshlrev_b32 v16, 16, v16
    v_cvt_pk_bf16_f32 v17, v14, v14
    v_lshlrev_b32 v17, 16, v17
    v_max_f32 v16, 0, v16
    v_mul_f32 v14, v16, v17
    v_cvt_pk_bf16_f32 v16, v67, v67
    v_lshlrev_b32 v16, 16, v16
    v_cvt_pk_bf16_f32 v17, v15, v15
    v_lshlrev_b32 v17, 16, v17
    v_max_f32 v16, 0, v16
    v_mul_f32 v15, v16, v17
    v_cvt_pk_bf16_f32 v10, v12, v13
    v_cvt_pk_bf16_f32 v11, v14, v15
    global_store_dwordx2 v9, v[10:11], s[22:23] offset:0
    ds_read_b32 v12, v8 offset:1024
    ds_read_b32 v13, v8 offset:1280
    ds_read_b32 v14, v8 offset:1536
    ds_read_b32 v15, v8 offset:1792
    s_waitcnt lgkmcnt(0)
    v_cvt_pk_bf16_f32 v16, v68, v68
    v_lshlrev_b32 v16, 16, v16
    v_cvt_pk_bf16_f32 v17, v12, v12
    v_lshlrev_b32 v17, 16, v17
    v_max_f32 v16, 0, v16
    v_mul_f32 v12, v16, v17
    v_cvt_pk_bf16_f32 v16, v69, v69
    v_lshlrev_b32 v16, 16, v16
    v_cvt_pk_bf16_f32 v17, v13, v13
    v_lshlrev_b32 v17, 16, v17
    v_max_f32 v16, 0, v16
    v_mul_f32 v13, v16, v17
    v_cvt_pk_bf16_f32 v16, v70, v70
    v_lshlrev_b32 v16, 16, v16
    v_cvt_pk_bf16_f32 v17, v14, v14
    v_lshlrev_b32 v17, 16, v17
    v_max_f32 v16, 0, v16
    v_mul_f32 v14, v16, v17
    v_cvt_pk_bf16_f32 v16, v71, v71
    v_lshlrev_b32 v16, 16, v16
    v_cvt_pk_bf16_f32 v17, v15, v15
    v_lshlrev_b32 v17, 16, v17
    v_max_f32 v16, 0, v16
    v_mul_f32 v15, v16, v17
    v_cvt_pk_bf16_f32 v10, v12, v13
    v_cvt_pk_bf16_f32 v11, v14, v15
    global_store_dwordx2 v9, v[10:11], s[22:23] offset:16
    ds_read_b32 v12, v8 offset:2048
    ds_read_b32 v13, v8 offset:2304
    ds_read_b32 v14, v8 offset:2560
    ds_read_b32 v15, v8 offset:2816
    s_waitcnt lgkmcnt(0)
    v_cvt_pk_bf16_f32 v16, v72, v72
    v_lshlrev_b32 v16, 16, v16
    v_cvt_pk_bf16_f32 v17, v12, v12
    v_lshlrev_b32 v17, 16, v17
    v_max_f32 v16, 0, v16
    v_mul_f32 v12, v16, v17
    v_cvt_pk_bf16_f32 v16, v73, v73
    v_lshlrev_b32 v16, 16, v16
    v_cvt_pk_bf16_f32 v17, v13, v13
    v_lshlrev_b32 v17, 16, v17
    v_max_f32 v16, 0, v16
    v_mul_f32 v13, v16, v17
    v_cvt_pk_bf16_f32 v16, v74, v74
    v_lshlrev_b32 v16, 16, v16
    v_cvt_pk_bf16_f32 v17, v14, v14
    v_lshlrev_b32 v17, 16, v17
    v_max_f32 v16, 0, v16
    v_mul_f32 v14, v16, v17
    v_cvt_pk_bf16_f32 v16, v75, v75
    v_lshlrev_b32 v16, 16, v16
    v_cvt_pk_bf16_f32 v17, v15, v15
    v_lshlrev_b32 v17, 16, v17
    v_max_f32 v16, 0, v16
    v_mul_f32 v15, v16, v17
    v_cvt_pk_bf16_f32 v10, v12, v13
    v_cvt_pk_bf16_f32 v11, v14, v15
    global_store_dwordx2 v9, v[10:11], s[22:23] offset:32
    ds_read_b32 v12, v8 offset:3072
    ds_read_b32 v13, v8 offset:3328
    ds_read_b32 v14, v8 offset:3584
    ds_read_b32 v15, v8 offset:3840
    s_waitcnt lgkmcnt(0)
    v_cvt_pk_bf16_f32 v16, v76, v76
    v_lshlrev_b32 v16, 16, v16
    v_cvt_pk_bf16_f32 v17, v12, v12
    v_lshlrev_b32 v17, 16, v17
    v_max_f32 v16, 0, v16
    v_mul_f32 v12, v16, v17
    v_cvt_pk_bf16_f32 v16, v77, v77
    v_lshlrev_b32 v16, 16, v16
    v_cvt_pk_bf16_f32 v17, v13, v13
    v_lshlrev_b32 v17, 16, v17
    v_max_f32 v16, 0, v16
    v_mul_f32 v13, v16, v17
    v_cvt_pk_bf16_f32 v16, v78, v78
    v_lshlrev_b32 v16, 16, v16
    v_cvt_pk_bf16_f32 v17, v14, v14
    v_lshlrev_b32 v17, 16, v17
    v_max_f32 v16, 0, v16
    v_mul_f32 v14, v16, v17
    v_cvt_pk_bf16_f32 v16, v79, v79
    v_lshlrev_b32 v16, 16, v16
    v_cvt_pk_bf16_f32 v17, v15, v15
    v_lshlrev_b32 v17, 16, v17
    v_max_f32 v16, 0, v16
    v_mul_f32 v15, v16, v17
    v_cvt_pk_bf16_f32 v10, v12, v13
    v_cvt_pk_bf16_f32 v11, v14, v15
    global_store_dwordx2 v9, v[10:11], s[22:23] offset:48
    ds_read_b32 v12, v8 offset:4096
    ds_read_b32 v13, v8 offset:4352
    ds_read_b32 v14, v8 offset:4608
    ds_read_b32 v15, v8 offset:4864
    s_waitcnt lgkmcnt(0)
    v_cvt_pk_bf16_f32 v16, v80, v80
    v_lshlrev_b32 v16, 16, v16
    v_cvt_pk_bf16_f32 v17, v12, v12
    v_lshlrev_b32 v17, 16, v17
    v_max_f32 v16, 0, v16
    v_mul_f32 v12, v16, v17
    v_cvt_pk_bf16_f32 v16, v81, v81
    v_lshlrev_b32 v16, 16, v16
    v_cvt_pk_bf16_f32 v17, v13, v13
    v_lshlrev_b32 v17, 16, v17
    v_max_f32 v16, 0, v16
    v_mul_f32 v13, v16, v17
    v_cvt_pk_bf16_f32 v16, v82, v82
    v_lshlrev_b32 v16, 16, v16
    v_cvt_pk_bf16_f32 v17, v14, v14
    v_lshlrev_b32 v17, 16, v17
    v_max_f32 v16, 0, v16
    v_mul_f32 v14, v16, v17
    v_cvt_pk_bf16_f32 v16, v83, v83
    v_lshlrev_b32 v16, 16, v16
    v_cvt_pk_bf16_f32 v17, v15, v15
    v_lshlrev_b32 v17, 16, v17
    v_max_f32 v16, 0, v16
    v_mul_f32 v15, v16, v17
    v_cvt_pk_bf16_f32 v10, v12, v13
    v_cvt_pk_bf16_f32 v11, v14, v15
    global_store_dwordx2 v9, v[10:11], s[22:23] offset:64
    ds_read_b32 v12, v8 offset:5120
    ds_read_b32 v13, v8 offset:5376
    ds_read_b32 v14, v8 offset:5632
    ds_read_b32 v15, v8 offset:5888
    s_waitcnt lgkmcnt(0)
    v_cvt_pk_bf16_f32 v16, v84, v84
    v_lshlrev_b32 v16, 16, v16
    v_cvt_pk_bf16_f32 v17, v12, v12
    v_lshlrev_b32 v17, 16, v17
    v_max_f32 v16, 0, v16
    v_mul_f32 v12, v16, v17
    v_cvt_pk_bf16_f32 v16, v85, v85
    v_lshlrev_b32 v16, 16, v16
    v_cvt_pk_bf16_f32 v17, v13, v13
    v_lshlrev_b32 v17, 16, v17
    v_max_f32 v16, 0, v16
    v_mul_f32 v13, v16, v17
    v_cvt_pk_bf16_f32 v16, v86, v86
    v_lshlrev_b32 v16, 16, v16
    v_cvt_pk_bf16_f32 v17, v14, v14
    v_lshlrev_b32 v17, 16, v17
    v_max_f32 v16, 0, v16
    v_mul_f32 v14, v16, v17
    v_cvt_pk_bf16_f32 v16, v87, v87
    v_lshlrev_b32 v16, 16, v16
    v_cvt_pk_bf16_f32 v17, v15, v15
    v_lshlrev_b32 v17, 16, v17
    v_max_f32 v16, 0, v16
    v_mul_f32 v15, v16, v17
    v_cvt_pk_bf16_f32 v10, v12, v13
    v_cvt_pk_bf16_f32 v11, v14, v15
    global_store_dwordx2 v9, v[10:11], s[22:23] offset:80
    ds_read_b32 v12, v8 offset:6144
    ds_read_b32 v13, v8 offset:6400
    ds_read_b32 v14, v8 offset:6656
    ds_read_b32 v15, v8 offset:6912
    s_waitcnt lgkmcnt(0)
    v_cvt_pk_bf16_f32 v16, v88, v88
    v_lshlrev_b32 v16, 16, v16
    v_cvt_pk_bf16_f32 v17, v12, v12
    v_lshlrev_b32 v17, 16, v17
    v_max_f32 v16, 0, v16
    v_mul_f32 v12, v16, v17
    v_cvt_pk_bf16_f32 v16, v89, v89
    v_lshlrev_b32 v16, 16, v16
    v_cvt_pk_bf16_f32 v17, v13, v13
    v_lshlrev_b32 v17, 16, v17
    v_max_f32 v16, 0, v16
    v_mul_f32 v13, v16, v17
    v_cvt_pk_bf16_f32 v16, v90, v90
    v_lshlrev_b32 v16, 16, v16
    v_cvt_pk_bf16_f32 v17, v14, v14
    v_lshlrev_b32 v17, 16, v17
    v_max_f32 v16, 0, v16
    v_mul_f32 v14, v16, v17
    v_cvt_pk_bf16_f32 v16, v91, v91
    v_lshlrev_b32 v16, 16, v16
    v_cvt_pk_bf16_f32 v17, v15, v15
    v_lshlrev_b32 v17, 16, v17
    v_max_f32 v16, 0, v16
    v_mul_f32 v15, v16, v17
    v_cvt_pk_bf16_f32 v10, v12, v13
    v_cvt_pk_bf16_f32 v11, v14, v15
    global_store_dwordx2 v9, v[10:11], s[22:23] offset:96
    ds_read_b32 v12, v8 offset:7168
    ds_read_b32 v13, v8 offset:7424
    ds_read_b32 v14, v8 offset:7680
    ds_read_b32 v15, v8 offset:7936
    s_waitcnt lgkmcnt(0)
    v_cvt_pk_bf16_f32 v16, v92, v92
    v_lshlrev_b32 v16, 16, v16
    v_cvt_pk_bf16_f32 v17, v12, v12
    v_lshlrev_b32 v17, 16, v17
    v_max_f32 v16, 0, v16
    v_mul_f32 v12, v16, v17
    v_cvt_pk_bf16_f32 v16, v93, v93
    v_lshlrev_b32 v16, 16, v16
    v_cvt_pk_bf16_f32 v17, v13, v13
    v_lshlrev_b32 v17, 16, v17
    v_max_f32 v16, 0, v16
    v_mul_f32 v13, v16, v17
    v_cvt_pk_bf16_f32 v16, v94, v94
    v_lshlrev_b32 v16, 16, v16
    v_cvt_pk_bf16_f32 v17, v14, v14
    v_lshlrev_b32 v17, 16, v17
    v_max_f32 v16, 0, v16
    v_mul_f32 v14, v16, v17
    v_cvt_pk_bf16_f32 v16, v95, v95
    v_lshlrev_b32 v16, 16, v16
    v_cvt_pk_bf16_f32 v17, v15, v15
    v_lshlrev_b32 v17, 16, v17
    v_max_f32 v16, 0, v16
    v_mul_f32 v15, v16, v17
    v_cvt_pk_bf16_f32 v10, v12, v13
    v_cvt_pk_bf16_f32 v11, v14, v15
    global_store_dwordx2 v9, v[10:11], s[22:23] offset:112
    ds_read_b32 v12, v8 offset:8192
    ds_read_b32 v13, v8 offset:8448
    ds_read_b32 v14, v8 offset:8704
    ds_read_b32 v15, v8 offset:8960
    s_waitcnt lgkmcnt(0)
    v_cvt_pk_bf16_f32 v16, v96, v96
    v_lshlrev_b32 v16, 16, v16
    v_cvt_pk_bf16_f32 v17, v12, v12
    v_lshlrev_b32 v17, 16, v17
    v_max_f32 v16, 0, v16
    v_mul_f32 v12, v16, v17
    v_cvt_pk_bf16_f32 v16, v97, v97
    v_lshlrev_b32 v16, 16, v16
    v_cvt_pk_bf16_f32 v17, v13, v13
    v_lshlrev_b32 v17, 16, v17
    v_max_f32 v16, 0, v16
    v_mul_f32 v13, v16, v17
    v_cvt_pk_bf16_f32 v16, v98, v98
    v_lshlrev_b32 v16, 16, v16
    v_cvt_pk_bf16_f32 v17, v14, v14
    v_lshlrev_b32 v17, 16, v17
    v_max_f32 v16, 0, v16
    v_mul_f32 v14, v16, v17
    v_cvt_pk_bf16_f32 v16, v99, v99
    v_lshlrev_b32 v16, 16, v16
    v_cvt_pk_bf16_f32 v17, v15, v15
    v_lshlrev_b32 v17, 16, v17
    v_max_f32 v16, 0, v16
    v_mul_f32 v15, v16, v17
    v_cvt_pk_bf16_f32 v10, v12, v13
    v_cvt_pk_bf16_f32 v11, v14, v15
    v_add_u32 v18, 294912, v9
    global_store_dwordx2 v18, v[10:11], s[22:23] offset:0
    ds_read_b32 v12, v8 offset:9216
    ds_read_b32 v13, v8 offset:9472
    ds_read_b32 v14, v8 offset:9728
    ds_read_b32 v15, v8 offset:9984
    s_waitcnt lgkmcnt(0)
    v_cvt_pk_bf16_f32 v16, v100, v100
    v_lshlrev_b32 v16, 16, v16
    v_cvt_pk_bf16_f32 v17, v12, v12
    v_lshlrev_b32 v17, 16, v17
    v_max_f32 v16, 0, v16
    v_mul_f32 v12, v16, v17
    v_cvt_pk_bf16_f32 v16, v101, v101
    v_lshlrev_b32 v16, 16, v16
    v_cvt_pk_bf16_f32 v17, v13, v13
    v_lshlrev_b32 v17, 16, v17
    v_max_f32 v16, 0, v16
    v_mul_f32 v13, v16, v17
    v_cvt_pk_bf16_f32 v16, v102, v102
    v_lshlrev_b32 v16, 16, v16
    v_cvt_pk_bf16_f32 v17, v14, v14
    v_lshlrev_b32 v17, 16, v17
    v_max_f32 v16, 0, v16
    v_mul_f32 v14, v16, v17
    v_cvt_pk_bf16_f32 v16, v103, v103
    v_lshlrev_b32 v16, 16, v16
    v_cvt_pk_bf16_f32 v17, v15, v15
    v_lshlrev_b32 v17, 16, v17
    v_max_f32 v16, 0, v16
    v_mul_f32 v15, v16, v17
    v_cvt_pk_bf16_f32 v10, v12, v13
    v_cvt_pk_bf16_f32 v11, v14, v15
    v_add_u32 v18, 294912, v9
    global_store_dwordx2 v18, v[10:11], s[22:23] offset:16
    ds_read_b32 v12, v8 offset:10240
    ds_read_b32 v13, v8 offset:10496
    ds_read_b32 v14, v8 offset:10752
    ds_read_b32 v15, v8 offset:11008
    s_waitcnt lgkmcnt(0)
    v_cvt_pk_bf16_f32 v16, v104, v104
    v_lshlrev_b32 v16, 16, v16
    v_cvt_pk_bf16_f32 v17, v12, v12
    v_lshlrev_b32 v17, 16, v17
    v_max_f32 v16, 0, v16
    v_mul_f32 v12, v16, v17
    v_cvt_pk_bf16_f32 v16, v105, v105
    v_lshlrev_b32 v16, 16, v16
    v_cvt_pk_bf16_f32 v17, v13, v13
    v_lshlrev_b32 v17, 16, v17
    v_max_f32 v16, 0, v16
    v_mul_f32 v13, v16, v17
    v_cvt_pk_bf16_f32 v16, v106, v106
    v_lshlrev_b32 v16, 16, v16
    v_cvt_pk_bf16_f32 v17, v14, v14
    v_lshlrev_b32 v17, 16, v17
    v_max_f32 v16, 0, v16
    v_mul_f32 v14, v16, v17
    v_cvt_pk_bf16_f32 v16, v107, v107
    v_lshlrev_b32 v16, 16, v16
    v_cvt_pk_bf16_f32 v17, v15, v15
    v_lshlrev_b32 v17, 16, v17
    v_max_f32 v16, 0, v16
    v_mul_f32 v15, v16, v17
    v_cvt_pk_bf16_f32 v10, v12, v13
    v_cvt_pk_bf16_f32 v11, v14, v15
    v_add_u32 v18, 294912, v9
    global_store_dwordx2 v18, v[10:11], s[22:23] offset:32
    ds_read_b32 v12, v8 offset:11264
    ds_read_b32 v13, v8 offset:11520
    ds_read_b32 v14, v8 offset:11776
    ds_read_b32 v15, v8 offset:12032
    s_waitcnt lgkmcnt(0)
    v_cvt_pk_bf16_f32 v16, v108, v108
    v_lshlrev_b32 v16, 16, v16
    v_cvt_pk_bf16_f32 v17, v12, v12
    v_lshlrev_b32 v17, 16, v17
    v_max_f32 v16, 0, v16
    v_mul_f32 v12, v16, v17
    v_cvt_pk_bf16_f32 v16, v109, v109
    v_lshlrev_b32 v16, 16, v16
    v_cvt_pk_bf16_f32 v17, v13, v13
    v_lshlrev_b32 v17, 16, v17
    v_max_f32 v16, 0, v16
    v_mul_f32 v13, v16, v17
    v_cvt_pk_bf16_f32 v16, v110, v110
    v_lshlrev_b32 v16, 16, v16
    v_cvt_pk_bf16_f32 v17, v14, v14
    v_lshlrev_b32 v17, 16, v17
    v_max_f32 v16, 0, v16
    v_mul_f32 v14, v16, v17
    v_cvt_pk_bf16_f32 v16, v111, v111
    v_lshlrev_b32 v16, 16, v16
    v_cvt_pk_bf16_f32 v17, v15, v15
    v_lshlrev_b32 v17, 16, v17
    v_max_f32 v16, 0, v16
    v_mul_f32 v15, v16, v17
    v_cvt_pk_bf16_f32 v10, v12, v13
    v_cvt_pk_bf16_f32 v11, v14, v15
    v_add_u32 v18, 294912, v9
    global_store_dwordx2 v18, v[10:11], s[22:23] offset:48
    ds_read_b32 v12, v8 offset:12288
    ds_read_b32 v13, v8 offset:12544
    ds_read_b32 v14, v8 offset:12800
    ds_read_b32 v15, v8 offset:13056
    s_waitcnt lgkmcnt(0)
    v_cvt_pk_bf16_f32 v16, v112, v112
    v_lshlrev_b32 v16, 16, v16
    v_cvt_pk_bf16_f32 v17, v12, v12
    v_lshlrev_b32 v17, 16, v17
    v_max_f32 v16, 0, v16
    v_mul_f32 v12, v16, v17
    v_cvt_pk_bf16_f32 v16, v113, v113
    v_lshlrev_b32 v16, 16, v16
    v_cvt_pk_bf16_f32 v17, v13, v13
    v_lshlrev_b32 v17, 16, v17
    v_max_f32 v16, 0, v16
    v_mul_f32 v13, v16, v17
    v_cvt_pk_bf16_f32 v16, v114, v114
    v_lshlrev_b32 v16, 16, v16
    v_cvt_pk_bf16_f32 v17, v14, v14
    v_lshlrev_b32 v17, 16, v17
    v_max_f32 v16, 0, v16
    v_mul_f32 v14, v16, v17
    v_cvt_pk_bf16_f32 v16, v115, v115
    v_lshlrev_b32 v16, 16, v16
    v_cvt_pk_bf16_f32 v17, v15, v15
    v_lshlrev_b32 v17, 16, v17
    v_max_f32 v16, 0, v16
    v_mul_f32 v15, v16, v17
    v_cvt_pk_bf16_f32 v10, v12, v13
    v_cvt_pk_bf16_f32 v11, v14, v15
    v_add_u32 v18, 294912, v9
    global_store_dwordx2 v18, v[10:11], s[22:23] offset:64
    ds_read_b32 v12, v8 offset:13312
    ds_read_b32 v13, v8 offset:13568
    ds_read_b32 v14, v8 offset:13824
    ds_read_b32 v15, v8 offset:14080
    s_waitcnt lgkmcnt(0)
    v_cvt_pk_bf16_f32 v16, v116, v116
    v_lshlrev_b32 v16, 16, v16
    v_cvt_pk_bf16_f32 v17, v12, v12
    v_lshlrev_b32 v17, 16, v17
    v_max_f32 v16, 0, v16
    v_mul_f32 v12, v16, v17
    v_cvt_pk_bf16_f32 v16, v117, v117
    v_lshlrev_b32 v16, 16, v16
    v_cvt_pk_bf16_f32 v17, v13, v13
    v_lshlrev_b32 v17, 16, v17
    v_max_f32 v16, 0, v16
    v_mul_f32 v13, v16, v17
    v_cvt_pk_bf16_f32 v16, v118, v118
    v_lshlrev_b32 v16, 16, v16
    v_cvt_pk_bf16_f32 v17, v14, v14
    v_lshlrev_b32 v17, 16, v17
    v_max_f32 v16, 0, v16
    v_mul_f32 v14, v16, v17
    v_cvt_pk_bf16_f32 v16, v119, v119
    v_lshlrev_b32 v16, 16, v16
    v_cvt_pk_bf16_f32 v17, v15, v15
    v_lshlrev_b32 v17, 16, v17
    v_max_f32 v16, 0, v16
    v_mul_f32 v15, v16, v17
    v_cvt_pk_bf16_f32 v10, v12, v13
    v_cvt_pk_bf16_f32 v11, v14, v15
    v_add_u32 v18, 294912, v9
    global_store_dwordx2 v18, v[10:11], s[22:23] offset:80
    ds_read_b32 v12, v8 offset:14336
    ds_read_b32 v13, v8 offset:14592
    ds_read_b32 v14, v8 offset:14848
    ds_read_b32 v15, v8 offset:15104
    s_waitcnt lgkmcnt(0)
    v_cvt_pk_bf16_f32 v16, v120, v120
    v_lshlrev_b32 v16, 16, v16
    v_cvt_pk_bf16_f32 v17, v12, v12
    v_lshlrev_b32 v17, 16, v17
    v_max_f32 v16, 0, v16
    v_mul_f32 v12, v16, v17
    v_cvt_pk_bf16_f32 v16, v121, v121
    v_lshlrev_b32 v16, 16, v16
    v_cvt_pk_bf16_f32 v17, v13, v13
    v_lshlrev_b32 v17, 16, v17
    v_max_f32 v16, 0, v16
    v_mul_f32 v13, v16, v17
    v_cvt_pk_bf16_f32 v16, v122, v122
    v_lshlrev_b32 v16, 16, v16
    v_cvt_pk_bf16_f32 v17, v14, v14
    v_lshlrev_b32 v17, 16, v17
    v_max_f32 v16, 0, v16
    v_mul_f32 v14, v16, v17
    v_cvt_pk_bf16_f32 v16, v123, v123
    v_lshlrev_b32 v16, 16, v16
    v_cvt_pk_bf16_f32 v17, v15, v15
    v_lshlrev_b32 v17, 16, v17
    v_max_f32 v16, 0, v16
    v_mul_f32 v15, v16, v17
    v_cvt_pk_bf16_f32 v10, v12, v13
    v_cvt_pk_bf16_f32 v11, v14, v15
    v_add_u32 v18, 294912, v9
    global_store_dwordx2 v18, v[10:11], s[22:23] offset:96
    ds_read_b32 v12, v8 offset:15360
    ds_read_b32 v13, v8 offset:15616
    ds_read_b32 v14, v8 offset:15872
    ds_read_b32 v15, v8 offset:16128
    s_waitcnt lgkmcnt(0)
    v_cvt_pk_bf16_f32 v16, v124, v124
    v_lshlrev_b32 v16, 16, v16
    v_cvt_pk_bf16_f32 v17, v12, v12
    v_lshlrev_b32 v17, 16, v17
    v_max_f32 v16, 0, v16
    v_mul_f32 v12, v16, v17
    v_cvt_pk_bf16_f32 v16, v125, v125
    v_lshlrev_b32 v16, 16, v16
    v_cvt_pk_bf16_f32 v17, v13, v13
    v_lshlrev_b32 v17, 16, v17
    v_max_f32 v16, 0, v16
    v_mul_f32 v13, v16, v17
    v_cvt_pk_bf16_f32 v16, v126, v126
    v_lshlrev_b32 v16, 16, v16
    v_cvt_pk_bf16_f32 v17, v14, v14
    v_lshlrev_b32 v17, 16, v17
    v_max_f32 v16, 0, v16
    v_mul_f32 v14, v16, v17
    v_cvt_pk_bf16_f32 v16, v127, v127
    v_lshlrev_b32 v16, 16, v16
    v_cvt_pk_bf16_f32 v17, v15, v15
    v_lshlrev_b32 v17, 16, v17
    v_max_f32 v16, 0, v16
    v_mul_f32 v15, v16, v17
    v_cvt_pk_bf16_f32 v10, v12, v13
    v_cvt_pk_bf16_f32 v11, v14, v15
    v_add_u32 v18, 294912, v9
    global_store_dwordx2 v18, v[10:11], s[22:23] offset:112
ffn1_kernel_end:
    s_endpgm
.globl ffn2_kernel
.p2align 8
.type ffn2_kernel,@function
ffn2_kernel:
    s_cmp_ge_u32 s2, 80
    s_cbranch_scc1 ffn2_kernel_end
    s_load_dwordx2 s[4:5], s[0:1], 120
    s_load_dwordx2 s[6:7], s[0:1], 120
    s_load_dwordx2 s[8:9], s[0:1], 80
    s_load_dwordx2 s[40:41], s[0:1], 0
    s_load_dwordx2 s[42:43], s[0:1], 104
    s_and_b32 s16, s2, 15
    s_lshr_b32 s17, s2, 4
    s_waitcnt lgkmcnt(0)
    s_add_u32 s6, s6, 84951040
    s_addc_u32 s7, s7, 0
    s_mul_i32 s18, s16, 1179648
    s_add_u32 s6, s6, s18
    s_addc_u32 s7, s7, 0
    s_lshl_b32 s19, s17, 8
    s_add_u32 s8, s8, s19
    s_addc_u32 s9, s9, 0
    v_lshrrev_b32 v1, 6, v0
    v_and_b32 v2, 63, v0
    s_nop 0
    v_readfirstlane_b32 s12, v1
    s_nop 3
    s_lshl_b32 s13, s12, 12
    v_lshrrev_b32 v3, 3, v2
    v_lshrrev_b32 v4, 4, v2
    v_and_b32 v5, 7, v2
    v_lshlrev_b32 v6, 5, v1
    s_mov_b32 s20, 9216
    v_add_u32 v7, 0, v4
    v_and_b32 v7, 7, v7
    v_xor_b32 v7, v5, v7
    v_add_u32 v8, 0, v3
    v_add_u32 v8, v8, v6
    v_mul_lo_u32 v8, v8, s20
    v_lshl_add_u32 v8, v7, 4, v8
    v_add_u32 v7, 4, v4
    v_and_b32 v7, 7, v7
    v_xor_b32 v7, v5, v7
    v_add_u32 v9, 8, v3
    v_add_u32 v9, v9, v6
    v_mul_lo_u32 v9, v9, s20
    v_lshl_add_u32 v9, v7, 4, v9
    v_add_u32 v7, 8, v4
    v_and_b32 v7, 7, v7
    v_xor_b32 v7, v5, v7
    v_add_u32 v10, 16, v3
    v_add_u32 v10, v10, v6
    v_mul_lo_u32 v10, v10, s20
    v_lshl_add_u32 v10, v7, 4, v10
    v_add_u32 v7, 12, v4
    v_and_b32 v7, 7, v7
    v_xor_b32 v7, v5, v7
    v_add_u32 v11, 24, v3
    v_add_u32 v11, v11, v6
    v_mul_lo_u32 v11, v11, s20
    v_lshl_add_u32 v11, v7, 4, v11
    v_and_b32 v5, 15, v2
    v_lshrrev_b32 v7, 2, v5
    v_xor_b32 v7, v7, v4
    v_and_b32 v5, 3, v5
    v_lshl_add_u32 v7, v7, 2, v5
    v_lshlrev_b32 v6, 4, v1
    s_mov_b32 s20, 1152
    v_add_u32 v3, 0, v4
    v_add_u32 v3, v3, v6
    v_mul_lo_u32 v3, v3, s20
    s_lshl_b32 s19, s17, 4
    v_add_u32 v5, s19, v7
    v_cmp_le_u32 vcc, 72, v5
    v_subrev_u32 v5, 8, v7
    v_cndmask_b32 v5, v7, v5, vcc
    v_lshl_add_u32 v3, v5, 4, v3
    v_mov_b32 v21, s9
    v_add_co_u32 v12, vcc, s8, v3
    v_addc_co_u32 v13, vcc, 0, v21, vcc
    v_add_u32 v3, 4, v4
    v_add_u32 v3, v3, v6
    v_mul_lo_u32 v3, v3, s20
    s_lshl_b32 s19, s17, 4
    v_add_u32 v5, s19, v7
    v_cmp_le_u32 vcc, 72, v5
    v_subrev_u32 v5, 8, v7
    v_cndmask_b32 v5, v7, v5, vcc
    v_lshl_add_u32 v3, v5, 4, v3
    v_mov_b32 v21, s9
    v_add_co_u32 v14, vcc, s8, v3
    v_addc_co_u32 v15, vcc, 0, v21, vcc
    v_add_u32 v3, 8, v4
    v_add_u32 v3, v3, v6
    v_mul_lo_u32 v3, v3, s20
    s_lshl_b32 s19, s17, 4
    v_add_u32 v5, s19, v7
    v_cmp_le_u32 vcc, 72, v5
    v_subrev_u32 v5, 8, v7
    v_cndmask_b32 v5, v7, v5, vcc
    v_lshl_add_u32 v3, v5, 4, v3
    v_mov_b32 v21, s9
    v_add_co_u32 v16, vcc, s8, v3
    v_addc_co_u32 v17, vcc, 0, v21, vcc
    v_add_u32 v3, 12, v4
    v_add_u32 v3, v3, v6
    v_mul_lo_u32 v3, v3, s20
    s_lshl_b32 s19, s17, 4
    v_add_u32 v5, s19, v7
    v_cmp_le_u32 vcc, 72, v5
    v_subrev_u32 v5, 8, v7
    v_cndmask_b32 v5, v7, v5, vcc
    v_lshl_add_u32 v3, v5, 4, v3
    v_mov_b32 v21, s9
    v_add_co_u32 v18, vcc, s8, v3
    v_addc_co_u32 v19, vcc, 0, v21, vcc
    v_and_b32 v3, 31, v2
    v_lshrrev_b32 v4, 5, v2
    v_and_b32 v5, 1, v1
    v_lshl_add_u32 v6, v5, 6, v3
    v_lshrrev_b32 v7, 1, v3
    v_and_b32 v7, 7, v7
    v_add_u32 v26, 0, v4
    v_xor_b32 v26, v26, v7
    v_lshlrev_b32 v26, 4, v26
    v_lshl_add_u32 v20, v6, 7, v26
    v_add_u32 v26, 2, v4
    v_xor_b32 v26, v26, v7
    v_lshlrev_b32 v26, 4, v26
    v_lshl_add_u32 v21, v6, 7, v26
    v_add_u32 v26, 4, v4
    v_xor_b32 v26, v26, v7
    v_lshlrev_b32 v26, 4, v26
    v_lshl_add_u32 v22, v6, 7, v26
    v_add_u32 v26, 6, v4
    v_xor_b32 v26, v26, v7
    v_lshlrev_b32 v26, 4, v26
    v_lshl_add_u32 v23, v6, 7, v26
    v_lshrrev_b32 v5, 1, v1
    v_and_b32 v6, 15, v2
    v_lshrrev_b32 v7, 2, v6
    v_lshl_add_u32 v26, v4, 3, v7
    v_lshrrev_b32 v27, 4, v2
    v_and_b32 v27, 1, v27
    v_and_b32 v28, 3, v2
    v_lshlrev_b32 v28, 3, v28
    v_lshl_add_u32 v28, v27, 5, v28
    v_lshl_add_u32 v29, v5, 1, 0
    v_xor_b32 v29, v29, v7
    v_lshl_add_u32 v29, v29, 6, v28
    v_lshl_add_u32 v24, v26, 8, v29
    v_add_u32 v24, 16384, v24
    v_lshl_add_u32 v29, v5, 1, 1
    v_xor_b32 v29, v29, v7
    v_lshl_add_u32 v29, v29, 6, v28
    v_lshl_add_u32 v25, v26, 8, v29
    v_add_u32 v25, 16384, v25
    v_mov_b32 v64, 0
    v_mov_b32 v65, 0
    v_mov_b32 v66, 0
    v_mov_b32 v67, 0
    v_mov_b32 v68, 0
    v_mov_b32 v69, 0
    v_mov_b32 v70, 0
    v_mov_b32 v71, 0
    v_mov_b32 v72, 0
    v_mov_b32 v73, 0
    v_mov_b32 v74, 0
    v_mov_b32 v75, 0
    v_mov_b32 v76, 0
    v_mov_b32 v77, 0
    v_mov_b32 v78, 0
    v_mov_b32 v79, 0
    v_mov_b32 v80, 0
    v_mov_b32 v81, 0
    v_mov_b32 v82, 0
    v_mov_b32 v83, 0
    v_mov_b32 v84, 0
    v_mov_b32 v85, 0
    v_mov_b32 v86, 0
    v_mov_b32 v87, 0
    v_mov_b32 v88, 0
    v_mov_b32 v89, 0
    v_mov_b32 v90, 0
    v_mov_b32 v91, 0
    v_mov_b32 v92, 0
    v_mov_b32 v93, 0
    v_mov_b32 v94, 0
    v_mov_b32 v95, 0
    v_mov_b32 v96, 0
    v_mov_b32 v97, 0
    v_mov_b32 v98, 0
    v_mov_b32 v99, 0
    v_mov_b32 v100, 0
    v_mov_b32 v101, 0
    v_mov_b32 v102, 0
    v_mov_b32 v103, 0
    v_mov_b32 v104, 0
    v_mov_b32 v105, 0
    v_mov_b32 v106, 0
    v_mov_b32 v107, 0
    v_mov_b32 v108, 0
    v_mov_b32 v109, 0
    v_mov_b32 v110, 0
    v_mov_b32 v111, 0
    v_mov_b32 v112, 0
    v_mov_b32 v113, 0
    v_mov_b32 v114, 0
    v_mov_b32 v115, 0
    v_mov_b32 v116, 0
    v_mov_b32 v117, 0
    v_mov_b32 v118, 0
    v_mov_b32 v119, 0
    v_mov_b32 v120, 0
    v_mov_b32 v121, 0
    v_mov_b32 v122, 0
    v_mov_b32 v123, 0
    v_mov_b32 v124, 0
    v_mov_b32 v125, 0
    v_mov_b32 v126, 0
    v_mov_b32 v127, 0
    s_add_u32 m0, s13, 0
    s_nop 0
    global_load_lds_dwordx4 v8, s[6:7]
    s_add_u32 m0, s13, 1024
    s_nop 0
    global_load_lds_dwordx4 v9, s[6:7]
    s_add_u32 m0, s13, 2048
    s_nop 0
    global_load_lds_dwordx4 v10, s[6:7]
    s_add_u32 m0, s13, 3072
    s_nop 0
    global_load_lds_dwordx4 v11, s[6:7]
    s_add_u32 m0, s13, 16384
    s_nop 0
    global_load_lds_dwordx4 v[12:13], off
    s_add_u32 m0, s13, 17408
    s_nop 0
    global_load_lds_dwordx4 v[14:15], off
    s_add_u32 m0, s13, 18432
    s_nop 0
    global_load_lds_dwordx4 v[16:17], off
    s_add_u32 m0, s13, 19456
    s_nop 0
    global_load_lds_dwordx4 v[18:19], off
    s_add_u32 s6, s6, 128
    s_addc_u32 s7, s7, 0
    v_add_co_u32 v12, vcc, 73728, v12
    v_addc_co_u32 v13, vcc, 0, v13, vcc
    v_add_co_u32 v14, vcc, 73728, v14
    v_addc_co_u32 v15, vcc, 0, v15, vcc
    v_add_co_u32 v16, vcc, 73728, v16
    v_addc_co_u32 v17, vcc, 0, v17, vcc
    v_add_co_u32 v18, vcc, 73728, v18
    v_addc_co_u32 v19, vcc, 0, v19, vcc
    s_mov_b32 s21, 35
ffn2_kernel_loop:
    s_add_u32 m0, s13, 32768
    s_nop 0
    global_load_lds_dwordx4 v8, s[6:7]
    s_add_u32 m0, s13, 33792
    s_nop 0
    global_load_lds_dwordx4 v9, s[6:7]
    s_add_u32 m0, s13, 34816
    s_nop 0
    global_load_lds_dwordx4 v10, s[6:7]
    s_add_u32 m0, s13, 35840
    s_nop 0
    global_load_lds_dwordx4 v11, s[6:7]
    s_add_u32 m0, s13, 49152
    s_nop 0
    global_load_lds_dwordx4 v[12:13], off
    s_add_u32 m0, s13, 50176
    s_nop 0
    global_load_lds_dwordx4 v[14:15], off
    s_add_u32 m0, s13, 51200
    s_nop 0
    global_load_lds_dwordx4 v[16:17], off
    s_add_u32 m0, s13, 52224
    s_nop 0
    global_load_lds_dwordx4 v[18:19], off
    s_add_u32 s6, s6, 128
    s_addc_u32 s7, s7, 0
    v_add_co_u32 v12, vcc, 73728, v12
    v_addc_co_u32 v13, vcc, 0, v13, vcc
    v_add_co_u32 v14, vcc, 73728, v14
    v_addc_co_u32 v15, vcc, 0, v15, vcc
    v_add_co_u32 v16, vcc, 73728, v16
    v_addc_co_u32 v17, vcc, 0, v17, vcc
    v_add_co_u32 v18, vcc, 73728, v18
    v_addc_co_u32 v19, vcc, 0, v19, vcc
    s_waitcnt vmcnt(8)
    s_barrier
    ds_read_b128 v[32:35], v20 offset:0
    ds_read_b128 v[36:39], v20 offset:4096
    ds_read_b64_tr_b16 v[40:41], v24 offset:0
    ds_read_b64_tr_b16 v[42:43], v24 offset:1024
    ds_read_b64_tr_b16 v[44:45], v25 offset:0
    ds_read_b64_tr_b16 v[46:47], v25 offset:1024
    ds_read_b128 v[48:51], v21 offset:0
    ds_read_b128 v[52:55], v21 offset:4096
    ds_read_b64_tr_b16 v[56:57], v24 offset:4096
    ds_read_b64_tr_b16 v[58:59], v24 offset:5120
    ds_read_b64_tr_b16 v[60:61], v25 offset:4096
    ds_read_b64_tr_b16 v[62:63], v25 offset:5120
    s_waitcnt lgkmcnt(6)
    v_mfma_f32_32x32x16_bf16 v[64:79], v[40:43], v[32:35], v[64:79]
    v_mfma_f32_32x32x16_bf16 v[80:95], v[44:47], v[32:35], v[80:95]
    v_mfma_f32_32x32x16_bf16 v[96:111], v[40:43], v[36:39], v[96:111]
    v_mfma_f32_32x32x16_bf16 v[112:127], v[44:47], v[36:39], v[112:127]
    ds_read_b128 v[32:35], v22 offset:0
    ds_read_b128 v[36:39], v22 offset:4096
    ds_read_b64_tr_b16 v[40:41], v24 offset:8192
    ds_read_b64_tr_b16 v[42:43], v24 offset:9216
    ds_read_b64_tr_b16 v[44:45], v25 offset:8192
    ds_read_b64_tr_b16 v[46:47], v25 offset:9216
    s_waitcnt lgkmcnt(6)
    v_mfma_f32_32x32x16_bf16 v[64:79], v[56:59], v[48:51], v[64:79]
    v_mfma_f32_32x32x16_bf16 v[80:95], v[60:63], v[48:51], v[80:95]
    v_mfma_f32_32x32x16_bf16 v[96:111], v[56:59], v[52:55], v[96:111]
    v_mfma_f32_32x32x16_bf16 v[112:127], v[60:63], v[52:55], v[112:127]
    ds_read_b128 v[48:51], v23 offset:0
    ds_read_b128 v[52:55], v23 offset:4096
    ds_read_b64_tr_b16 v[56:57], v24 offset:12288
    ds_read_b64_tr_b16 v[58:59], v24 offset:13312
    ds_read_b64_tr_b16 v[60:61], v25 offset:12288
    ds_read_b64_tr_b16 v[62:63], v25 offset:13312
    s_waitcnt lgkmcnt(6)
    v_mfma_f32_32x32x16_bf16 v[64:79], v[40:43], v[32:35], v[64:79]
    v_mfma_f32_32x32x16_bf16 v[80:95], v[44:47], v[32:35], v[80:95]
    v_mfma_f32_32x32x16_bf16 v[96:111], v[40:43], v[36:39], v[96:111]
    v_mfma_f32_32x32x16_bf16 v[112:127], v[44:47], v[36:39], v[112:127]
    s_waitcnt lgkmcnt(0)
    v_mfma_f32_32x32x16_bf16 v[64:79], v[56:59], v[48:51], v[64:79]
    v_mfma_f32_32x32x16_bf16 v[80:95], v[60:63], v[48:51], v[80:95]
    v_mfma_f32_32x32x16_bf16 v[96:111], v[56:59], v[52:55], v[96:111]
    v_mfma_f32_32x32x16_bf16 v[112:127], v[60:63], v[52:55], v[112:127]
    s_barrier
    s_add_u32 m0, s13, 0
    s_nop 0
    global_load_lds_dwordx4 v8, s[6:7]
    s_add_u32 m0, s13, 1024
    s_nop 0
    global_load_lds_dwordx4 v9, s[6:7]
    s_add_u32 m0, s13, 2048
    s_nop 0
    global_load_lds_dwordx4 v10, s[6:7]
    s_add_u32 m0, s13, 3072
    s_nop 0
    global_load_lds_dwordx4 v11, s[6:7]
    s_add_u32 m0, s13, 16384
    s_nop 0
    global_load_lds_dwordx4 v[12:13], off
    s_add_u32 m0, s13, 17408
    s_nop 0
    global_load_lds_dwordx4 v[14:15], off
    s_add_u32 m0, s13, 18432
    s_nop 0
    global_load_lds_dwordx4 v[16:17], off
    s_add_u32 m0, s13, 19456
    s_nop 0
    global_load_lds_dwordx4 v[18:19], off
    s_add_u32 s6, s6, 128
    s_addc_u32 s7, s7, 0
    v_add_co_u32 v12, vcc, 73728, v12
    v_addc_co_u32 v13, vcc, 0, v13, vcc
    v_add_co_u32 v14, vcc, 73728, v14
    v_addc_co_u32 v15, vcc, 0, v15, vcc
    v_add_co_u32 v16, vcc, 73728, v16
    v_addc_co_u32 v17, vcc, 0, v17, vcc
    v_add_co_u32 v18, vcc, 73728, v18
    v_addc_co_u32 v19, vcc, 0, v19, vcc
    s_waitcnt vmcnt(8)
    s_barrier
    ds_read_b128 v[32:35], v20 offset:32768
    ds_read_b128 v[36:39], v20 offset:36864
    ds_read_b64_tr_b16 v[40:41], v24 offset:32768
    ds_read_b64_tr_b16 v[42:43], v24 offset:33792
    ds_read_b64_tr_b16 v[44:45], v25 offset:32768
    ds_read_b64_tr_b16 v[46:47], v25 offset:33792
    ds_read_b128 v[48:51], v21 offset:32768
    ds_read_b128 v[52:55], v21 offset:36864
    ds_read_b64_tr_b16 v[56:57], v24 offset:36864
    ds_read_b64_tr_b16 v[58:59], v24 offset:37888
    ds_read_b64_tr_b16 v[60:61], v25 offset:36864
    ds_read_b64_tr_b16 v[62:63], v25 offset:37888
    s_waitcnt lgkmcnt(6)
    v_mfma_f32_32x32x16_bf16 v[64:79], v[40:43], v[32:35], v[64:79]
    v_mfma_f32_32x32x16_bf16 v[80:95], v[44:47], v[32:35], v[80:95]
    v_mfma_f32_32x32x16_bf16 v[96:111], v[40:43], v[36:39], v[96:111]
    v_mfma_f32_32x32x16_bf16 v[112:127], v[44:47], v[36:39], v[112:127]
    ds_read_b128 v[32:35], v22 offset:32768
    ds_read_b128 v[36:39], v22 offset:36864
    ds_read_b64_tr_b16 v[40:41], v24 offset:40960
    ds_read_b64_tr_b16 v[42:43], v24 offset:41984
    ds_read_b64_tr_b16 v[44:45], v25 offset:40960
    ds_read_b64_tr_b16 v[46:47], v25 offset:41984
    s_waitcnt lgkmcnt(6)
    v_mfma_f32_32x32x16_bf16 v[64:79], v[56:59], v[48:51], v[64:79]
    v_mfma_f32_32x32x16_bf16 v[80:95], v[60:63], v[48:51], v[80:95]
    v_mfma_f32_32x32x16_bf16 v[96:111], v[56:59], v[52:55], v[96:111]
    v_mfma_f32_32x32x16_bf16 v[112:127], v[60:63], v[52:55], v[112:127]
    ds_read_b128 v[48:51], v23 offset:32768
    ds_read_b128 v[52:55], v23 offset:36864
    ds_read_b64_tr_b16 v[56:57], v24 offset:45056
    ds_read_b64_tr_b16 v[58:59], v24 offset:46080
    ds_read_b64_tr_b16 v[60:61], v25 offset:45056
    ds_read_b64_tr_b16 v[62:63], v25 offset:46080
    s_waitcnt lgkmcnt(6)
    v_mfma_f32_32x32x16_bf16 v[64:79], v[40:43], v[32:35], v[64:79]
    v_mfma_f32_32x32x16_bf16 v[80:95], v[44:47], v[32:35], v[80:95]
    v_mfma_f32_32x32x16_bf16 v[96:111], v[40:43], v[36:39], v[96:111]
    v_mfma_f32_32x32x16_bf16 v[112:127], v[44:47], v[36:39], v[112:127]
    s_waitcnt lgkmcnt(0)
    v_mfma_f32_32x32x16_bf16 v[64:79], v[56:59], v[48:51], v[64:79]
    v_mfma_f32_32x32x16_bf16 v[80:95], v[60:63], v[48:51], v[80:95]
    v_mfma_f32_32x32x16_bf16 v[96:111], v[56:59], v[52:55], v[96:111]
    v_mfma_f32_32x32x16_bf16 v[112:127], v[60:63], v[52:55], v[112:127]
    s_barrier
    s_sub_u32 s21, s21, 1
    s_cmp_lg_u32 s21, 0
    s_cbranch_scc1 ffn2_kernel_loop
    s_add_u32 m0, s13, 32768
    s_nop 0
    global_load_lds_dwordx4 v8, s[6:7]
    s_add_u32 m0, s13, 33792
    s_nop 0
    global_load_lds_dwordx4 v9, s[6:7]
    s_add_u32 m0, s13, 34816
    s_nop 0
    global_load_lds_dwordx4 v10, s[6:7]
    s_add_u32 m0, s13, 35840
    s_nop 0
    global_load_lds_dwordx4 v11, s[6:7]
    s_add_u32 m0, s13, 49152
    s_nop 0
    global_load_lds_dwordx4 v[12:13], off
    s_add_u32 m0, s13, 50176
    s_nop 0
    global_load_lds_dwordx4 v[14:15], off
    s_add_u32 m0, s13, 51200
    s_nop 0
    global_load_lds_dwordx4 v[16:17], off
    s_add_u32 m0, s13, 52224
    s_nop 0
    global_load_lds_dwordx4 v[18:19], off
    s_add_u32 s6, s6, 128
    s_addc_u32 s7, s7, 0
    v_add_co_u32 v12, vcc, 73728, v12
    v_addc_co_u32 v13, vcc, 0, v13, vcc
    v_add_co_u32 v14, vcc, 73728, v14
    v_addc_co_u32 v15, vcc, 0, v15, vcc
    v_add_co_u32 v16, vcc, 73728, v16
    v_addc_co_u32 v17, vcc, 0, v17, vcc
    v_add_co_u32 v18, vcc, 73728, v18
    v_addc_co_u32 v19, vcc, 0, v19, vcc
    s_waitcnt vmcnt(8)
    s_barrier
    ds_read_b128 v[32:35], v20 offset:0
    ds_read_b128 v[36:39], v20 offset:4096
    ds_read_b64_tr_b16 v[40:41], v24 offset:0
    ds_read_b64_tr_b16 v[42:43], v24 offset:1024
    ds_read_b64_tr_b16 v[44:45], v25 offset:0
    ds_read_b64_tr_b16 v[46:47], v25 offset:1024
    ds_read_b128 v[48:51], v21 offset:0
    ds_read_b128 v[52:55], v21 offset:4096
    ds_read_b64_tr_b16 v[56:57], v24 offset:4096
    ds_read_b64_tr_b16 v[58:59], v24 offset:5120
    ds_read_b64_tr_b16 v[60:61], v25 offset:4096
    ds_read_b64_tr_b16 v[62:63], v25 offset:5120
    s_waitcnt lgkmcnt(6)
    v_mfma_f32_32x32x16_bf16 v[64:79], v[40:43], v[32:35], v[64:79]
    v_mfma_f32_32x32x16_bf16 v[80:95], v[44:47], v[32:35], v[80:95]
    v_mfma_f32_32x32x16_bf16 v[96:111], v[40:43], v[36:39], v[96:111]
    v_mfma_f32_32x32x16_bf16 v[112:127], v[44:47], v[36:39], v[112:127]
    ds_read_b128 v[32:35], v22 offset:0
    ds_read_b128 v[36:39], v22 offset:4096
    ds_read_b64_tr_b16 v[40:41], v24 offset:8192
    ds_read_b64_tr_b16 v[42:43], v24 offset:9216
    ds_read_b64_tr_b16 v[44:45], v25 offset:8192
    ds_read_b64_tr_b16 v[46:47], v25 offset:9216
    s_waitcnt lgkmcnt(6)
    v_mfma_f32_32x32x16_bf16 v[64:79], v[56:59], v[48:51], v[64:79]
    v_mfma_f32_32x32x16_bf16 v[80:95], v[60:63], v[48:51], v[80:95]
    v_mfma_f32_32x32x16_bf16 v[96:111], v[56:59], v[52:55], v[96:111]
    v_mfma_f32_32x32x16_bf16 v[112:127], v[60:63], v[52:55], v[112:127]
    ds_read_b128 v[48:51], v23 offset:0
    ds_read_b128 v[52:55], v23 offset:4096
    ds_read_b64_tr_b16 v[56:57], v24 offset:12288
    ds_read_b64_tr_b16 v[58:59], v24 offset:13312
    ds_read_b64_tr_b16 v[60:61], v25 offset:12288
    ds_read_b64_tr_b16 v[62:63], v25 offset:13312
    s_waitcnt lgkmcnt(6)
    v_mfma_f32_32x32x16_bf16 v[64:79], v[40:43], v[32:35], v[64:79]
    v_mfma_f32_32x32x16_bf16 v[80:95], v[44:47], v[32:35], v[80:95]
    v_mfma_f32_32x32x16_bf16 v[96:111], v[40:43], v[36:39], v[96:111]
    v_mfma_f32_32x32x16_bf16 v[112:127], v[44:47], v[36:39], v[112:127]
    s_waitcnt lgkmcnt(0)
    v_mfma_f32_32x32x16_bf16 v[64:79], v[56:59], v[48:51], v[64:79]
    v_mfma_f32_32x32x16_bf16 v[80:95], v[60:63], v[48:51], v[80:95]
    v_mfma_f32_32x32x16_bf16 v[96:111], v[56:59], v[52:55], v[96:111]
    v_mfma_f32_32x32x16_bf16 v[112:127], v[60:63], v[52:55], v[112:127]
    s_barrier
    s_waitcnt vmcnt(0)
    s_barrier
    ds_read_b128 v[32:35], v20 offset:32768
    ds_read_b128 v[36:39], v20 offset:36864
    ds_read_b64_tr_b16 v[40:41], v24 offset:32768
    ds_read_b64_tr_b16 v[42:43], v24 offset:33792
    ds_read_b64_tr_b16 v[44:45], v25 offset:32768
    ds_read_b64_tr_b16 v[46:47], v25 offset:33792
    ds_read_b128 v[48:51], v21 offset:32768
    ds_read_b128 v[52:55], v21 offset:36864
    ds_read_b64_tr_b16 v[56:57], v24 offset:36864
    ds_read_b64_tr_b16 v[58:59], v24 offset:37888
    ds_read_b64_tr_b16 v[60:61], v25 offset:36864
    ds_read_b64_tr_b16 v[62:63], v25 offset:37888
    s_waitcnt lgkmcnt(6)
    v_mfma_f32_32x32x16_bf16 v[64:79], v[40:43], v[32:35], v[64:79]
    v_mfma_f32_32x32x16_bf16 v[80:95], v[44:47], v[32:35], v[80:95]
    v_mfma_f32_32x32x16_bf16 v[96:111], v[40:43], v[36:39], v[96:111]
    v_mfma_f32_32x32x16_bf16 v[112:127], v[44:47], v[36:39], v[112:127]
    ds_read_b128 v[32:35], v22 offset:32768
    ds_read_b128 v[36:39], v22 offset:36864
    ds_read_b64_tr_b16 v[40:41], v24 offset:40960
    ds_read_b64_tr_b16 v[42:43], v24 offset:41984
    ds_read_b64_tr_b16 v[44:45], v25 offset:40960
    ds_read_b64_tr_b16 v[46:47], v25 offset:41984
    s_waitcnt lgkmcnt(6)
    v_mfma_f32_32x32x16_bf16 v[64:79], v[56:59], v[48:51], v[64:79]
    v_mfma_f32_32x32x16_bf16 v[80:95], v[60:63], v[48:51], v[80:95]
    v_mfma_f32_32x32x16_bf16 v[96:111], v[56:59], v[52:55], v[96:111]
    v_mfma_f32_32x32x16_bf16 v[112:127], v[60:63], v[52:55], v[112:127]
    ds_read_b128 v[48:51], v23 offset:32768
    ds_read_b128 v[52:55], v23 offset:36864
    ds_read_b64_tr_b16 v[56:57], v24 offset:45056
    ds_read_b64_tr_b16 v[58:59], v24 offset:46080
    ds_read_b64_tr_b16 v[60:61], v25 offset:45056
    ds_read_b64_tr_b16 v[62:63], v25 offset:46080
    s_waitcnt lgkmcnt(6)
    v_mfma_f32_32x32x16_bf16 v[64:79], v[40:43], v[32:35], v[64:79]
    v_mfma_f32_32x32x16_bf16 v[80:95], v[44:47], v[32:35], v[80:95]
    v_mfma_f32_32x32x16_bf16 v[96:111], v[40:43], v[36:39], v[96:111]
    v_mfma_f32_32x32x16_bf16 v[112:127], v[44:47], v[36:39], v[112:127]
    s_waitcnt lgkmcnt(0)
    v_mfma_f32_32x32x16_bf16 v[64:79], v[56:59], v[48:51], v[64:79]
    v_mfma_f32_32x32x16_bf16 v[80:95], v[60:63], v[48:51], v[80:95]
    v_mfma_f32_32x32x16_bf16 v[96:111], v[56:59], v[52:55], v[96:111]
    v_mfma_f32_32x32x16_bf16 v[112:127], v[60:63], v[52:55], v[112:127]
    s_barrier
    s_nop 15
    v_and_b32 v3, 31, v2
    v_lshrrev_b32 v4, 5, v2
    v_and_b32 v5, 1, v1
    v_lshrrev_b32 v6, 1, v1
    v_lshl_add_u32 v7, v5, 6, v3
    s_lshl_b32 s18, s16, 7
    v_add_u32 v7, s18, v7
    s_add_u32 s22, s4, 80232448
    s_addc_u32 s23, s5, 0
    s_mov_b32 s26, s42
    s_mov_b32 s27, s43
    s_lshl_b32 s19, s17, 8
    s_add_u32 s22, s22, s19
    s_addc_u32 s23, s23, 0
    s_add_u32 s26, s26, s19
    s_addc_u32 s27, s27, 0
    s_lshl_b32 s19, s17, 9
    s_add_u32 s19, s19, 11520
    s_add_u32 s28, s4, s19
    s_addc_u32 s29, s5, 0
    s_mov_b32 s20, 1152
    v_mul_lo_u32 v9, v7, s20
    v_lshl_add_u32 v9, v6, 7, v9
    v_lshl_add_u32 v9, v4, 3, v9
    v_lshlrev_b32 v19, 8, v6
    v_lshl_add_u32 v19, v4, 4, v19
    s_lshl_b32 s19, s17, 7
    v_lshl_add_u32 v20, v6, 6, s19
    v_cmp_gt_u32 vcc, 576, v20
    s_and_saveexec_b64 s[24:25], vcc
    s_cbranch_execz ffn2_kernel_end
    global_load_dwordx2 v[10:11], v9, s[22:23] offset:0
    global_load_dwordx4 v[12:15], v19, s[28:29] offset:0
    s_waitcnt vmcnt(0)
    v_cvt_pk_bf16_f32 v16, v64, v64
    v_lshlrev_b32 v16, 16, v16
    v_mul_f32 v16, v16, v12
    v_cvt_pk_bf16_f32 v16, v16, v16
    v_lshlrev_b32 v16, 16, v16
    v_lshlrev_b32 v17, 16, v10
    v_add_f32 v12, v16, v17
    v_cvt_pk_bf16_f32 v16, v65, v65
    v_lshlrev_b32 v16, 16, v16
    v_mul_f32 v16, v16, v13
    v_cvt_pk_bf16_f32 v16, v16, v16
    v_lshlrev_b32 v16, 16, v16
    v_and_b32 v17, 0xffff0000, v10
    v_add_f32 v13, v16, v17
    v_cvt_pk_bf16_f32 v16, v66, v66
    v_lshlrev_b32 v16, 16, v16
    v_mul_f32 v16, v16, v14
    v_cvt_pk_bf16_f32 v16, v16, v16
    v_lshlrev_b32 v16, 16, v16
    v_lshlrev_b32 v17, 16, v11
    v_add_f32 v14, v16, v17
    v_cvt_pk_bf16_f32 v16, v67, v67
    v_lshlrev_b32 v16, 16, v16
    v_mul_f32 v16, v16, v15
    v_cvt_pk_bf16_f32 v16, v16, v16
    v_lshlrev_b32 v16, 16, v16
    v_and_b32 v17, 0xffff0000, v11
    v_add_f32 v15, v16, v17
    v_cvt_pk_bf16_f32 v10, v12, v13
    v_cvt_pk_bf16_f32 v11, v14, v15
    global_store_dwordx2 v9, v[10:11], s[26:27] offset:0
    global_load_dwordx2 v[10:11], v9, s[22:23] offset:16
    global_load_dwordx4 v[12:15], v19, s[28:29] offset:32
    s_waitcnt vmcnt(0)
    v_cvt_pk_bf16_f32 v16, v68, v68
    v_lshlrev_b32 v16, 16, v16
    v_mul_f32 v16, v16, v12
    v_cvt_pk_bf16_f32 v16, v16, v16
    v_lshlrev_b32 v16, 16, v16
    v_lshlrev_b32 v17, 16, v10
    v_add_f32 v12, v16, v17
    v_cvt_pk_bf16_f32 v16, v69, v69
    v_lshlrev_b32 v16, 16, v16
    v_mul_f32 v16, v16, v13
    v_cvt_pk_bf16_f32 v16, v16, v16
    v_lshlrev_b32 v16, 16, v16
    v_and_b32 v17, 0xffff0000, v10
    v_add_f32 v13, v16, v17
    v_cvt_pk_bf16_f32 v16, v70, v70
    v_lshlrev_b32 v16, 16, v16
    v_mul_f32 v16, v16, v14
    v_cvt_pk_bf16_f32 v16, v16, v16
    v_lshlrev_b32 v16, 16, v16
    v_lshlrev_b32 v17, 16, v11
    v_add_f32 v14, v16, v17
    v_cvt_pk_bf16_f32 v16, v71, v71
    v_lshlrev_b32 v16, 16, v16
    v_mul_f32 v16, v16, v15
    v_cvt_pk_bf16_f32 v16, v16, v16
    v_lshlrev_b32 v16, 16, v16
    v_and_b32 v17, 0xffff0000, v11
    v_add_f32 v15, v16, v17
    v_cvt_pk_bf16_f32 v10, v12, v13
    v_cvt_pk_bf16_f32 v11, v14, v15
    global_store_dwordx2 v9, v[10:11], s[26:27] offset:16
    global_load_dwordx2 v[10:11], v9, s[22:23] offset:32
    global_load_dwordx4 v[12:15], v19, s[28:29] offset:64
    s_waitcnt vmcnt(0)
    v_cvt_pk_bf16_f32 v16, v72, v72
    v_lshlrev_b32 v16, 16, v16
    v_mul_f32 v16, v16, v12
    v_cvt_pk_bf16_f32 v16, v16, v16
    v_lshlrev_b32 v16, 16, v16
    v_lshlrev_b32 v17, 16, v10
    v_add_f32 v12, v16, v17
    v_cvt_pk_bf16_f32 v16, v73, v73
    v_lshlrev_b32 v16, 16, v16
    v_mul_f32 v16, v16, v13
    v_cvt_pk_bf16_f32 v16, v16, v16
    v_lshlrev_b32 v16, 16, v16
    v_and_b32 v17, 0xffff0000, v10
    v_add_f32 v13, v16, v17
    v_cvt_pk_bf16_f32 v16, v74, v74
    v_lshlrev_b32 v16, 16, v16
    v_mul_f32 v16, v16, v14
    v_cvt_pk_bf16_f32 v16, v16, v16
    v_lshlrev_b32 v16, 16, v16
    v_lshlrev_b32 v17, 16, v11
    v_add_f32 v14, v16, v17
    v_cvt_pk_bf16_f32 v16, v75, v75
    v_lshlrev_b32 v16, 16, v16
    v_mul_f32 v16, v16, v15
    v_cvt_pk_bf16_f32 v16, v16, v16
    v_lshlrev_b32 v16, 16, v16
    v_and_b32 v17, 0xffff0000, v11
    v_add_f32 v15, v16, v17
    v_cvt_pk_bf16_f32 v10, v12, v13
    v_cvt_pk_bf16_f32 v11, v14, v15
    global_store_dwordx2 v9, v[10:11], s[26:27] offset:32
    global_load_dwordx2 v[10:11], v9, s[22:23] offset:48
    global_load_dwordx4 v[12:15], v19, s[28:29] offset:96
    s_waitcnt vmcnt(0)
    v_cvt_pk_bf16_f32 v16, v76, v76
    v_lshlrev_b32 v16, 16, v16
    v_mul_f32 v16, v16, v12
    v_cvt_pk_bf16_f32 v16, v16, v16
    v_lshlrev_b32 v16, 16, v16
    v_lshlrev_b32 v17, 16, v10
    v_add_f32 v12, v16, v17
    v_cvt_pk_bf16_f32 v16, v77, v77
    v_lshlrev_b32 v16, 16, v16
    v_mul_f32 v16, v16, v13
    v_cvt_pk_bf16_f32 v16, v16, v16
    v_lshlrev_b32 v16, 16, v16
    v_and_b32 v17, 0xffff0000, v10
    v_add_f32 v13, v16, v17
    v_cvt_pk_bf16_f32 v16, v78, v78
    v_lshlrev_b32 v16, 16, v16
    v_mul_f32 v16, v16, v14
    v_cvt_pk_bf16_f32 v16, v16, v16
    v_lshlrev_b32 v16, 16, v16
    v_lshlrev_b32 v17, 16, v11
    v_add_f32 v14, v16, v17
    v_cvt_pk_bf16_f32 v16, v79, v79
    v_lshlrev_b32 v16, 16, v16
    v_mul_f32 v16, v16, v15
    v_cvt_pk_bf16_f32 v16, v16, v16
    v_lshlrev_b32 v16, 16, v16
    v_and_b32 v17, 0xffff0000, v11
    v_add_f32 v15, v16, v17
    v_cvt_pk_bf16_f32 v10, v12, v13
    v_cvt_pk_bf16_f32 v11, v14, v15
    global_store_dwordx2 v9, v[10:11], s[26:27] offset:48
    global_load_dwordx2 v[10:11], v9, s[22:23] offset:64
    global_load_dwordx4 v[12:15], v19, s[28:29] offset:128
    s_waitcnt vmcnt(0)
    v_cvt_pk_bf16_f32 v16, v80, v80
    v_lshlrev_b32 v16, 16, v16
    v_mul_f32 v16, v16, v12
    v_cvt_pk_bf16_f32 v16, v16, v16
    v_lshlrev_b32 v16, 16, v16
    v_lshlrev_b32 v17, 16, v10
    v_add_f32 v12, v16, v17
    v_cvt_pk_bf16_f32 v16, v81, v81
    v_lshlrev_b32 v16, 16, v16
    v_mul_f32 v16, v16, v13
    v_cvt_pk_bf16_f32 v16, v16, v16
    v_lshlrev_b32 v16, 16, v16
    v_and_b32 v17, 0xffff0000, v10
    v_add_f32 v13, v16, v17
    v_cvt_pk_bf16_f32 v16, v82, v82
    v_lshlrev_b32 v16, 16, v16
    v_mul_f32 v16, v16, v14
    v_cvt_pk_bf16_f32 v16, v16, v16
    v_lshlrev_b32 v16, 16, v16
    v_lshlrev_b32 v17, 16, v11
    v_add_f32 v14, v16, v17
    v_cvt_pk_bf16_f32 v16, v83, v83
    v_lshlrev_b32 v16, 16, v16
    v_mul_f32 v16, v16, v15
    v_cvt_pk_bf16_f32 v16, v16, v16
    v_lshlrev_b32 v16, 16, v16
    v_and_b32 v17, 0xffff0000, v11
    v_add_f32 v15, v16, v17
    v_cvt_pk_bf16_f32 v10, v12, v13
    v_cvt_pk_bf16_f32 v11, v14, v15
    global_store_dwordx2 v9, v[10:11], s[26:27] offset:64
    global_load_dwordx2 v[10:11], v9, s[22:23] offset:80
    global_load_dwordx4 v[12:15], v19, s[28:29] offset:160
    s_waitcnt vmcnt(0)
    v_cvt_pk_bf16_f32 v16, v84, v84
    v_lshlrev_b32 v16, 16, v16
    v_mul_f32 v16, v16, v12
    v_cvt_pk_bf16_f32 v16, v16, v16
    v_lshlrev_b32 v16, 16, v16
    v_lshlrev_b32 v17, 16, v10
    v_add_f32 v12, v16, v17
    v_cvt_pk_bf16_f32 v16, v85, v85
    v_lshlrev_b32 v16, 16, v16
    v_mul_f32 v16, v16, v13
    v_cvt_pk_bf16_f32 v16, v16, v16
    v_lshlrev_b32 v16, 16, v16
    v_and_b32 v17, 0xffff0000, v10
    v_add_f32 v13, v16, v17
    v_cvt_pk_bf16_f32 v16, v86, v86
    v_lshlrev_b32 v16, 16, v16
    v_mul_f32 v16, v16, v14
    v_cvt_pk_bf16_f32 v16, v16, v16
    v_lshlrev_b32 v16, 16, v16
    v_lshlrev_b32 v17, 16, v11
    v_add_f32 v14, v16, v17
    v_cvt_pk_bf16_f32 v16, v87, v87
    v_lshlrev_b32 v16, 16, v16
    v_mul_f32 v16, v16, v15
    v_cvt_pk_bf16_f32 v16, v16, v16
    v_lshlrev_b32 v16, 16, v16
    v_and_b32 v17, 0xffff0000, v11
    v_add_f32 v15, v16, v17
    v_cvt_pk_bf16_f32 v10, v12, v13
    v_cvt_pk_bf16_f32 v11, v14, v15
    global_store_dwordx2 v9, v[10:11], s[26:27] offset:80
    global_load_dwordx2 v[10:11], v9, s[22:23] offset:96
    global_load_dwordx4 v[12:15], v19, s[28:29] offset:192
    s_waitcnt vmcnt(0)
    v_cvt_pk_bf16_f32 v16, v88, v88
    v_lshlrev_b32 v16, 16, v16
    v_mul_f32 v16, v16, v12
    v_cvt_pk_bf16_f32 v16, v16, v16
    v_lshlrev_b32 v16, 16, v16
    v_lshlrev_b32 v17, 16, v10
    v_add_f32 v12, v16, v17
    v_cvt_pk_bf16_f32 v16, v89, v89
    v_lshlrev_b32 v16, 16, v16
    v_mul_f32 v16, v16, v13
    v_cvt_pk_bf16_f32 v16, v16, v16
    v_lshlrev_b32 v16, 16, v16
    v_and_b32 v17, 0xffff0000, v10
    v_add_f32 v13, v16, v17
    v_cvt_pk_bf16_f32 v16, v90, v90
    v_lshlrev_b32 v16, 16, v16
    v_mul_f32 v16, v16, v14
    v_cvt_pk_bf16_f32 v16, v16, v16
    v_lshlrev_b32 v16, 16, v16
    v_lshlrev_b32 v17, 16, v11
    v_add_f32 v14, v16, v17
    v_cvt_pk_bf16_f32 v16, v91, v91
    v_lshlrev_b32 v16, 16, v16
    v_mul_f32 v16, v16, v15
    v_cvt_pk_bf16_f32 v16, v16, v16
    v_lshlrev_b32 v16, 16, v16
    v_and_b32 v17, 0xffff0000, v11
    v_add_f32 v15, v16, v17
    v_cvt_pk_bf16_f32 v10, v12, v13
    v_cvt_pk_bf16_f32 v11, v14, v15
    global_store_dwordx2 v9, v[10:11], s[26:27] offset:96
    global_load_dwordx2 v[10:11], v9, s[22:23] offset:112
    global_load_dwordx4 v[12:15], v19, s[28:29] offset:224
    s_waitcnt vmcnt(0)
    v_cvt_pk_bf16_f32 v16, v92, v92
    v_lshlrev_b32 v16, 16, v16
    v_mul_f32 v16, v16, v12
    v_cvt_pk_bf16_f32 v16, v16, v16
    v_lshlrev_b32 v16, 16, v16
    v_lshlrev_b32 v17, 16, v10
    v_add_f32 v12, v16, v17
    v_cvt_pk_bf16_f32 v16, v93, v93
    v_lshlrev_b32 v16, 16, v16
    v_mul_f32 v16, v16, v13
    v_cvt_pk_bf16_f32 v16, v16, v16
    v_lshlrev_b32 v16, 16, v16
    v_and_b32 v17, 0xffff0000, v10
    v_add_f32 v13, v16, v17
    v_cvt_pk_bf16_f32 v16, v94, v94
    v_lshlrev_b32 v16, 16, v16
    v_mul_f32 v16, v16, v14
    v_cvt_pk_bf16_f32 v16, v16, v16
    v_lshlrev_b32 v16, 16, v16
    v_lshlrev_b32 v17, 16, v11
    v_add_f32 v14, v16, v17
    v_cvt_pk_bf16_f32 v16, v95, v95
    v_lshlrev_b32 v16, 16, v16
    v_mul_f32 v16, v16, v15
    v_cvt_pk_bf16_f32 v16, v16, v16
    v_lshlrev_b32 v16, 16, v16
    v_and_b32 v17, 0xffff0000, v11
    v_add_f32 v15, v16, v17
    v_cvt_pk_bf16_f32 v10, v12, v13
    v_cvt_pk_bf16_f32 v11, v14, v15
    global_store_dwordx2 v9, v[10:11], s[26:27] offset:112
    v_add_u32 v9, 36864, v9
    global_load_dwordx2 v[10:11], v9, s[22:23] offset:0
    global_load_dwordx4 v[12:15], v19, s[28:29] offset:0
    s_waitcnt vmcnt(0)
    v_cvt_pk_bf16_f32 v16, v96, v96
    v_lshlrev_b32 v16, 16, v16
    v_mul_f32 v16, v16, v12
    v_cvt_pk_bf16_f32 v16, v16, v16
    v_lshlrev_b32 v16, 16, v16
    v_lshlrev_b32 v17, 16, v10
    v_add_f32 v12, v16, v17
    v_cvt_pk_bf16_f32 v16, v97, v97
    v_lshlrev_b32 v16, 16, v16
    v_mul_f32 v16, v16, v13
    v_cvt_pk_bf16_f32 v16, v16, v16
    v_lshlrev_b32 v16, 16, v16
    v_and_b32 v17, 0xffff0000, v10
    v_add_f32 v13, v16, v17
    v_cvt_pk_bf16_f32 v16, v98, v98
    v_lshlrev_b32 v16, 16, v16
    v_mul_f32 v16, v16, v14
    v_cvt_pk_bf16_f32 v16, v16, v16
    v_lshlrev_b32 v16, 16, v16
    v_lshlrev_b32 v17, 16, v11
    v_add_f32 v14, v16, v17
    v_cvt_pk_bf16_f32 v16, v99, v99
    v_lshlrev_b32 v16, 16, v16
    v_mul_f32 v16, v16, v15
    v_cvt_pk_bf16_f32 v16, v16, v16
    v_lshlrev_b32 v16, 16, v16
    v_and_b32 v17, 0xffff0000, v11
    v_add_f32 v15, v16, v17
    v_cvt_pk_bf16_f32 v10, v12, v13
    v_cvt_pk_bf16_f32 v11, v14, v15
    global_store_dwordx2 v9, v[10:11], s[26:27] offset:0
    global_load_dwordx2 v[10:11], v9, s[22:23] offset:16
    global_load_dwordx4 v[12:15], v19, s[28:29] offset:32
    s_waitcnt vmcnt(0)
    v_cvt_pk_bf16_f32 v16, v100, v100
    v_lshlrev_b32 v16, 16, v16
    v_mul_f32 v16, v16, v12
    v_cvt_pk_bf16_f32 v16, v16, v16
    v_lshlrev_b32 v16, 16, v16
    v_lshlrev_b32 v17, 16, v10
    v_add_f32 v12, v16, v17
    v_cvt_pk_bf16_f32 v16, v101, v101
    v_lshlrev_b32 v16, 16, v16
    v_mul_f32 v16, v16, v13
    v_cvt_pk_bf16_f32 v16, v16, v16
    v_lshlrev_b32 v16, 16, v16
    v_and_b32 v17, 0xffff0000, v10
    v_add_f32 v13, v16, v17
    v_cvt_pk_bf16_f32 v16, v102, v102
    v_lshlrev_b32 v16, 16, v16
    v_mul_f32 v16, v16, v14
    v_cvt_pk_bf16_f32 v16, v16, v16
    v_lshlrev_b32 v16, 16, v16
    v_lshlrev_b32 v17, 16, v11
    v_add_f32 v14, v16, v17
    v_cvt_pk_bf16_f32 v16, v103, v103
    v_lshlrev_b32 v16, 16, v16
    v_mul_f32 v16, v16, v15
    v_cvt_pk_bf16_f32 v16, v16, v16
    v_lshlrev_b32 v16, 16, v16
    v_and_b32 v17, 0xffff0000, v11
    v_add_f32 v15, v16, v17
    v_cvt_pk_bf16_f32 v10, v12, v13
    v_cvt_pk_bf16_f32 v11, v14, v15
    global_store_dwordx2 v9, v[10:11], s[26:27] offset:16
    global_load_dwordx2 v[10:11], v9, s[22:23] offset:32
    global_load_dwordx4 v[12:15], v19, s[28:29] offset:64
    s_waitcnt vmcnt(0)
    v_cvt_pk_bf16_f32 v16, v104, v104
    v_lshlrev_b32 v16, 16, v16
    v_mul_f32 v16, v16, v12
    v_cvt_pk_bf16_f32 v16, v16, v16
    v_lshlrev_b32 v16, 16, v16
    v_lshlrev_b32 v17, 16, v10
    v_add_f32 v12, v16, v17
    v_cvt_pk_bf16_f32 v16, v105, v105
    v_lshlrev_b32 v16, 16, v16
    v_mul_f32 v16, v16, v13
    v_cvt_pk_bf16_f32 v16, v16, v16
    v_lshlrev_b32 v16, 16, v16
    v_and_b32 v17, 0xffff0000, v10
    v_add_f32 v13, v16, v17
    v_cvt_pk_bf16_f32 v16, v106, v106
    v_lshlrev_b32 v16, 16, v16
    v_mul_f32 v16, v16, v14
    v_cvt_pk_bf16_f32 v16, v16, v16
    v_lshlrev_b32 v16, 16, v16
    v_lshlrev_b32 v17, 16, v11
    v_add_f32 v14, v16, v17
    v_cvt_pk_bf16_f32 v16, v107, v107
    v_lshlrev_b32 v16, 16, v16
    v_mul_f32 v16, v16, v15
    v_cvt_pk_bf16_f32 v16, v16, v16
    v_lshlrev_b32 v16, 16, v16
    v_and_b32 v17, 0xffff0000, v11
    v_add_f32 v15, v16, v17
    v_cvt_pk_bf16_f32 v10, v12, v13
    v_cvt_pk_bf16_f32 v11, v14, v15
    global_store_dwordx2 v9, v[10:11], s[26:27] offset:32
    global_load_dwordx2 v[10:11], v9, s[22:23] offset:48
    global_load_dwordx4 v[12:15], v19, s[28:29] offset:96
    s_waitcnt vmcnt(0)
    v_cvt_pk_bf16_f32 v16, v108, v108
    v_lshlrev_b32 v16, 16, v16
    v_mul_f32 v16, v16, v12
    v_cvt_pk_bf16_f32 v16, v16, v16
    v_lshlrev_b32 v16, 16, v16
    v_lshlrev_b32 v17, 16, v10
    v_add_f32 v12, v16, v17
    v_cvt_pk_bf16_f32 v16, v109, v109
    v_lshlrev_b32 v16, 16, v16
    v_mul_f32 v16, v16, v13
    v_cvt_pk_bf16_f32 v16, v16, v16
    v_lshlrev_b32 v16, 16, v16
    v_and_b32 v17, 0xffff0000, v10
    v_add_f32 v13, v16, v17
    v_cvt_pk_bf16_f32 v16, v110, v110
    v_lshlrev_b32 v16, 16, v16
    v_mul_f32 v16, v16, v14
    v_cvt_pk_bf16_f32 v16, v16, v16
    v_lshlrev_b32 v16, 16, v16
    v_lshlrev_b32 v17, 16, v11
    v_add_f32 v14, v16, v17
    v_cvt_pk_bf16_f32 v16, v111, v111
    v_lshlrev_b32 v16, 16, v16
    v_mul_f32 v16, v16, v15
    v_cvt_pk_bf16_f32 v16, v16, v16
    v_lshlrev_b32 v16, 16, v16
    v_and_b32 v17, 0xffff0000, v11
    v_add_f32 v15, v16, v17
    v_cvt_pk_bf16_f32 v10, v12, v13
    v_cvt_pk_bf16_f32 v11, v14, v15
    global_store_dwordx2 v9, v[10:11], s[26:27] offset:48
    global_load_dwordx2 v[10:11], v9, s[22:23] offset:64
    global_load_dwordx4 v[12:15], v19, s[28:29] offset:128
    s_waitcnt vmcnt(0)
    v_cvt_pk_bf16_f32 v16, v112, v112
    v_lshlrev_b32 v16, 16, v16
    v_mul_f32 v16, v16, v12
    v_cvt_pk_bf16_f32 v16, v16, v16
    v_lshlrev_b32 v16, 16, v16
    v_lshlrev_b32 v17, 16, v10
    v_add_f32 v12, v16, v17
    v_cvt_pk_bf16_f32 v16, v113, v113
    v_lshlrev_b32 v16, 16, v16
    v_mul_f32 v16, v16, v13
    v_cvt_pk_bf16_f32 v16, v16, v16
    v_lshlrev_b32 v16, 16, v16
    v_and_b32 v17, 0xffff0000, v10
    v_add_f32 v13, v16, v17
    v_cvt_pk_bf16_f32 v16, v114, v114
    v_lshlrev_b32 v16, 16, v16
    v_mul_f32 v16, v16, v14
    v_cvt_pk_bf16_f32 v16, v16, v16
    v_lshlrev_b32 v16, 16, v16
    v_lshlrev_b32 v17, 16, v11
    v_add_f32 v14, v16, v17
    v_cvt_pk_bf16_f32 v16, v115, v115
    v_lshlrev_b32 v16, 16, v16
    v_mul_f32 v16, v16, v15
    v_cvt_pk_bf16_f32 v16, v16, v16
    v_lshlrev_b32 v16, 16, v16
    v_and_b32 v17, 0xffff0000, v11
    v_add_f32 v15, v16, v17
    v_cvt_pk_bf16_f32 v10, v12, v13
    v_cvt_pk_bf16_f32 v11, v14, v15
    global_store_dwordx2 v9, v[10:11], s[26:27] offset:64
    global_load_dwordx2 v[10:11], v9, s[22:23] offset:80
    global_load_dwordx4 v[12:15], v19, s[28:29] offset:160
    s_waitcnt vmcnt(0)
    v_cvt_pk_bf16_f32 v16, v116, v116
    v_lshlrev_b32 v16, 16, v16
    v_mul_f32 v16, v16, v12
    v_cvt_pk_bf16_f32 v16, v16, v16
    v_lshlrev_b32 v16, 16, v16
    v_lshlrev_b32 v17, 16, v10
    v_add_f32 v12, v16, v17
    v_cvt_pk_bf16_f32 v16, v117, v117
    v_lshlrev_b32 v16, 16, v16
    v_mul_f32 v16, v16, v13
    v_cvt_pk_bf16_f32 v16, v16, v16
    v_lshlrev_b32 v16, 16, v16
    v_and_b32 v17, 0xffff0000, v10
    v_add_f32 v13, v16, v17
    v_cvt_pk_bf16_f32 v16, v118, v118
    v_lshlrev_b32 v16, 16, v16
    v_mul_f32 v16, v16, v14
    v_cvt_pk_bf16_f32 v16, v16, v16
    v_lshlrev_b32 v16, 16, v16
    v_lshlrev_b32 v17, 16, v11
    v_add_f32 v14, v16, v17
    v_cvt_pk_bf16_f32 v16, v119, v119
    v_lshlrev_b32 v16, 16, v16
    v_mul_f32 v16, v16, v15
    v_cvt_pk_bf16_f32 v16, v16, v16
    v_lshlrev_b32 v16, 16, v16
    v_and_b32 v17, 0xffff0000, v11
    v_add_f32 v15, v16, v17
    v_cvt_pk_bf16_f32 v10, v12, v13
    v_cvt_pk_bf16_f32 v11, v14, v15
    global_store_dwordx2 v9, v[10:11], s[26:27] offset:80
    global_load_dwordx2 v[10:11], v9, s[22:23] offset:96
    global_load_dwordx4 v[12:15], v19, s[28:29] offset:192
    s_waitcnt vmcnt(0)
    v_cvt_pk_bf16_f32 v16, v120, v120
    v_lshlrev_b32 v16, 16, v16
    v_mul_f32 v16, v16, v12
    v_cvt_pk_bf16_f32 v16, v16, v16
    v_lshlrev_b32 v16, 16, v16
    v_lshlrev_b32 v17, 16, v10
    v_add_f32 v12, v16, v17
    v_cvt_pk_bf16_f32 v16, v121, v121
    v_lshlrev_b32 v16, 16, v16
    v_mul_f32 v16, v16, v13
    v_cvt_pk_bf16_f32 v16, v16, v16
    v_lshlrev_b32 v16, 16, v16
    v_and_b32 v17, 0xffff0000, v10
    v_add_f32 v13, v16, v17
    v_cvt_pk_bf16_f32 v16, v122, v122
    v_lshlrev_b32 v16, 16, v16
    v_mul_f32 v16, v16, v14
    v_cvt_pk_bf16_f32 v16, v16, v16
    v_lshlrev_b32 v16, 16, v16
    v_lshlrev_b32 v17, 16, v11
    v_add_f32 v14, v16, v17
    v_cvt_pk_bf16_f32 v16, v123, v123
    v_lshlrev_b32 v16, 16, v16
    v_mul_f32 v16, v16, v15
    v_cvt_pk_bf16_f32 v16, v16, v16
    v_lshlrev_b32 v16, 16, v16
    v_and_b32 v17, 0xffff0000, v11
    v_add_f32 v15, v16, v17
    v_cvt_pk_bf16_f32 v10, v12, v13
    v_cvt_pk_bf16_f32 v11, v14, v15
    global_store_dwordx2 v9, v[10:11], s[26:27] offset:96
    global_load_dwordx2 v[10:11], v9, s[22:23] offset:112
    global_load_dwordx4 v[12:15], v19, s[28:29] offset:224
    s_waitcnt vmcnt(0)
    v_cvt_pk_bf16_f32 v16, v124, v124
    v_lshlrev_b32 v16, 16, v16
    v_mul_f32 v16, v16, v12
    v_cvt_pk_bf16_f32 v16, v16, v16
    v_lshlrev_b32 v16, 16, v16
    v_lshlrev_b32 v17, 16, v10
    v_add_f32 v12, v16, v17
    v_cvt_pk_bf16_f32 v16, v125, v125
    v_lshlrev_b32 v16, 16, v16
    v_mul_f32 v16, v16, v13
    v_cvt_pk_bf16_f32 v16, v16, v16
    v_lshlrev_b32 v16, 16, v16
    v_and_b32 v17, 0xffff0000, v10
    v_add_f32 v13, v16, v17
    v_cvt_pk_bf16_f32 v16, v126, v126
    v_lshlrev_b32 v16, 16, v16
    v_mul_f32 v16, v16, v14
    v_cvt_pk_bf16_f32 v16, v16, v16
    v_lshlrev_b32 v16, 16, v16
    v_lshlrev_b32 v17, 16, v11
    v_add_f32 v14, v16, v17
    v_cvt_pk_bf16_f32 v16, v127, v127
    v_lshlrev_b32 v16, 16, v16
    v_mul_f32 v16, v16, v15
    v_cvt_pk_bf16_f32 v16, v16, v16
    v_lshlrev_b32 v16, 16, v16
    v_and_b32 v17, 0xffff0000, v11
    v_add_f32 v15, v16, v17
    v_cvt_pk_bf16_f32 v10, v12, v13
    v_cvt_pk_bf16_f32 v11, v14, v15
    global_store_dwordx2 v9, v[10:11], s[26:27] offset:112
ffn2_kernel_end:
    s_endpgm
.section .rodata,"a"
.p2align 6
.amdhsa_kernel k0_kernel
  .amdhsa_next_free_vgpr 32
  .amdhsa_next_free_sgpr 102
  .amdhsa_accum_offset 32
  .amdhsa_group_segment_fixed_size 0
  .amdhsa_kernarg_size 128
  .amdhsa_user_sgpr_count 2
  .amdhsa_user_sgpr_kernarg_segment_ptr 1
  .amdhsa_system_sgpr_workgroup_id_x 1
.end_amdhsa_kernel
.p2align 6
.amdhsa_kernel ln1_kernel
  .amdhsa_next_free_vgpr 48
  .amdhsa_next_free_sgpr 102
  .amdhsa_accum_offset 48
  .amdhsa_group_segment_fixed_size 0
  .amdhsa_kernarg_size 128
  .amdhsa_user_sgpr_count 2
  .amdhsa_user_sgpr_kernarg_segment_ptr 1
  .amdhsa_system_sgpr_workgroup_id_x 1
.end_amdhsa_kernel
.p2align 6
.amdhsa_kernel qkv_kernel
  .amdhsa_next_free_vgpr 128
  .amdhsa_next_free_sgpr 102
  .amdhsa_accum_offset 128
  .amdhsa_group_segment_fixed_size 0
  .amdhsa_kernarg_size 128
  .amdhsa_user_sgpr_count 2
  .amdhsa_user_sgpr_kernarg_segment_ptr 1
  .amdhsa_system_sgpr_workgroup_id_x 1
.end_amdhsa_kernel
.p2align 6
.amdhsa_kernel rec_kernel
  .amdhsa_next_free_vgpr 512
  .amdhsa_next_free_sgpr 102
  .amdhsa_accum_offset 256
  .amdhsa_group_segment_fixed_size 0
  .amdhsa_kernarg_size 128
  .amdhsa_user_sgpr_count 2
  .amdhsa_user_sgpr_kernarg_segment_ptr 1
  .amdhsa_system_sgpr_workgroup_id_x 1
.end_amdhsa_kernel
.p2align 6
.amdhsa_kernel attn_kernel
  .amdhsa_next_free_vgpr 208
  .amdhsa_next_free_sgpr 102
  .amdhsa_accum_offset 208
  .amdhsa_group_segment_fixed_size 0
  .amdhsa_kernarg_size 128
  .amdhsa_user_sgpr_count 2
  .amdhsa_user_sgpr_kernarg_segment_ptr 1
  .amdhsa_system_sgpr_workgroup_id_x 1
.end_amdhsa_kernel
.p2align 6
.amdhsa_kernel oproj_kernel
  .amdhsa_next_free_vgpr 128
  .amdhsa_next_free_sgpr 102
  .amdhsa_accum_offset 128
  .amdhsa_group_segment_fixed_size 0
  .amdhsa_kernarg_size 128
  .amdhsa_user_sgpr_count 2
  .amdhsa_user_sgpr_kernarg_segment_ptr 1
  .amdhsa_system_sgpr_workgroup_id_x 1
.end_amdhsa_kernel
.p2align 6
.amdhsa_kernel ln2_kernel
  .amdhsa_next_free_vgpr 48
  .amdhsa_next_free_sgpr 102
  .amdhsa_accum_offset 48
  .amdhsa_group_segment_fixed_size 0
  .amdhsa_kernarg_size 128
  .amdhsa_user_sgpr_count 2
  .amdhsa_user_sgpr_kernarg_segment_ptr 1
  .amdhsa_system_sgpr_workgroup_id_x 1
.end_amdhsa_kernel
.p2align 6
.amdhsa_kernel ffn1_kernel
  .amdhsa_next_free_vgpr 128
  .amdhsa_next_free_sgpr 102
  .amdhsa_accum_offset 128
  .amdhsa_group_segment_fixed_size 0
  .amdhsa_kernarg_size 128
  .amdhsa_user_sgpr_count 2
  .amdhsa_user_sgpr_kernarg_segment_ptr 1
  .amdhsa_system_sgpr_workgroup_id_x 1
.end_amdhsa_kernel
.p2align 6
.amdhsa_kernel ffn2_kernel
  .amdhsa_next_free_vgpr 128
  .amdhsa_next_free_sgpr 102
  .amdhsa_accum_offset 128
  .amdhsa_group_segment_fixed_size 0
  .amdhsa_kernarg_size 128
  .amdhsa_user_sgpr_count 2
  .amdhsa_user_sgpr_kernarg_segment_ptr 1
  .amdhsa_system_sgpr_workgroup_id_x 1
.end_amdhsa_kernel
```
